```python
import torch

def _softmax(x, axis=-1):
    return torch.softmax(x, dim=axis)
def _gelu(x):
    return torch.nn.functional.gelu(x, approximate="tanh")
def _silu(x):
    return torch.nn.functional.silu(x)
def _sigmoid(x):
    return torch.sigmoid(x)
def _layernorm(x, axis=-1, eps=1e-5):
    m = x.mean(dim=axis, keepdim=True)
    v = x.var(dim=axis, keepdim=True, unbiased=False)
    return (x - m) / torch.sqrt(v + eps)
def _scatter_add(tgt, idx, src, axis=0):
    return tgt.clone().index_add_(axis, idx, src)
def _segment_sum(src, seg, n):
    out = torch.zeros((n,) + src.shape[1:], dtype=src.dtype)
    return out.index_add_(0, seg, src)
def _pad(x, pw):
    flat = tuple(v for pair in reversed(pw) for v in pair)
    return torch.nn.functional.pad(x, flat)

kernel_name = 'concat_heads__mha_block_cached__mha_block_cached__near_ridge'

def setup_inputs():

    _w = (lambda a: (lambda t: t.to(torch.bfloat16) if t.is_floating_point() else t)(torch.as_tensor(a)))
    def _A_setup():
        B, Sq, D = 16, 64, 1024
        H, Sk, Dh = 32, 512, 128
        return {
            "x": _w((lambda *s: torch.randn(*s, dtype=torch.bfloat16) * 0.8)(B, Sq, D)),
            "k_cache": _w((lambda *s: torch.randn(*s, dtype=torch.bfloat16) * 0.8)(B, H, Sk, Dh)),
            "v_cache": _w((lambda *s: torch.randn(*s, dtype=torch.bfloat16) * 0.05)(B, H, Sk, Dh)),
            "wq": _w((lambda *s: torch.randn(*s, dtype=torch.bfloat16) * 0.8)(D, H * Dh) * (D ** -0.5)),
            "wo": _w((lambda *s: torch.randn(*s, dtype=torch.bfloat16) * 0.05)(H * Dh, D) * ((H * Dh) ** -0.5)),
        }
    _A_in = _A_setup()

    def _B_setup():
        B, Sq, D = 16, 64, 1024
        H, Sk, Dh = 32, 512, 128
        return {
            "x": _w((lambda *s: torch.randn(*s, dtype=torch.bfloat16) * 0.8)(B, Sq, D)),
            "k_cache": _w((lambda *s: torch.randn(*s, dtype=torch.bfloat16) * 0.8)(B, H, Sk, Dh)),
            "v_cache": _w((lambda *s: torch.randn(*s, dtype=torch.bfloat16) * 0.05)(B, H, Sk, Dh)),
            "wq": _w((lambda *s: torch.randn(*s, dtype=torch.bfloat16) * 0.8)(D, H * Dh) * (D ** -0.5)),
            "wo": _w((lambda *s: torch.randn(*s, dtype=torch.bfloat16) * 0.05)(H * Dh, D) * ((H * Dh) ** -0.5)),
        }
    _B_in = _B_setup()

    return {
        "A_x": _A_in["x"],
        "A_k_cache": _A_in["k_cache"],
        "A_v_cache": _A_in["v_cache"],
        "A_wq": _A_in["wq"],
        "A_wo": _A_in["wo"],
        "B_x": _B_in["x"],
        "B_k_cache": _B_in["k_cache"],
        "B_v_cache": _B_in["v_cache"],
        "B_wq": _B_in["wq"],
        "B_wo": _B_in["wo"],
    }

def reference(A_x, A_k_cache, A_v_cache, A_wq, A_wo, B_x, B_k_cache, B_v_cache, B_wq, B_wo):
    def _A_ref(x, k_cache, v_cache, wq, wo):
        B, Sq, D = x.shape
        H, Dh = 32, 128
        q = (lambda x, *d: x.permute(*d))((x @ wq).reshape(B, Sq, H, Dh), 0, 2, 1, 3)
        scores = torch.einsum("bhqd,bhkd->bhqk", q, k_cache) * (Dh ** -0.5)
        p = _softmax(scores, axis=-1)
        o = torch.einsum("bhqk,bhkd->bhqd", p, v_cache)
        return (lambda x, *d: x.permute(*d))(o, 0, 2, 1, 3).reshape(B, Sq, H * Dh) @ wo

    def _B_ref(x, k_cache, v_cache, wq, wo):
        B, Sq, D = x.shape
        H, Dh = 32, 128
        q = (lambda x, *d: x.permute(*d))((x @ wq).reshape(B, Sq, H, Dh), 0, 2, 1, 3)
        scores = torch.einsum("bhqd,bhkd->bhqk", q, k_cache) * (Dh ** -0.5)
        p = _softmax(scores, axis=-1)
        o = torch.einsum("bhqk,bhkd->bhqd", p, v_cache)
        return (lambda x, *d: x.permute(*d))(o, 0, 2, 1, 3).reshape(B, Sq, H * Dh) @ wo

    a = _A_ref(A_x, A_k_cache, A_v_cache, A_wq, A_wo)
    b = _B_ref(B_x, B_k_cache, B_v_cache, B_wq, B_wo)
    return torch.concatenate([a, b], axis=-1)
```

```asm
; @launch grid=(256,1,1) block=(256,1,1) lds=163840
.amdgcn_target "amdgcn-amd-amdhsa--gfx950"
.text
.globl concat_heads__mha_block_cached__mha_block_cached__near_ridge_kernel
.p2align 8
.type concat_heads__mha_block_cached__mha_block_cached__near_ridge_kernel,@function
concat_heads__mha_block_cached__mha_block_cached__near_ridge_kernel:
 s_cmp_ge_u32 s2, 256
 s_cbranch_scc1 L_END
 s_load_dwordx4 s[96:99], s[0:1], 80
 s_load_dwordx2 s[90:91], s[0:1], 96
 s_and_b32 s3, s2, 7
 s_lshr_b32 s4, s2, 3
 s_lshr_b32 s45, s3, 2
 s_and_b32 s5, s3, 3
 s_lshl_b32 s5, s5, 3
 s_and_b32 s6, s4, 7
 s_add_u32 s46, s5, s6
 s_lshr_b32 s47, s4, 3
 s_lshl_b32 s7, s47, 1
 s_add_u32 s7, s7, s6
 s_and_b32 s51, s7, 7
 s_lshr_b32 s7, s6, 1
 s_add_u32 s7, s7, s47
 s_and_b32 s51, s7, 3
 s_lshr_b32 s5, s3, 1
 s_and_b32 s5, s5, 1
 s_lshl_b32 s5, s5, 2
 s_and_b32 s6, s4, 3
 s_add_u32 s48, s5, s6
 s_and_b32 s5, s3, 1
 s_lshl_b32 s5, s5, 2
 s_lshr_b32 s7, s4, 2
 s_and_b32 s7, s7, 3
 s_add_u32 s49, s5, s7
 s_lshr_b32 s50, s4, 4
 s_add_u32 s52, s6, s7
 s_and_b32 s52, s52, 3
 s_lshl_b32 s52, s52, 1
 s_mul_i32 s5, s45, 40
 s_add_u32 s4, s0, s5
 s_addc_u32 s5, s1, 0
 s_load_dwordx4 s[8:11], s[4:5], 0
 s_load_dwordx4 s[12:15], s[4:5], 16
 s_load_dwordx2 s[16:17], s[4:5], 32
 v_lshrrev_b32 v1, 6, v0
 v_and_b32 v0, 63, v0
 s_nop 0
 v_readfirstlane_b32 s44, v1
 v_lshrrev_b32 v1, 3, v0
 v_and_b32 v2, 7, v0
 v_lshrrev_b32 v3, 4, v0
 v_and_b32 v4, 15, v0
 v_xor_b32 v5, v2, v3
 v_lshlrev_b32 v5, 4, v5
 v_lshl_add_u32 v46, v1, 11, v5
 v_xor_b32 v5, 64, v5
 v_lshl_add_u32 v5, v1, 11, v5
 v_add_u32 v47, 15360, v5
 v_lshrrev_b32 v5, 1, v4
 v_xor_b32 v5, v5, v3
 v_lshlrev_b32 v5, 4, v5
 v_lshl_add_u32 v5, v4, 7, v5
 s_lshl_b32 s66, s44, 14
 s_add_u32 s66, s66, 98304
 v_add_u32 v48, s66, v5
 v_xor_b32 v49, 64, v48
 v_and_b32 v5, 1, v3
 v_and_b32 v6, 2, v3
 v_lshl_or_b32 v5, v6, 1, v5
 v_xor_b32 v5, v5, v4
 v_xor_b32 v6, 0, v5
 v_lshlrev_b32 v6, 4, v6
 v_lshl_add_u32 v6, v3, 13, v6
 v_add_u32 v50, 0, v6
 v_xor_b32 v6, 0, v5
 v_lshlrev_b32 v6, 4, v6
 v_lshl_add_u32 v6, v3, 13, v6
 v_add_u32 v51, 31744, v6
 v_xor_b32 v6, 8, v5
 v_lshlrev_b32 v6, 4, v6
 v_lshl_add_u32 v6, v3, 13, v6
 v_add_u32 v52, 63488, v6
 v_xor_b32 v6, 8, v5
 v_lshlrev_b32 v6, 4, v6
 v_lshl_add_u32 v6, v3, 13, v6
 v_add_u32 v53, 95232, v6
 v_lshrrev_b32 v5, 2, v4
 v_and_b32 v6, 3, v0
 v_and_b32 v7, 1, v5
 v_and_b32 v1, 2, v5
 v_lshl_or_b32 v7, v1, 1, v7
 v_and_b32 v1, 1, v3
 v_lshl_or_b32 v7, v1, 3, v7
 v_xor_b32 v7, v7, v6
 v_lshlrev_b32 v7, 4, v7
 v_and_b32 v1, 1, v6
 v_lshl_or_b32 v7, v1, 3, v7
 v_lshl_add_u32 v1, v3, 3, v5
 v_lshl_add_u32 v7, v1, 8, v7
 v_add_u32 v7, 49152, v7
 v_xor_b32 v54, 0, v7
 v_xor_b32 v55, 8, v7
 v_xor_b32 v56, 64, v7
 v_xor_b32 v57, 72, v7
 v_xor_b32 v58, 128, v7
 v_xor_b32 v59, 136, v7
 v_xor_b32 v60, 192, v7
 v_xor_b32 v61, 200, v7
 v_add_u32 v5, 0, v3
 v_lshlrev_b32 v5, 1, v5
 v_xor_b32 v5, v5, v4
 v_lshlrev_b32 v5, 4, v5
 v_lshl_add_u32 v5, v3, 11, v5
 v_add_u32 v40, 0, v5
 v_add_u32 v5, 4, v3
 v_lshlrev_b32 v5, 1, v5
 v_xor_b32 v5, v5, v4
 v_lshlrev_b32 v5, 4, v5
 v_lshl_add_u32 v5, v3, 11, v5
 v_add_u32 v41, 7168, v5
 v_add_u32 v5, 0, v3
 v_lshlrev_b32 v5, 1, v5
 v_xor_b32 v5, v5, v4
 v_lshlrev_b32 v5, 4, v5
 v_lshl_add_u32 v5, v3, 11, v5
 v_add_u32 v42, 14336, v5
 v_add_u32 v5, 4, v3
 v_lshlrev_b32 v5, 1, v5
 v_xor_b32 v5, v5, v4
 v_lshlrev_b32 v5, 4, v5
 v_lshl_add_u32 v5, v3, 11, v5
 v_add_u32 v43, 21504, v5
 s_lshl_b32 s58, s50, 4
 v_add_u32 v5, s58, v4
 v_lshrrev_b32 v6, 3, v5
 s_lshl_b32 s58, s45, 2
 v_add_u32 v6, s58, v6
 v_and_b32 v5, 7, v5
 s_lshr_b32 s58, s48, 1
 s_lshl_b32 s58, s58, 3
 v_add_u32 v5, s58, v5
 v_lshl_add_u32 v5, v5, 3, v6
 v_lshlrev_b32 v5, 7, v5
 s_mov_b32 s58, 46137344
 v_add_u32 v44, s58, v5
 v_add_u32 v5, 0, v3
 v_xor_b32 v5, v5, v4
 v_lshlrev_b32 v5, 4, v5
 v_lshl_add_u32 v8, v3, 8, v5
 v_add_u32 v5, 4, v3
 v_xor_b32 v5, v5, v4
 v_lshlrev_b32 v5, 4, v5
 v_lshl_add_u32 v9, v3, 8, v5
 v_add_u32 v5, 8, v3
 v_xor_b32 v5, v5, v4
 v_lshlrev_b32 v5, 4, v5
 v_lshl_add_u32 v10, v3, 8, v5
 v_add_u32 v5, 12, v3
 v_xor_b32 v5, v5, v4
 v_lshlrev_b32 v5, 4, v5
 v_lshl_add_u32 v11, v3, 8, v5
 v_xor_b32 v5, v3, v4
 v_lshlrev_b32 v5, 4, v5
 v_lshl_add_u32 v5, v4, 8, v5
 v_xor_b32 v14, 0, v5
 v_add_u32 v18, 0x10000, v14
 v_xor_b32 v15, 64, v5
 v_add_u32 v19, 0x10000, v15
 v_xor_b32 v16, 128, v5
 v_add_u32 v20, 0x10000, v16
 v_xor_b32 v17, 192, v5
 v_add_u32 v21, 0x10000, v17
 v_add_u32 v5, 0, v3
 v_lshlrev_b32 v5, 1, v5
 v_xor_b32 v5, v5, v4
 v_lshlrev_b32 v5, 4, v5
 v_lshl_add_u32 v12, v3, 8, v5
 v_add_u32 v5, 4, v3
 v_lshlrev_b32 v5, 1, v5
 v_xor_b32 v5, v5, v4
 v_lshlrev_b32 v5, 4, v5
 v_lshl_add_u32 v13, v3, 8, v5
 v_lshrrev_b32 v5, 2, v4
 v_and_b32 v6, 3, v0
 v_and_b32 v7, 1, v3
 v_lshl_add_u32 v7, v7, 2, v5
 v_lshlrev_b32 v7, 1, v7
 v_lshrrev_b32 v1, 1, v6
 v_xor_b32 v7, v7, v1
 v_lshlrev_b32 v7, 4, v7
 v_and_b32 v1, 1, v6
 v_lshl_or_b32 v7, v1, 3, v7
 v_lshl_add_u32 v1, v3, 2, v5
 v_lshl_add_u32 v7, v1, 8, v7
 v_xor_b32 v22, 0, v7
 v_add_u32 v30, 0x10000, v22
 v_xor_b32 v23, 32, v7
 v_add_u32 v31, 0x10000, v23
 v_xor_b32 v24, 64, v7
 v_add_u32 v32, 0x10000, v24
 v_xor_b32 v25, 96, v7
 v_add_u32 v33, 0x10000, v25
 v_xor_b32 v26, 128, v7
 v_add_u32 v34, 0x10000, v26
 v_xor_b32 v27, 160, v7
 v_add_u32 v35, 0x10000, v27
 v_xor_b32 v28, 192, v7
 v_add_u32 v36, 0x10000, v28
 v_xor_b32 v29, 224, v7
 v_add_u32 v37, 0x10000, v29
 v_lshlrev_b32 v45, 7, v0
 s_and_b32 s58, s2, 3
 s_lshl_b32 s58, s58, 5
 s_lshr_b32 s59, s2, 3
 s_add_u32 s58, s58, s59
 s_lshl_b32 s88, s58, 16
 s_lshl_b32 s58, s44, 14
 s_add_u32 s88, s88, s58
 v_lshlrev_b32 v38, 4, v0
 v_add_u32 v39, 0x20000, v38
 v_mov_b32 v1, 0x3f803f80
 v_accvgpr_write_b32 a168, v1
 v_accvgpr_write_b32 a169, v1
 v_accvgpr_write_b32 a170, v1
 v_accvgpr_write_b32 a171, v1
 s_waitcnt lgkmcnt(0)
 s_mov_b32 s92, s98
 s_mov_b32 s93, s99
 s_mov_b32 s36, s96
 s_and_b32 s37, s97, 0xffff
 s_mov_b32 s38, 4194304
 s_mov_b32 s39, 0x20000
 s_mov_b32 s32, s16
 s_and_b32 s33, s17, 0xffff
 s_mov_b32 s34, 8388608
 s_mov_b32 s35, 0x20000
 s_mov_b32 s40, s16
 s_and_b32 s41, s17, 0xffff
 s_mov_b32 s42, 8388608
 s_mov_b32 s43, 0x20000
 s_mov_b32 s20, s12
 s_and_b32 s21, s13, 0xffff
 s_mov_b32 s22, 67108864
 s_mov_b32 s23, 0x20000
 s_mov_b32 s16, s10
 s_and_b32 s17, s11, 0xffff
 s_mov_b32 s18, 67108864
 s_mov_b32 s19, 0x20000
 s_mov_b32 s24, s10
 s_and_b32 s25, s11, 0xffff
 s_mov_b32 s26, 67108864
 s_mov_b32 s27, 0x20000
 s_mov_b32 s4, s14
 s_mov_b32 s5, s15
 s_and_b32 s9, s9, 0xffff
 s_mov_b32 s10, 2097152
 s_mov_b32 s11, 0x20000
 s_mov_b32 s12, s4
 s_and_b32 s13, s5, 0xffff
 s_mov_b32 s14, 8388608
 s_mov_b32 s15, 0x20000
 s_mov_b32 s28, s90
 s_and_b32 s29, s91, 0xffff
 s_mov_b32 s30, 50331648
 s_mov_b32 s31, 0x20000
 s_mov_b32 s84, s90
 s_and_b32 s85, s91, 0xffff
 s_mov_b32 s86, 50331648
 s_mov_b32 s87, 0x20000
 s_add_u32 s94, s90, 50331648
 s_addc_u32 s95, s91, 0
 s_mov_b32 s89, 0
 s_lshl_b32 s65, s44, 12
 s_add_u32 s67, s65, 49152
 s_lshl_b32 s58, s47, 19
 s_lshl_b32 s59, s44, 15
 s_add_u32 s70, s58, s59
 s_add_u32 s71, s70, 0x20000
 s_add_u32 s72, s70, 0x40000
 s_add_u32 s73, s70, 0x60000
 s_lshl_b32 s58, s44, 17
 s_lshl_b32 s59, s46, 8
 s_add_u32 s53, s58, s59
 s_add_u32 s58, s51, 0
 s_and_b32 s58, s58, 3
 s_or_b32 s58, s58, 0
 s_lshl_b32 s55, s58, 19
 s_add_u32 m0, s67, 0
 s_add_u32 s59, s53, s55
 buffer_load_dwordx4 v50, s[12:15], s59 offen offset:0 lds
 buffer_load_dwordx4 v51, s[12:15], s59 offen offset:1024 lds
 buffer_load_dwordx4 v52, s[12:15], s59 offen offset:2048 lds
 buffer_load_dwordx4 v53, s[12:15], s59 offen offset:3072 lds
 s_add_u32 s58, s51, 0
 s_and_b32 s58, s58, 3
 s_or_b32 s58, s58, 0
 s_lshl_b32 s54, s58, 7
 s_add_u32 m0, s66, 0
 s_add_u32 s59, s70, s54
 buffer_load_dwordx4 v46, s[8:11], s59 offen offset:0 lds
 buffer_load_dwordx4 v47, s[8:11], s59 offen offset:1024 lds
 s_add_u32 m0, s66, 2048
 s_add_u32 s59, s71, s54
 buffer_load_dwordx4 v46, s[8:11], s59 offen offset:0 lds
 buffer_load_dwordx4 v47, s[8:11], s59 offen offset:1024 lds
 s_add_u32 m0, s66, 4096
 s_add_u32 s59, s72, s54
 buffer_load_dwordx4 v46, s[8:11], s59 offen offset:0 lds
 buffer_load_dwordx4 v47, s[8:11], s59 offen offset:1024 lds
 s_add_u32 m0, s66, 6144
 s_add_u32 s59, s73, s54
 buffer_load_dwordx4 v46, s[8:11], s59 offen offset:0 lds
 buffer_load_dwordx4 v47, s[8:11], s59 offen offset:1024 lds
 s_add_u32 s58, s51, 1
 s_and_b32 s58, s58, 3
 s_or_b32 s58, s58, 0
 s_lshl_b32 s55, s58, 19
 s_add_u32 m0, s67, 16384
 s_add_u32 s59, s53, s55
 buffer_load_dwordx4 v50, s[12:15], s59 offen offset:0 lds
 buffer_load_dwordx4 v51, s[12:15], s59 offen offset:1024 lds
 buffer_load_dwordx4 v52, s[12:15], s59 offen offset:2048 lds
 buffer_load_dwordx4 v53, s[12:15], s59 offen offset:3072 lds
 s_mov_b32 s64, 1040356334
 s_mov_b32 s68, 0xffff0000
 s_mov_b32 s69, 0xffff0000
 s_lshl_b32 s58, s47, 24
 s_lshl_b32 s59, s46, 17
 s_add_u32 s60, s58, s59
 s_add_u32 s60, s60, s65
 s_add_u32 s61, s60, 0x400000
 s_lshl_b32 s58, s45, 23
 s_lshl_b32 s59, s47, 21
 s_add_u32 s63, s58, s59
 s_lshl_b32 s58, s44, 17
 s_add_u32 s63, s63, s58
 s_lshl_b32 s58, s46, 12
 s_add_u32 s63, s63, s58
 s_lshl_b32 s58, s50, 22
 s_lshl_b32 s59, s44, 15
 s_add_u32 s75, s58, s59
 s_lshl_b32 s58, s49, 8
 s_add_u32 s75, s75, s58
 s_lshl_b32 s58, s48, 3
 s_lshl_b32 s59, s44, 1
 s_add_u32 s58, s58, s59
 s_lshl_b32 s81, s58, 16
 s_lshl_b32 s76, s58, 17
 s_lshl_b32 s59, s45, 23
 s_add_u32 s76, s76, s59
 s_lshl_b32 s59, s50, 16
 s_add_u32 s76, s76, s59
 s_lshl_b32 s59, s45, 11
 s_add_u32 s81, s81, s59
 s_lshl_b32 s59, s49, 8
 s_add_u32 s81, s81, s59
 s_lshl_b32 s59, s50, 7
 s_add_u32 s81, s81, s59
 s_lshl_b32 s59, s44, 13
 s_lshl_b32 s82, s2, 15
 s_add_u32 s82, s82, s59
 s_add_u32 s82, s82, 16777216
 s_xor_b32 s83, s2, 128
 s_lshl_b32 s83, s83, 15
 s_add_u32 s83, s83, s59
 s_add_u32 s83, s83, 16777216
 s_lshr_b32 s58, s2, 3
 s_and_b32 s58, s58, 7
 s_lshl_b32 s100, s58, 14
 s_mov_b32 s62, 0
 s_mov_b32 s74, 0
 s_mov_b32 s7, 0
 s_mov_b32 s3, 0
 s_cmp_lg_u32 s44, 0
 s_cbranch_scc1 L_NONCE_DONE
 s_memrealtime s[96:97]
 s_waitcnt lgkmcnt(0)
 s_or_b32 s96, s96, 1
 v_mov_b32 v4, s96
 v_mov_b32 v5, 0
 v_accvgpr_write_b32 a164, v4
 v_accvgpr_write_b32 a165, v5
 s_mov_b64 exec, 1
 global_atomic_cmpswap a166, v5, a[164:165], s[92:93] sc0
 s_mov_b64 exec, -1
L_NONCE_DONE:
 s_waitcnt vmcnt(12)
 s_barrier
 ds_read_b64_tr_b16 a[0:1], v54 offset:0
 ds_read_b64_tr_b16 a[2:3], v54 offset:1024
 ds_read_b64_tr_b16 a[4:5], v55 offset:0
 ds_read_b64_tr_b16 a[6:7], v55 offset:1024
 ds_read_b64_tr_b16 a[8:9], v56 offset:0
 ds_read_b64_tr_b16 a[10:11], v56 offset:1024
 ds_read_b64_tr_b16 a[12:13], v57 offset:0
 ds_read_b64_tr_b16 a[14:15], v57 offset:1024
 ds_read_b64_tr_b16 a[16:17], v58 offset:0
 ds_read_b64_tr_b16 a[18:19], v58 offset:1024
 ds_read_b64_tr_b16 a[20:21], v59 offset:0
 ds_read_b64_tr_b16 a[22:23], v59 offset:1024
 ds_read_b64_tr_b16 a[24:25], v60 offset:0
 ds_read_b64_tr_b16 a[26:27], v60 offset:1024
 ds_read_b64_tr_b16 a[28:29], v61 offset:0
 ds_read_b64_tr_b16 a[30:31], v61 offset:1024
 ds_read_b64_tr_b16 a[32:33], v54 offset:8192
 ds_read_b64_tr_b16 a[34:35], v54 offset:9216
 ds_read_b64_tr_b16 a[36:37], v55 offset:8192
 ds_read_b64_tr_b16 a[38:39], v55 offset:9216
 ds_read_b64_tr_b16 a[40:41], v56 offset:8192
 ds_read_b64_tr_b16 a[42:43], v56 offset:9216
 ds_read_b64_tr_b16 a[44:45], v57 offset:8192
 ds_read_b64_tr_b16 a[46:47], v57 offset:9216
 ds_read_b64_tr_b16 a[48:49], v58 offset:8192
 ds_read_b64_tr_b16 a[50:51], v58 offset:9216
 ds_read_b64_tr_b16 a[52:53], v59 offset:8192
 ds_read_b64_tr_b16 a[54:55], v59 offset:9216
 ds_read_b64_tr_b16 a[56:57], v60 offset:8192
 ds_read_b64_tr_b16 a[58:59], v60 offset:9216
 ds_read_b64_tr_b16 a[60:61], v61 offset:8192
 ds_read_b64_tr_b16 a[62:63], v61 offset:9216
 s_waitcnt vmcnt(10)
 ds_read_b128 a[128:131], v48 offset:0
 ds_read_b128 a[132:135], v49 offset:0
 s_add_u32 s58, s51, 1
 s_and_b32 s58, s58, 3
 s_or_b32 s58, s58, 0
 s_lshl_b32 s54, s58, 7
 s_add_u32 m0, s66, 8192
 s_add_u32 s59, s70, s54
 buffer_load_dwordx4 v46, s[8:11], s59 offen offset:0 lds
 buffer_load_dwordx4 v47, s[8:11], s59 offen offset:1024 lds
 s_add_u32 m0, s66, 10240
 s_add_u32 s59, s71, s54
 buffer_load_dwordx4 v46, s[8:11], s59 offen offset:0 lds
 buffer_load_dwordx4 v47, s[8:11], s59 offen offset:1024 lds
 s_add_u32 m0, s66, 12288
 s_add_u32 s59, s72, s54
 buffer_load_dwordx4 v46, s[8:11], s59 offen offset:0 lds
 buffer_load_dwordx4 v47, s[8:11], s59 offen offset:1024 lds
 s_add_u32 m0, s66, 14336
 s_add_u32 s59, s73, s54
 buffer_load_dwordx4 v46, s[8:11], s59 offen offset:0 lds
 buffer_load_dwordx4 v47, s[8:11], s59 offen offset:1024 lds
 s_add_u32 s58, s51, 2
 s_and_b32 s58, s58, 3
 s_or_b32 s58, s58, 0
 s_lshl_b32 s55, s58, 19
 s_add_u32 m0, s67, 32768
 s_add_u32 s59, s53, s55
 buffer_load_dwordx4 v50, s[12:15], s59 offen offset:0 lds
 buffer_load_dwordx4 v51, s[12:15], s59 offen offset:1024 lds
 buffer_load_dwordx4 v52, s[12:15], s59 offen offset:2048 lds
 buffer_load_dwordx4 v53, s[12:15], s59 offen offset:3072 lds
 s_add_u32 s58, s51, 2
 s_and_b32 s58, s58, 3
 s_lshl_b32 s54, s58, 7
 s_add_u32 s58, s51, 3
 s_and_b32 s58, s58, 3
 s_lshl_b32 s55, s58, 19
 s_waitcnt vmcnt(12)
 s_waitcnt lgkmcnt(2)
 s_barrier
 s_waitcnt lgkmcnt(0)
 v_mfma_f32_16x16x32_bf16 v[128:131], a[0:3], a[128:131], 0
 ds_read_b64_tr_b16 a[64:65], v54 offset:16384
 s_add_u32 s57, s53, s55
 v_mfma_f32_16x16x32_bf16 v[132:135], a[4:7], a[128:131], 0
 ds_read_b64_tr_b16 a[66:67], v54 offset:17408
 s_add_u32 m0, s67, 0
 v_mfma_f32_16x16x32_bf16 v[136:139], a[8:11], a[128:131], 0
 buffer_load_dwordx4 v50, s[12:15], s57 offen offset:0 lds
 v_mfma_f32_16x16x32_bf16 v[140:143], a[12:15], a[128:131], 0
 ds_read_b64_tr_b16 a[68:69], v55 offset:16384
 v_mfma_f32_16x16x32_bf16 v[144:147], a[16:19], a[128:131], 0
 ds_read_b128 a[136:139], v48 offset:2048
 v_mfma_f32_16x16x32_bf16 v[148:151], a[20:23], a[128:131], 0
 ds_read_b128 a[140:143], v49 offset:2048
 v_mfma_f32_16x16x32_bf16 v[152:155], a[24:27], a[128:131], 0
 ds_read_b64_tr_b16 a[70:71], v55 offset:17408
 v_mfma_f32_16x16x32_bf16 v[156:159], a[28:31], a[128:131], 0
 buffer_load_dwordx4 v51, s[12:15], s57 offen offset:1024 lds
 v_mfma_f32_16x16x32_bf16 v[128:131], a[32:35], a[132:135], v[128:131]
 ds_read_b64_tr_b16 a[72:73], v56 offset:16384
 v_mfma_f32_16x16x32_bf16 v[132:135], a[36:39], a[132:135], v[132:135]
 ds_read_b64_tr_b16 a[74:75], v56 offset:17408
 v_mfma_f32_16x16x32_bf16 v[136:139], a[40:43], a[132:135], v[136:139]
 ds_read_b64_tr_b16 a[76:77], v57 offset:16384
 v_mfma_f32_16x16x32_bf16 v[140:143], a[44:47], a[132:135], v[140:143]
 v_mfma_f32_16x16x32_bf16 v[144:147], a[48:51], a[132:135], v[144:147]
 buffer_load_dwordx4 v52, s[12:15], s57 offen offset:2048 lds
 v_mfma_f32_16x16x32_bf16 v[148:151], a[52:55], a[132:135], v[148:151]
 ds_read_b64_tr_b16 a[78:79], v57 offset:17408
 v_mfma_f32_16x16x32_bf16 v[152:155], a[56:59], a[132:135], v[152:155]
 ds_read_b64_tr_b16 a[80:81], v58 offset:16384
 v_mfma_f32_16x16x32_bf16 v[156:159], a[60:63], a[132:135], v[156:159]
 ds_read_b64_tr_b16 a[82:83], v58 offset:17408
 s_waitcnt lgkmcnt(7)
 v_mfma_f32_16x16x32_bf16 v[160:163], a[0:3], a[136:139], 0
 v_mfma_f32_16x16x32_bf16 v[164:167], a[4:7], a[136:139], 0
 buffer_load_dwordx4 v53, s[12:15], s57 offen offset:3072 lds
 s_add_u32 s55, s55, 524288
 v_mfma_f32_16x16x32_bf16 v[168:171], a[8:11], a[136:139], 0
 ds_read_b64_tr_b16 a[84:85], v59 offset:16384
 s_and_b32 s55, s55, 1572864
 v_mfma_f32_16x16x32_bf16 v[172:175], a[12:15], a[136:139], 0
 ds_read_b64_tr_b16 a[86:87], v59 offset:17408
 v_mfma_f32_16x16x32_bf16 v[176:179], a[16:19], a[136:139], 0
 ds_read_b128 a[128:131], v48 offset:4096
 v_mfma_f32_16x16x32_bf16 v[180:183], a[20:23], a[136:139], 0
 ds_read_b128 a[132:135], v49 offset:4096
 s_add_u32 s56, s70, s54
 v_mfma_f32_16x16x32_bf16 v[184:187], a[24:27], a[136:139], 0
 ds_read_b64_tr_b16 a[88:89], v60 offset:16384
 s_add_u32 m0, s66, 0
 v_mfma_f32_16x16x32_bf16 v[188:191], a[28:31], a[136:139], 0
 buffer_load_dwordx4 v46, s[8:11], s56 offen offset:0 lds
 v_mfma_f32_16x16x32_bf16 v[160:163], a[32:35], a[140:143], v[160:163]
 ds_read_b64_tr_b16 a[90:91], v60 offset:17408
 v_mfma_f32_16x16x32_bf16 v[164:167], a[36:39], a[140:143], v[164:167]
 ds_read_b64_tr_b16 a[92:93], v61 offset:16384
 v_mfma_f32_16x16x32_bf16 v[168:171], a[40:43], a[140:143], v[168:171]
 ds_read_b64_tr_b16 a[94:95], v61 offset:17408
 v_mfma_f32_16x16x32_bf16 v[172:175], a[44:47], a[140:143], v[172:175]
 v_mfma_f32_16x16x32_bf16 v[176:179], a[48:51], a[140:143], v[176:179]
 buffer_load_dwordx4 v47, s[8:11], s56 offen offset:1024 lds
 v_mfma_f32_16x16x32_bf16 v[180:183], a[52:55], a[140:143], v[180:183]
 ds_read_b64_tr_b16 a[96:97], v54 offset:24576
 v_mfma_f32_16x16x32_bf16 v[184:187], a[56:59], a[140:143], v[184:187]
 ds_read_b64_tr_b16 a[98:99], v54 offset:25600
 v_mfma_f32_16x16x32_bf16 v[188:191], a[60:63], a[140:143], v[188:191]
 ds_read_b64_tr_b16 a[100:101], v55 offset:24576
 s_waitcnt lgkmcnt(7)
 v_mfma_f32_16x16x32_bf16 v[192:195], a[0:3], a[128:131], 0
 s_add_u32 s56, s71, s54
 v_mfma_f32_16x16x32_bf16 v[196:199], a[4:7], a[128:131], 0
 ds_read_b64_tr_b16 a[102:103], v55 offset:25600
 s_add_u32 m0, s66, 2048
 v_mfma_f32_16x16x32_bf16 v[200:203], a[8:11], a[128:131], 0
 buffer_load_dwordx4 v46, s[8:11], s56 offen offset:0 lds
 v_mfma_f32_16x16x32_bf16 v[204:207], a[12:15], a[128:131], 0
 ds_read_b64_tr_b16 a[104:105], v56 offset:24576
 v_mfma_f32_16x16x32_bf16 v[208:211], a[16:19], a[128:131], 0
 ds_read_b128 a[136:139], v48 offset:6144
 v_mfma_f32_16x16x32_bf16 v[212:215], a[20:23], a[128:131], 0
 ds_read_b128 a[140:143], v49 offset:6144
 v_mfma_f32_16x16x32_bf16 v[216:219], a[24:27], a[128:131], 0
 ds_read_b64_tr_b16 a[106:107], v56 offset:25600
 v_mfma_f32_16x16x32_bf16 v[220:223], a[28:31], a[128:131], 0
 buffer_load_dwordx4 v47, s[8:11], s56 offen offset:1024 lds
 v_mfma_f32_16x16x32_bf16 v[192:195], a[32:35], a[132:135], v[192:195]
 ds_read_b64_tr_b16 a[108:109], v57 offset:24576
 v_mfma_f32_16x16x32_bf16 v[196:199], a[36:39], a[132:135], v[196:199]
 ds_read_b64_tr_b16 a[110:111], v57 offset:25600
 v_mfma_f32_16x16x32_bf16 v[200:203], a[40:43], a[132:135], v[200:203]
 ds_read_b64_tr_b16 a[112:113], v58 offset:24576
 v_mfma_f32_16x16x32_bf16 v[204:207], a[44:47], a[132:135], v[204:207]
 ds_read_b64_tr_b16 a[114:115], v58 offset:25600
 s_add_u32 s56, s72, s54
 v_mfma_f32_16x16x32_bf16 v[208:211], a[48:51], a[132:135], v[208:211]
 s_add_u32 m0, s66, 4096
 v_mfma_f32_16x16x32_bf16 v[212:215], a[52:55], a[132:135], v[212:215]
 buffer_load_dwordx4 v46, s[8:11], s56 offen offset:0 lds
 v_mfma_f32_16x16x32_bf16 v[216:219], a[56:59], a[132:135], v[216:219]
 ds_read_b64_tr_b16 a[116:117], v59 offset:24576
 v_mfma_f32_16x16x32_bf16 v[220:223], a[60:63], a[132:135], v[220:223]
 ds_read_b64_tr_b16 a[118:119], v59 offset:25600
 s_waitcnt lgkmcnt(7)
 v_mfma_f32_16x16x32_bf16 v[224:227], a[0:3], a[136:139], 0
 v_mfma_f32_16x16x32_bf16 v[228:231], a[4:7], a[136:139], 0
 ds_read_b64_tr_b16 a[120:121], v60 offset:24576
 v_mfma_f32_16x16x32_bf16 v[232:235], a[8:11], a[136:139], 0
 buffer_load_dwordx4 v47, s[8:11], s56 offen offset:1024 lds
 v_mfma_f32_16x16x32_bf16 v[236:239], a[12:15], a[136:139], 0
 ds_read_b64_tr_b16 a[122:123], v60 offset:25600
 v_mfma_f32_16x16x32_bf16 v[240:243], a[16:19], a[136:139], 0
 s_waitcnt vmcnt(20)
 ds_read_b128 a[128:131], v48 offset:8192
 v_mfma_f32_16x16x32_bf16 v[244:247], a[20:23], a[136:139], 0
 ds_read_b128 a[132:135], v49 offset:8192
 v_mfma_f32_16x16x32_bf16 v[248:251], a[24:27], a[136:139], 0
 ds_read_b64_tr_b16 a[124:125], v61 offset:24576
 s_add_u32 s56, s73, s54
 v_mfma_f32_16x16x32_bf16 v[252:255], a[28:31], a[136:139], 0
 ds_read_b64_tr_b16 a[126:127], v61 offset:25600
 s_add_u32 m0, s66, 6144
 v_mfma_f32_16x16x32_bf16 v[224:227], a[32:35], a[140:143], v[224:227]
 buffer_load_dwordx4 v46, s[8:11], s56 offen offset:0 lds
 v_mfma_f32_16x16x32_bf16 v[228:231], a[36:39], a[140:143], v[228:231]
 v_mfma_f32_16x16x32_bf16 v[232:235], a[40:43], a[140:143], v[232:235]
 v_mfma_f32_16x16x32_bf16 v[236:239], a[44:47], a[140:143], v[236:239]
 v_mfma_f32_16x16x32_bf16 v[240:243], a[48:51], a[140:143], v[240:243]
 v_mfma_f32_16x16x32_bf16 v[244:247], a[52:55], a[140:143], v[244:247]
 buffer_load_dwordx4 v47, s[8:11], s56 offen offset:1024 lds
 s_add_u32 s54, s54, 128
 v_mfma_f32_16x16x32_bf16 v[248:251], a[56:59], a[140:143], v[248:251]
 s_and_b32 s54, s54, 384
 v_mfma_f32_16x16x32_bf16 v[252:255], a[60:63], a[140:143], v[252:255]
 s_waitcnt vmcnt(12)
 s_waitcnt lgkmcnt(0)
 s_barrier
 v_mfma_f32_16x16x32_bf16 v[128:131], a[64:67], a[128:131], v[128:131]
 ds_read_b64_tr_b16 a[0:1], v54 offset:32768
 s_add_u32 s53, s53, 2097152
 s_add_u32 s57, s53, s55
 v_mfma_f32_16x16x32_bf16 v[132:135], a[68:71], a[128:131], v[132:135]
 ds_read_b64_tr_b16 a[2:3], v54 offset:33792
 s_add_u32 m0, s67, 16384
 v_mfma_f32_16x16x32_bf16 v[136:139], a[72:75], a[128:131], v[136:139]
 buffer_load_dwordx4 v50, s[12:15], s57 offen offset:0 lds
 v_mfma_f32_16x16x32_bf16 v[140:143], a[76:79], a[128:131], v[140:143]
 ds_read_b64_tr_b16 a[4:5], v55 offset:32768
 v_mfma_f32_16x16x32_bf16 v[144:147], a[80:83], a[128:131], v[144:147]
 ds_read_b128 a[136:139], v48 offset:10240
 v_mfma_f32_16x16x32_bf16 v[148:151], a[84:87], a[128:131], v[148:151]
 ds_read_b128 a[140:143], v49 offset:10240
 v_mfma_f32_16x16x32_bf16 v[152:155], a[88:91], a[128:131], v[152:155]
 ds_read_b64_tr_b16 a[6:7], v55 offset:33792
 v_mfma_f32_16x16x32_bf16 v[156:159], a[92:95], a[128:131], v[156:159]
 buffer_load_dwordx4 v51, s[12:15], s57 offen offset:1024 lds
 v_mfma_f32_16x16x32_bf16 v[128:131], a[96:99], a[132:135], v[128:131]
 ds_read_b64_tr_b16 a[8:9], v56 offset:32768
 v_mfma_f32_16x16x32_bf16 v[132:135], a[100:103], a[132:135], v[132:135]
 ds_read_b64_tr_b16 a[10:11], v56 offset:33792
 v_mfma_f32_16x16x32_bf16 v[136:139], a[104:107], a[132:135], v[136:139]
 ds_read_b64_tr_b16 a[12:13], v57 offset:32768
 v_mfma_f32_16x16x32_bf16 v[140:143], a[108:111], a[132:135], v[140:143]
 v_mfma_f32_16x16x32_bf16 v[144:147], a[112:115], a[132:135], v[144:147]
 buffer_load_dwordx4 v52, s[12:15], s57 offen offset:2048 lds
 v_mfma_f32_16x16x32_bf16 v[148:151], a[116:119], a[132:135], v[148:151]
 ds_read_b64_tr_b16 a[14:15], v57 offset:33792
 v_mfma_f32_16x16x32_bf16 v[152:155], a[120:123], a[132:135], v[152:155]
 ds_read_b64_tr_b16 a[16:17], v58 offset:32768
 v_mfma_f32_16x16x32_bf16 v[156:159], a[124:127], a[132:135], v[156:159]
 ds_read_b64_tr_b16 a[18:19], v58 offset:33792
 s_waitcnt lgkmcnt(7)
 v_mfma_f32_16x16x32_bf16 v[160:163], a[64:67], a[136:139], v[160:163]
 v_mfma_f32_16x16x32_bf16 v[164:167], a[68:71], a[136:139], v[164:167]
 buffer_load_dwordx4 v53, s[12:15], s57 offen offset:3072 lds
 s_add_u32 s55, s55, 524288
 v_mfma_f32_16x16x32_bf16 v[168:171], a[72:75], a[136:139], v[168:171]
 ds_read_b64_tr_b16 a[20:21], v59 offset:32768
 s_and_b32 s55, s55, 1572864
 v_mfma_f32_16x16x32_bf16 v[172:175], a[76:79], a[136:139], v[172:175]
 ds_read_b64_tr_b16 a[22:23], v59 offset:33792
 v_mfma_f32_16x16x32_bf16 v[176:179], a[80:83], a[136:139], v[176:179]
 ds_read_b128 a[128:131], v48 offset:12288
 v_mfma_f32_16x16x32_bf16 v[180:183], a[84:87], a[136:139], v[180:183]
 ds_read_b128 a[132:135], v49 offset:12288
 s_add_u32 s56, s70, s54
 v_mfma_f32_16x16x32_bf16 v[184:187], a[88:91], a[136:139], v[184:187]
 ds_read_b64_tr_b16 a[24:25], v60 offset:32768
 s_add_u32 m0, s66, 8192
 v_mfma_f32_16x16x32_bf16 v[188:191], a[92:95], a[136:139], v[188:191]
 buffer_load_dwordx4 v46, s[8:11], s56 offen offset:0 lds
 v_mfma_f32_16x16x32_bf16 v[160:163], a[96:99], a[140:143], v[160:163]
 ds_read_b64_tr_b16 a[26:27], v60 offset:33792
 v_mfma_f32_16x16x32_bf16 v[164:167], a[100:103], a[140:143], v[164:167]
 ds_read_b64_tr_b16 a[28:29], v61 offset:32768
 v_mfma_f32_16x16x32_bf16 v[168:171], a[104:107], a[140:143], v[168:171]
 ds_read_b64_tr_b16 a[30:31], v61 offset:33792
 v_mfma_f32_16x16x32_bf16 v[172:175], a[108:111], a[140:143], v[172:175]
 v_mfma_f32_16x16x32_bf16 v[176:179], a[112:115], a[140:143], v[176:179]
 buffer_load_dwordx4 v47, s[8:11], s56 offen offset:1024 lds
 v_mfma_f32_16x16x32_bf16 v[180:183], a[116:119], a[140:143], v[180:183]
 ds_read_b64_tr_b16 a[32:33], v54 offset:40960
 v_mfma_f32_16x16x32_bf16 v[184:187], a[120:123], a[140:143], v[184:187]
 ds_read_b64_tr_b16 a[34:35], v54 offset:41984
 v_mfma_f32_16x16x32_bf16 v[188:191], a[124:127], a[140:143], v[188:191]
 ds_read_b64_tr_b16 a[36:37], v55 offset:40960
 s_waitcnt lgkmcnt(7)
 v_mfma_f32_16x16x32_bf16 v[192:195], a[64:67], a[128:131], v[192:195]
 s_add_u32 s56, s71, s54
 v_mfma_f32_16x16x32_bf16 v[196:199], a[68:71], a[128:131], v[196:199]
 ds_read_b64_tr_b16 a[38:39], v55 offset:41984
 s_add_u32 m0, s66, 10240
 v_mfma_f32_16x16x32_bf16 v[200:203], a[72:75], a[128:131], v[200:203]
 buffer_load_dwordx4 v46, s[8:11], s56 offen offset:0 lds
 v_mfma_f32_16x16x32_bf16 v[204:207], a[76:79], a[128:131], v[204:207]
 ds_read_b64_tr_b16 a[40:41], v56 offset:40960
 v_mfma_f32_16x16x32_bf16 v[208:211], a[80:83], a[128:131], v[208:211]
 ds_read_b128 a[136:139], v48 offset:14336
 v_mfma_f32_16x16x32_bf16 v[212:215], a[84:87], a[128:131], v[212:215]
 ds_read_b128 a[140:143], v49 offset:14336
 v_mfma_f32_16x16x32_bf16 v[216:219], a[88:91], a[128:131], v[216:219]
 ds_read_b64_tr_b16 a[42:43], v56 offset:41984
 v_mfma_f32_16x16x32_bf16 v[220:223], a[92:95], a[128:131], v[220:223]
 buffer_load_dwordx4 v47, s[8:11], s56 offen offset:1024 lds
 v_mfma_f32_16x16x32_bf16 v[192:195], a[96:99], a[132:135], v[192:195]
 ds_read_b64_tr_b16 a[44:45], v57 offset:40960
 v_mfma_f32_16x16x32_bf16 v[196:199], a[100:103], a[132:135], v[196:199]
 ds_read_b64_tr_b16 a[46:47], v57 offset:41984
 v_mfma_f32_16x16x32_bf16 v[200:203], a[104:107], a[132:135], v[200:203]
 ds_read_b64_tr_b16 a[48:49], v58 offset:40960
 v_mfma_f32_16x16x32_bf16 v[204:207], a[108:111], a[132:135], v[204:207]
 ds_read_b64_tr_b16 a[50:51], v58 offset:41984
 s_add_u32 s56, s72, s54
 v_mfma_f32_16x16x32_bf16 v[208:211], a[112:115], a[132:135], v[208:211]
 s_add_u32 m0, s66, 12288
 v_mfma_f32_16x16x32_bf16 v[212:215], a[116:119], a[132:135], v[212:215]
 buffer_load_dwordx4 v46, s[8:11], s56 offen offset:0 lds
 v_mfma_f32_16x16x32_bf16 v[216:219], a[120:123], a[132:135], v[216:219]
 ds_read_b64_tr_b16 a[52:53], v59 offset:40960
 v_mfma_f32_16x16x32_bf16 v[220:223], a[124:127], a[132:135], v[220:223]
 ds_read_b64_tr_b16 a[54:55], v59 offset:41984
 s_waitcnt lgkmcnt(7)
 v_mfma_f32_16x16x32_bf16 v[224:227], a[64:67], a[136:139], v[224:227]
 v_mfma_f32_16x16x32_bf16 v[228:231], a[68:71], a[136:139], v[228:231]
 ds_read_b64_tr_b16 a[56:57], v60 offset:40960
 v_mfma_f32_16x16x32_bf16 v[232:235], a[72:75], a[136:139], v[232:235]
 buffer_load_dwordx4 v47, s[8:11], s56 offen offset:1024 lds
 v_mfma_f32_16x16x32_bf16 v[236:239], a[76:79], a[136:139], v[236:239]
 ds_read_b64_tr_b16 a[58:59], v60 offset:41984
 v_mfma_f32_16x16x32_bf16 v[240:243], a[80:83], a[136:139], v[240:243]
 s_waitcnt vmcnt(16)
 ds_read_b128 a[128:131], v48 offset:0
 v_mfma_f32_16x16x32_bf16 v[244:247], a[84:87], a[136:139], v[244:247]
 ds_read_b128 a[132:135], v49 offset:0
 v_mfma_f32_16x16x32_bf16 v[248:251], a[88:91], a[136:139], v[248:251]
 ds_read_b64_tr_b16 a[60:61], v61 offset:40960
 s_add_u32 s56, s73, s54
 v_mfma_f32_16x16x32_bf16 v[252:255], a[92:95], a[136:139], v[252:255]
 ds_read_b64_tr_b16 a[62:63], v61 offset:41984
 s_add_u32 m0, s66, 14336
 v_mfma_f32_16x16x32_bf16 v[224:227], a[96:99], a[140:143], v[224:227]
 buffer_load_dwordx4 v46, s[8:11], s56 offen offset:0 lds
 v_mfma_f32_16x16x32_bf16 v[228:231], a[100:103], a[140:143], v[228:231]
 v_mfma_f32_16x16x32_bf16 v[232:235], a[104:107], a[140:143], v[232:235]
 v_mfma_f32_16x16x32_bf16 v[236:239], a[108:111], a[140:143], v[236:239]
 v_mfma_f32_16x16x32_bf16 v[240:243], a[112:115], a[140:143], v[240:243]
 v_mfma_f32_16x16x32_bf16 v[244:247], a[116:119], a[140:143], v[244:247]
 buffer_load_dwordx4 v47, s[8:11], s56 offen offset:1024 lds
 s_add_u32 s54, s54, 128
 v_mfma_f32_16x16x32_bf16 v[248:251], a[120:123], a[140:143], v[248:251]
 s_and_b32 s54, s54, 384
 v_mfma_f32_16x16x32_bf16 v[252:255], a[124:127], a[140:143], v[252:255]
 s_waitcnt lgkmcnt(0)
 s_barrier
 v_mfma_f32_16x16x32_bf16 v[128:131], a[0:3], a[128:131], v[128:131]
 ds_read_b64_tr_b16 a[64:65], v54 offset:0
 s_add_u32 s57, s53, s55
 v_mfma_f32_16x16x32_bf16 v[132:135], a[4:7], a[128:131], v[132:135]
 ds_read_b64_tr_b16 a[66:67], v54 offset:1024
 s_add_u32 m0, s67, 32768
 v_mfma_f32_16x16x32_bf16 v[136:139], a[8:11], a[128:131], v[136:139]
 buffer_load_dwordx4 v50, s[12:15], s57 offen offset:0 lds
 v_mfma_f32_16x16x32_bf16 v[140:143], a[12:15], a[128:131], v[140:143]
 ds_read_b64_tr_b16 a[68:69], v55 offset:0
 v_mfma_f32_16x16x32_bf16 v[144:147], a[16:19], a[128:131], v[144:147]
 s_waitcnt vmcnt(17)
 ds_read_b128 a[136:139], v48 offset:2048
 v_mfma_f32_16x16x32_bf16 v[148:151], a[20:23], a[128:131], v[148:151]
 ds_read_b128 a[140:143], v49 offset:2048
 v_mfma_f32_16x16x32_bf16 v[152:155], a[24:27], a[128:131], v[152:155]
 ds_read_b64_tr_b16 a[70:71], v55 offset:1024
 v_mfma_f32_16x16x32_bf16 v[156:159], a[28:31], a[128:131], v[156:159]
 buffer_load_dwordx4 v51, s[12:15], s57 offen offset:1024 lds
 v_mfma_f32_16x16x32_bf16 v[128:131], a[32:35], a[132:135], v[128:131]
 ds_read_b64_tr_b16 a[72:73], v56 offset:0
 v_mfma_f32_16x16x32_bf16 v[132:135], a[36:39], a[132:135], v[132:135]
 ds_read_b64_tr_b16 a[74:75], v56 offset:1024
 v_mfma_f32_16x16x32_bf16 v[136:139], a[40:43], a[132:135], v[136:139]
 ds_read_b64_tr_b16 a[76:77], v57 offset:0
 v_mfma_f32_16x16x32_bf16 v[140:143], a[44:47], a[132:135], v[140:143]
 v_mfma_f32_16x16x32_bf16 v[144:147], a[48:51], a[132:135], v[144:147]
 buffer_load_dwordx4 v52, s[12:15], s57 offen offset:2048 lds
 v_mfma_f32_16x16x32_bf16 v[148:151], a[52:55], a[132:135], v[148:151]
 ds_read_b64_tr_b16 a[78:79], v57 offset:1024
 v_mfma_f32_16x16x32_bf16 v[152:155], a[56:59], a[132:135], v[152:155]
 ds_read_b64_tr_b16 a[80:81], v58 offset:0
 v_mfma_f32_16x16x32_bf16 v[156:159], a[60:63], a[132:135], v[156:159]
 ds_read_b64_tr_b16 a[82:83], v58 offset:1024
 s_waitcnt lgkmcnt(7)
 v_mfma_f32_16x16x32_bf16 v[160:163], a[0:3], a[136:139], v[160:163]
 v_mfma_f32_16x16x32_bf16 v[164:167], a[4:7], a[136:139], v[164:167]
 buffer_load_dwordx4 v53, s[12:15], s57 offen offset:3072 lds
 s_add_u32 s55, s55, 524288
 v_mfma_f32_16x16x32_bf16 v[168:171], a[8:11], a[136:139], v[168:171]
 ds_read_b64_tr_b16 a[84:85], v59 offset:0
 s_and_b32 s55, s55, 1572864
 v_mfma_f32_16x16x32_bf16 v[172:175], a[12:15], a[136:139], v[172:175]
 ds_read_b64_tr_b16 a[86:87], v59 offset:1024
 v_mfma_f32_16x16x32_bf16 v[176:179], a[16:19], a[136:139], v[176:179]
 s_waitcnt vmcnt(18)
 ds_read_b128 a[128:131], v48 offset:4096
 s_add_u32 s70, s70, 512
 v_mfma_f32_16x16x32_bf16 v[180:183], a[20:23], a[136:139], v[180:183]
 ds_read_b128 a[132:135], v49 offset:4096
 s_add_u32 s56, s70, s54
 v_mfma_f32_16x16x32_bf16 v[184:187], a[24:27], a[136:139], v[184:187]
 ds_read_b64_tr_b16 a[88:89], v60 offset:0
 s_add_u32 m0, s66, 0
 v_mfma_f32_16x16x32_bf16 v[188:191], a[28:31], a[136:139], v[188:191]
 buffer_load_dwordx4 v46, s[8:11], s56 offen offset:0 lds
 v_mfma_f32_16x16x32_bf16 v[160:163], a[32:35], a[140:143], v[160:163]
 ds_read_b64_tr_b16 a[90:91], v60 offset:1024
 v_mfma_f32_16x16x32_bf16 v[164:167], a[36:39], a[140:143], v[164:167]
 ds_read_b64_tr_b16 a[92:93], v61 offset:0
 v_mfma_f32_16x16x32_bf16 v[168:171], a[40:43], a[140:143], v[168:171]
 ds_read_b64_tr_b16 a[94:95], v61 offset:1024
 v_mfma_f32_16x16x32_bf16 v[172:175], a[44:47], a[140:143], v[172:175]
 v_mfma_f32_16x16x32_bf16 v[176:179], a[48:51], a[140:143], v[176:179]
 buffer_load_dwordx4 v47, s[8:11], s56 offen offset:1024 lds
 v_mfma_f32_16x16x32_bf16 v[180:183], a[52:55], a[140:143], v[180:183]
 ds_read_b64_tr_b16 a[96:97], v54 offset:8192
 v_mfma_f32_16x16x32_bf16 v[184:187], a[56:59], a[140:143], v[184:187]
 ds_read_b64_tr_b16 a[98:99], v54 offset:9216
 v_mfma_f32_16x16x32_bf16 v[188:191], a[60:63], a[140:143], v[188:191]
 ds_read_b64_tr_b16 a[100:101], v55 offset:8192
 s_add_u32 s71, s71, 512
 s_waitcnt lgkmcnt(7)
 v_mfma_f32_16x16x32_bf16 v[192:195], a[0:3], a[128:131], v[192:195]
 s_add_u32 s56, s71, s54
 v_mfma_f32_16x16x32_bf16 v[196:199], a[4:7], a[128:131], v[196:199]
 ds_read_b64_tr_b16 a[102:103], v55 offset:9216
 s_add_u32 m0, s66, 2048
 v_mfma_f32_16x16x32_bf16 v[200:203], a[8:11], a[128:131], v[200:203]
 buffer_load_dwordx4 v46, s[8:11], s56 offen offset:0 lds
 v_mfma_f32_16x16x32_bf16 v[204:207], a[12:15], a[128:131], v[204:207]
 ds_read_b64_tr_b16 a[104:105], v56 offset:8192
 v_mfma_f32_16x16x32_bf16 v[208:211], a[16:19], a[128:131], v[208:211]
 s_waitcnt vmcnt(19)
 ds_read_b128 a[136:139], v48 offset:6144
 v_mfma_f32_16x16x32_bf16 v[212:215], a[20:23], a[128:131], v[212:215]
 ds_read_b128 a[140:143], v49 offset:6144
 v_mfma_f32_16x16x32_bf16 v[216:219], a[24:27], a[128:131], v[216:219]
 ds_read_b64_tr_b16 a[106:107], v56 offset:9216
 v_mfma_f32_16x16x32_bf16 v[220:223], a[28:31], a[128:131], v[220:223]
 buffer_load_dwordx4 v47, s[8:11], s56 offen offset:1024 lds
 v_mfma_f32_16x16x32_bf16 v[192:195], a[32:35], a[132:135], v[192:195]
 ds_read_b64_tr_b16 a[108:109], v57 offset:8192
 v_mfma_f32_16x16x32_bf16 v[196:199], a[36:39], a[132:135], v[196:199]
 ds_read_b64_tr_b16 a[110:111], v57 offset:9216
 v_mfma_f32_16x16x32_bf16 v[200:203], a[40:43], a[132:135], v[200:203]
 ds_read_b64_tr_b16 a[112:113], v58 offset:8192
 s_add_u32 s72, s72, 512
 v_mfma_f32_16x16x32_bf16 v[204:207], a[44:47], a[132:135], v[204:207]
 ds_read_b64_tr_b16 a[114:115], v58 offset:9216
 s_add_u32 s56, s72, s54
 v_mfma_f32_16x16x32_bf16 v[208:211], a[48:51], a[132:135], v[208:211]
 s_add_u32 m0, s66, 4096
 v_mfma_f32_16x16x32_bf16 v[212:215], a[52:55], a[132:135], v[212:215]
 buffer_load_dwordx4 v46, s[8:11], s56 offen offset:0 lds
 v_mfma_f32_16x16x32_bf16 v[216:219], a[56:59], a[132:135], v[216:219]
 ds_read_b64_tr_b16 a[116:117], v59 offset:8192
 v_mfma_f32_16x16x32_bf16 v[220:223], a[60:63], a[132:135], v[220:223]
 ds_read_b64_tr_b16 a[118:119], v59 offset:9216
 s_waitcnt lgkmcnt(7)
 v_mfma_f32_16x16x32_bf16 v[224:227], a[0:3], a[136:139], v[224:227]
 v_mfma_f32_16x16x32_bf16 v[228:231], a[4:7], a[136:139], v[228:231]
 ds_read_b64_tr_b16 a[120:121], v60 offset:8192
 v_mfma_f32_16x16x32_bf16 v[232:235], a[8:11], a[136:139], v[232:235]
 buffer_load_dwordx4 v47, s[8:11], s56 offen offset:1024 lds
 v_mfma_f32_16x16x32_bf16 v[236:239], a[12:15], a[136:139], v[236:239]
 ds_read_b64_tr_b16 a[122:123], v60 offset:9216
 v_mfma_f32_16x16x32_bf16 v[240:243], a[16:19], a[136:139], v[240:243]
 s_waitcnt vmcnt(16)
 ds_read_b128 a[128:131], v48 offset:8192
 v_mfma_f32_16x16x32_bf16 v[244:247], a[20:23], a[136:139], v[244:247]
 ds_read_b128 a[132:135], v49 offset:8192
 s_add_u32 s73, s73, 512
 v_mfma_f32_16x16x32_bf16 v[248:251], a[24:27], a[136:139], v[248:251]
 ds_read_b64_tr_b16 a[124:125], v61 offset:8192
 s_add_u32 s56, s73, s54
 v_mfma_f32_16x16x32_bf16 v[252:255], a[28:31], a[136:139], v[252:255]
 ds_read_b64_tr_b16 a[126:127], v61 offset:9216
 s_add_u32 m0, s66, 6144
 v_mfma_f32_16x16x32_bf16 v[224:227], a[32:35], a[140:143], v[224:227]
 buffer_load_dwordx4 v46, s[8:11], s56 offen offset:0 lds
 v_mfma_f32_16x16x32_bf16 v[228:231], a[36:39], a[140:143], v[228:231]
 v_mfma_f32_16x16x32_bf16 v[232:235], a[40:43], a[140:143], v[232:235]
 v_mfma_f32_16x16x32_bf16 v[236:239], a[44:47], a[140:143], v[236:239]
 v_mfma_f32_16x16x32_bf16 v[240:243], a[48:51], a[140:143], v[240:243]
 v_mfma_f32_16x16x32_bf16 v[244:247], a[52:55], a[140:143], v[244:247]
 buffer_load_dwordx4 v47, s[8:11], s56 offen offset:1024 lds
 s_add_u32 s54, s54, 128
 v_mfma_f32_16x16x32_bf16 v[248:251], a[56:59], a[140:143], v[248:251]
 s_and_b32 s54, s54, 384
 v_mfma_f32_16x16x32_bf16 v[252:255], a[60:63], a[140:143], v[252:255]
 s_waitcnt lgkmcnt(0)
 s_barrier
 v_mfma_f32_16x16x32_bf16 v[128:131], a[64:67], a[128:131], v[128:131]
 ds_read_b64_tr_b16 a[0:1], v54 offset:16384
 s_add_u32 s57, s53, s55
 v_mfma_f32_16x16x32_bf16 v[132:135], a[68:71], a[128:131], v[132:135]
 ds_read_b64_tr_b16 a[2:3], v54 offset:17408
 s_add_u32 m0, s67, 0
 v_mfma_f32_16x16x32_bf16 v[136:139], a[72:75], a[128:131], v[136:139]
 buffer_load_dwordx4 v50, s[12:15], s57 offen offset:0 lds
 v_mfma_f32_16x16x32_bf16 v[140:143], a[76:79], a[128:131], v[140:143]
 ds_read_b64_tr_b16 a[4:5], v55 offset:16384
 v_mfma_f32_16x16x32_bf16 v[144:147], a[80:83], a[128:131], v[144:147]
 s_waitcnt vmcnt(17)
 ds_read_b128 a[136:139], v48 offset:10240
 v_mfma_f32_16x16x32_bf16 v[148:151], a[84:87], a[128:131], v[148:151]
 ds_read_b128 a[140:143], v49 offset:10240
 v_mfma_f32_16x16x32_bf16 v[152:155], a[88:91], a[128:131], v[152:155]
 ds_read_b64_tr_b16 a[6:7], v55 offset:17408
 v_mfma_f32_16x16x32_bf16 v[156:159], a[92:95], a[128:131], v[156:159]
 buffer_load_dwordx4 v51, s[12:15], s57 offen offset:1024 lds
 v_mfma_f32_16x16x32_bf16 v[128:131], a[96:99], a[132:135], v[128:131]
 ds_read_b64_tr_b16 a[8:9], v56 offset:16384
 v_mfma_f32_16x16x32_bf16 v[132:135], a[100:103], a[132:135], v[132:135]
 ds_read_b64_tr_b16 a[10:11], v56 offset:17408
 v_mfma_f32_16x16x32_bf16 v[136:139], a[104:107], a[132:135], v[136:139]
 ds_read_b64_tr_b16 a[12:13], v57 offset:16384
 v_mfma_f32_16x16x32_bf16 v[140:143], a[108:111], a[132:135], v[140:143]
 v_mfma_f32_16x16x32_bf16 v[144:147], a[112:115], a[132:135], v[144:147]
 buffer_load_dwordx4 v52, s[12:15], s57 offen offset:2048 lds
 v_mfma_f32_16x16x32_bf16 v[148:151], a[116:119], a[132:135], v[148:151]
 ds_read_b64_tr_b16 a[14:15], v57 offset:17408
 v_mfma_f32_16x16x32_bf16 v[152:155], a[120:123], a[132:135], v[152:155]
 ds_read_b64_tr_b16 a[16:17], v58 offset:16384
 v_mfma_f32_16x16x32_bf16 v[156:159], a[124:127], a[132:135], v[156:159]
 ds_read_b64_tr_b16 a[18:19], v58 offset:17408
 s_waitcnt lgkmcnt(7)
 v_mfma_f32_16x16x32_bf16 v[160:163], a[64:67], a[136:139], v[160:163]
 v_mfma_f32_16x16x32_bf16 v[164:167], a[68:71], a[136:139], v[164:167]
 buffer_load_dwordx4 v53, s[12:15], s57 offen offset:3072 lds
 s_add_u32 s55, s55, 524288
 s_add_u32 s7, s60, 49152
 v_mfma_f32_16x16x32_bf16 v[168:171], a[72:75], a[136:139], v[168:171]
 ds_read_b64_tr_b16 a[20:21], v59 offset:16384
 s_and_b32 s55, s55, 1572864
 v_mfma_f32_16x16x32_bf16 v[172:175], a[76:79], a[136:139], v[172:175]
 buffer_load_dwordx4 a[192:195], v8, s[16:19], s7 offen offset:0 nt
 v_mfma_f32_16x16x32_bf16 v[176:179], a[80:83], a[136:139], v[176:179]
 s_waitcnt vmcnt(18)
 ds_read_b128 a[128:131], v48 offset:12288
 v_mfma_f32_16x16x32_bf16 v[180:183], a[84:87], a[136:139], v[180:183]
 ds_read_b128 a[132:135], v49 offset:12288
 s_add_u32 s56, s70, s54
 v_mfma_f32_16x16x32_bf16 v[184:187], a[88:91], a[136:139], v[184:187]
 ds_read_b64_tr_b16 a[22:23], v59 offset:17408
 s_add_u32 m0, s66, 8192
 v_mfma_f32_16x16x32_bf16 v[188:191], a[92:95], a[136:139], v[188:191]
 buffer_load_dwordx4 v46, s[8:11], s56 offen offset:0 lds
 v_mfma_f32_16x16x32_bf16 v[160:163], a[96:99], a[140:143], v[160:163]
 ds_read_b64_tr_b16 a[24:25], v60 offset:16384
 v_mfma_f32_16x16x32_bf16 v[164:167], a[100:103], a[140:143], v[164:167]
 ds_read_b64_tr_b16 a[26:27], v60 offset:17408
 v_mfma_f32_16x16x32_bf16 v[168:171], a[104:107], a[140:143], v[168:171]
 ds_read_b64_tr_b16 a[28:29], v61 offset:16384
 v_mfma_f32_16x16x32_bf16 v[172:175], a[108:111], a[140:143], v[172:175]
 ds_read_b64_tr_b16 a[30:31], v61 offset:17408
 v_mfma_f32_16x16x32_bf16 v[176:179], a[112:115], a[140:143], v[176:179]
 buffer_load_dwordx4 v47, s[8:11], s56 offen offset:1024 lds
 v_mfma_f32_16x16x32_bf16 v[180:183], a[116:119], a[140:143], v[180:183]
 ds_read_b64_tr_b16 a[32:33], v54 offset:24576
 v_mfma_f32_16x16x32_bf16 v[184:187], a[120:123], a[140:143], v[184:187]
 buffer_load_dwordx4 a[196:199], v9, s[16:19], s7 offen offset:1024 nt
 v_mfma_f32_16x16x32_bf16 v[188:191], a[124:127], a[140:143], v[188:191]
 ds_read_b64_tr_b16 a[34:35], v54 offset:25600
 s_waitcnt lgkmcnt(7)
 v_mfma_f32_16x16x32_bf16 v[192:195], a[64:67], a[128:131], v[192:195]
 ds_read_b64_tr_b16 a[36:37], v55 offset:24576
 s_add_u32 s56, s71, s54
 v_mfma_f32_16x16x32_bf16 v[196:199], a[68:71], a[128:131], v[196:199]
 ds_read_b64_tr_b16 a[38:39], v55 offset:25600
 s_add_u32 m0, s66, 10240
 v_mfma_f32_16x16x32_bf16 v[200:203], a[72:75], a[128:131], v[200:203]
 buffer_load_dwordx4 v46, s[8:11], s56 offen offset:0 lds
 v_mfma_f32_16x16x32_bf16 v[204:207], a[76:79], a[128:131], v[204:207]
 ds_read_b64_tr_b16 a[40:41], v56 offset:24576
 v_mfma_f32_16x16x32_bf16 v[208:211], a[80:83], a[128:131], v[208:211]
 s_waitcnt vmcnt(19)
 ds_read_b128 a[136:139], v48 offset:14336
 v_mfma_f32_16x16x32_bf16 v[212:215], a[84:87], a[128:131], v[212:215]
 ds_read_b128 a[140:143], v49 offset:14336
 v_mfma_f32_16x16x32_bf16 v[216:219], a[88:91], a[128:131], v[216:219]
 ds_read_b64_tr_b16 a[42:43], v56 offset:25600
 v_mfma_f32_16x16x32_bf16 v[220:223], a[92:95], a[128:131], v[220:223]
 buffer_load_dwordx4 v47, s[8:11], s56 offen offset:1024 lds
 v_mfma_f32_16x16x32_bf16 v[192:195], a[96:99], a[132:135], v[192:195]
 ds_read_b64_tr_b16 a[44:45], v57 offset:24576
 v_mfma_f32_16x16x32_bf16 v[196:199], a[100:103], a[132:135], v[196:199]
 buffer_load_dwordx4 a[200:203], v10, s[16:19], s7 offen offset:2048 nt
 v_mfma_f32_16x16x32_bf16 v[200:203], a[104:107], a[132:135], v[200:203]
 ds_read_b64_tr_b16 a[46:47], v57 offset:25600
 v_mfma_f32_16x16x32_bf16 v[204:207], a[108:111], a[132:135], v[204:207]
 ds_read_b64_tr_b16 a[48:49], v58 offset:24576
 s_add_u32 s56, s72, s54
 v_mfma_f32_16x16x32_bf16 v[208:211], a[112:115], a[132:135], v[208:211]
 ds_read_b64_tr_b16 a[50:51], v58 offset:25600
 s_add_u32 m0, s66, 12288
 v_mfma_f32_16x16x32_bf16 v[212:215], a[116:119], a[132:135], v[212:215]
 buffer_load_dwordx4 v46, s[8:11], s56 offen offset:0 lds
 v_mfma_f32_16x16x32_bf16 v[216:219], a[120:123], a[132:135], v[216:219]
 ds_read_b64_tr_b16 a[52:53], v59 offset:24576
 v_mfma_f32_16x16x32_bf16 v[220:223], a[124:127], a[132:135], v[220:223]
 ds_read_b64_tr_b16 a[54:55], v59 offset:25600
 s_waitcnt lgkmcnt(7)
 v_mfma_f32_16x16x32_bf16 v[224:227], a[64:67], a[136:139], v[224:227]
 v_mfma_f32_16x16x32_bf16 v[228:231], a[68:71], a[136:139], v[228:231]
 ds_read_b64_tr_b16 a[56:57], v60 offset:24576
 v_mfma_f32_16x16x32_bf16 v[232:235], a[72:75], a[136:139], v[232:235]
 buffer_load_dwordx4 v47, s[8:11], s56 offen offset:1024 lds
 v_mfma_f32_16x16x32_bf16 v[236:239], a[76:79], a[136:139], v[236:239]
 ds_read_b64_tr_b16 a[58:59], v60 offset:25600
 v_mfma_f32_16x16x32_bf16 v[240:243], a[80:83], a[136:139], v[240:243]
 buffer_load_dwordx4 a[204:207], v11, s[16:19], s7 offen offset:3072 nt
 v_mfma_f32_16x16x32_bf16 v[244:247], a[84:87], a[136:139], v[244:247]
 s_waitcnt vmcnt(16)
 ds_read_b128 a[128:131], v48 offset:0
 v_mfma_f32_16x16x32_bf16 v[248:251], a[88:91], a[136:139], v[248:251]
 ds_read_b128 a[132:135], v49 offset:0
 s_add_u32 s56, s73, s54
 v_mfma_f32_16x16x32_bf16 v[252:255], a[92:95], a[136:139], v[252:255]
 ds_read_b64_tr_b16 a[60:61], v61 offset:24576
 s_add_u32 m0, s66, 14336
 v_mfma_f32_16x16x32_bf16 v[224:227], a[96:99], a[140:143], v[224:227]
 buffer_load_dwordx4 v46, s[8:11], s56 offen offset:0 lds
 v_mfma_f32_16x16x32_bf16 v[228:231], a[100:103], a[140:143], v[228:231]
 ds_read_b64_tr_b16 a[62:63], v61 offset:25600
 v_mfma_f32_16x16x32_bf16 v[232:235], a[104:107], a[140:143], v[232:235]
 v_mfma_f32_16x16x32_bf16 v[236:239], a[108:111], a[140:143], v[236:239]
 v_mfma_f32_16x16x32_bf16 v[240:243], a[112:115], a[140:143], v[240:243]
 v_mfma_f32_16x16x32_bf16 v[244:247], a[116:119], a[140:143], v[244:247]
 buffer_load_dwordx4 v47, s[8:11], s56 offen offset:1024 lds
 s_add_u32 s54, s54, 128
 v_mfma_f32_16x16x32_bf16 v[248:251], a[120:123], a[140:143], v[248:251]
 s_and_b32 s54, s54, 384
 v_mfma_f32_16x16x32_bf16 v[252:255], a[124:127], a[140:143], v[252:255]
 s_waitcnt lgkmcnt(0)
 s_barrier
 v_mfma_f32_16x16x32_bf16 v[128:131], a[0:3], a[128:131], v[128:131]
 ds_read_b64_tr_b16 a[64:65], v54 offset:32768
 s_add_u32 s57, s53, s55
 v_mfma_f32_16x16x32_bf16 v[132:135], a[4:7], a[128:131], v[132:135]
 ds_read_b64_tr_b16 a[66:67], v54 offset:33792
 s_add_u32 m0, s67, 16384
 v_mfma_f32_16x16x32_bf16 v[136:139], a[8:11], a[128:131], v[136:139]
 buffer_load_dwordx4 v50, s[12:15], s57 offen offset:0 lds
 v_mfma_f32_16x16x32_bf16 v[140:143], a[12:15], a[128:131], v[140:143]
 ds_read_b64_tr_b16 a[68:69], v55 offset:32768
 v_mfma_f32_16x16x32_bf16 v[144:147], a[16:19], a[128:131], v[144:147]
 s_waitcnt vmcnt(17)
 ds_read_b128 a[136:139], v48 offset:2048
 v_mfma_f32_16x16x32_bf16 v[148:151], a[20:23], a[128:131], v[148:151]
 ds_read_b128 a[140:143], v49 offset:2048
 v_mfma_f32_16x16x32_bf16 v[152:155], a[24:27], a[128:131], v[152:155]
 ds_read_b64_tr_b16 a[70:71], v55 offset:33792
 v_mfma_f32_16x16x32_bf16 v[156:159], a[28:31], a[128:131], v[156:159]
 buffer_load_dwordx4 v51, s[12:15], s57 offen offset:1024 lds
 v_mfma_f32_16x16x32_bf16 v[128:131], a[32:35], a[132:135], v[128:131]
 ds_read_b64_tr_b16 a[72:73], v56 offset:32768
 v_mfma_f32_16x16x32_bf16 v[132:135], a[36:39], a[132:135], v[132:135]
 ds_read_b64_tr_b16 a[74:75], v56 offset:33792
 v_mfma_f32_16x16x32_bf16 v[136:139], a[40:43], a[132:135], v[136:139]
 ds_read_b64_tr_b16 a[76:77], v57 offset:32768
 v_mfma_f32_16x16x32_bf16 v[140:143], a[44:47], a[132:135], v[140:143]
 v_mfma_f32_16x16x32_bf16 v[144:147], a[48:51], a[132:135], v[144:147]
 buffer_load_dwordx4 v52, s[12:15], s57 offen offset:2048 lds
 v_mfma_f32_16x16x32_bf16 v[148:151], a[52:55], a[132:135], v[148:151]
 ds_read_b64_tr_b16 a[78:79], v57 offset:33792
 v_mfma_f32_16x16x32_bf16 v[152:155], a[56:59], a[132:135], v[152:155]
 ds_read_b64_tr_b16 a[80:81], v58 offset:32768
 v_mfma_f32_16x16x32_bf16 v[156:159], a[60:63], a[132:135], v[156:159]
 ds_read_b64_tr_b16 a[82:83], v58 offset:33792
 s_waitcnt lgkmcnt(7)
 v_mfma_f32_16x16x32_bf16 v[160:163], a[0:3], a[136:139], v[160:163]
 v_mfma_f32_16x16x32_bf16 v[164:167], a[4:7], a[136:139], v[164:167]
 buffer_load_dwordx4 v53, s[12:15], s57 offen offset:3072 lds
 s_add_u32 s55, s55, 524288
 v_mfma_f32_16x16x32_bf16 v[168:171], a[8:11], a[136:139], v[168:171]
 ds_read_b64_tr_b16 a[84:85], v59 offset:32768
 s_and_b32 s55, s55, 1572864
 v_mfma_f32_16x16x32_bf16 v[172:175], a[12:15], a[136:139], v[172:175]
 ds_read_b64_tr_b16 a[86:87], v59 offset:33792
 v_mfma_f32_16x16x32_bf16 v[176:179], a[16:19], a[136:139], v[176:179]
 s_waitcnt vmcnt(18)
 ds_read_b128 a[128:131], v48 offset:4096
 v_mfma_f32_16x16x32_bf16 v[180:183], a[20:23], a[136:139], v[180:183]
 ds_read_b128 a[132:135], v49 offset:4096
 s_add_u32 s56, s70, s54
 v_mfma_f32_16x16x32_bf16 v[184:187], a[24:27], a[136:139], v[184:187]
 ds_read_b64_tr_b16 a[88:89], v60 offset:32768
 s_add_u32 m0, s66, 0
 v_mfma_f32_16x16x32_bf16 v[188:191], a[28:31], a[136:139], v[188:191]
 buffer_load_dwordx4 v46, s[8:11], s56 offen offset:0 lds
 v_mfma_f32_16x16x32_bf16 v[160:163], a[32:35], a[140:143], v[160:163]
 ds_read_b64_tr_b16 a[90:91], v60 offset:33792
 v_mfma_f32_16x16x32_bf16 v[164:167], a[36:39], a[140:143], v[164:167]
 ds_read_b64_tr_b16 a[92:93], v61 offset:32768
 v_mfma_f32_16x16x32_bf16 v[168:171], a[40:43], a[140:143], v[168:171]
 ds_read_b64_tr_b16 a[94:95], v61 offset:33792
 v_mfma_f32_16x16x32_bf16 v[172:175], a[44:47], a[140:143], v[172:175]
 v_mfma_f32_16x16x32_bf16 v[176:179], a[48:51], a[140:143], v[176:179]
 buffer_load_dwordx4 v47, s[8:11], s56 offen offset:1024 lds
 v_mfma_f32_16x16x32_bf16 v[180:183], a[52:55], a[140:143], v[180:183]
 ds_read_b64_tr_b16 a[96:97], v54 offset:40960
 v_mfma_f32_16x16x32_bf16 v[184:187], a[56:59], a[140:143], v[184:187]
 ds_read_b64_tr_b16 a[98:99], v54 offset:41984
 v_mfma_f32_16x16x32_bf16 v[188:191], a[60:63], a[140:143], v[188:191]
 ds_read_b64_tr_b16 a[100:101], v55 offset:40960
 s_waitcnt lgkmcnt(7)
 v_mfma_f32_16x16x32_bf16 v[192:195], a[0:3], a[128:131], v[192:195]
 s_add_u32 s56, s71, s54
 v_mfma_f32_16x16x32_bf16 v[196:199], a[4:7], a[128:131], v[196:199]
 ds_read_b64_tr_b16 a[102:103], v55 offset:41984
 s_add_u32 m0, s66, 2048
 v_mfma_f32_16x16x32_bf16 v[200:203], a[8:11], a[128:131], v[200:203]
 buffer_load_dwordx4 v46, s[8:11], s56 offen offset:0 lds
 v_mfma_f32_16x16x32_bf16 v[204:207], a[12:15], a[128:131], v[204:207]
 ds_read_b64_tr_b16 a[104:105], v56 offset:40960
 v_mfma_f32_16x16x32_bf16 v[208:211], a[16:19], a[128:131], v[208:211]
 s_waitcnt vmcnt(19)
 ds_read_b128 a[136:139], v48 offset:6144
 v_mfma_f32_16x16x32_bf16 v[212:215], a[20:23], a[128:131], v[212:215]
 ds_read_b128 a[140:143], v49 offset:6144
 v_mfma_f32_16x16x32_bf16 v[216:219], a[24:27], a[128:131], v[216:219]
 ds_read_b64_tr_b16 a[106:107], v56 offset:41984
 v_mfma_f32_16x16x32_bf16 v[220:223], a[28:31], a[128:131], v[220:223]
 buffer_load_dwordx4 v47, s[8:11], s56 offen offset:1024 lds
 v_mfma_f32_16x16x32_bf16 v[192:195], a[32:35], a[132:135], v[192:195]
 ds_read_b64_tr_b16 a[108:109], v57 offset:40960
 v_mfma_f32_16x16x32_bf16 v[196:199], a[36:39], a[132:135], v[196:199]
 ds_read_b64_tr_b16 a[110:111], v57 offset:41984
 v_mfma_f32_16x16x32_bf16 v[200:203], a[40:43], a[132:135], v[200:203]
 ds_read_b64_tr_b16 a[112:113], v58 offset:40960
 v_mfma_f32_16x16x32_bf16 v[204:207], a[44:47], a[132:135], v[204:207]
 ds_read_b64_tr_b16 a[114:115], v58 offset:41984
 s_add_u32 s56, s72, s54
 v_mfma_f32_16x16x32_bf16 v[208:211], a[48:51], a[132:135], v[208:211]
 s_add_u32 m0, s66, 4096
 v_mfma_f32_16x16x32_bf16 v[212:215], a[52:55], a[132:135], v[212:215]
 buffer_load_dwordx4 v46, s[8:11], s56 offen offset:0 lds
 v_mfma_f32_16x16x32_bf16 v[216:219], a[56:59], a[132:135], v[216:219]
 ds_read_b64_tr_b16 a[116:117], v59 offset:40960
 v_mfma_f32_16x16x32_bf16 v[220:223], a[60:63], a[132:135], v[220:223]
 ds_read_b64_tr_b16 a[118:119], v59 offset:41984
 s_waitcnt lgkmcnt(7)
 v_mfma_f32_16x16x32_bf16 v[224:227], a[0:3], a[136:139], v[224:227]
 v_mfma_f32_16x16x32_bf16 v[228:231], a[4:7], a[136:139], v[228:231]
 ds_read_b64_tr_b16 a[120:121], v60 offset:40960
 v_mfma_f32_16x16x32_bf16 v[232:235], a[8:11], a[136:139], v[232:235]
 buffer_load_dwordx4 v47, s[8:11], s56 offen offset:1024 lds
 v_mfma_f32_16x16x32_bf16 v[236:239], a[12:15], a[136:139], v[236:239]
 ds_read_b64_tr_b16 a[122:123], v60 offset:41984
 v_mfma_f32_16x16x32_bf16 v[240:243], a[16:19], a[136:139], v[240:243]
 s_waitcnt vmcnt(16)
 ds_read_b128 a[128:131], v48 offset:8192
 v_mfma_f32_16x16x32_bf16 v[244:247], a[20:23], a[136:139], v[244:247]
 ds_read_b128 a[132:135], v49 offset:8192
 v_mfma_f32_16x16x32_bf16 v[248:251], a[24:27], a[136:139], v[248:251]
 ds_read_b64_tr_b16 a[124:125], v61 offset:40960
 s_add_u32 s56, s73, s54
 v_mfma_f32_16x16x32_bf16 v[252:255], a[28:31], a[136:139], v[252:255]
 ds_read_b64_tr_b16 a[126:127], v61 offset:41984
 s_add_u32 m0, s66, 6144
 v_mfma_f32_16x16x32_bf16 v[224:227], a[32:35], a[140:143], v[224:227]
 buffer_load_dwordx4 v46, s[8:11], s56 offen offset:0 lds
 v_mfma_f32_16x16x32_bf16 v[228:231], a[36:39], a[140:143], v[228:231]
 v_mfma_f32_16x16x32_bf16 v[232:235], a[40:43], a[140:143], v[232:235]
 v_mfma_f32_16x16x32_bf16 v[236:239], a[44:47], a[140:143], v[236:239]
 v_mfma_f32_16x16x32_bf16 v[240:243], a[48:51], a[140:143], v[240:243]
 v_mfma_f32_16x16x32_bf16 v[244:247], a[52:55], a[140:143], v[244:247]
 buffer_load_dwordx4 v47, s[8:11], s56 offen offset:1024 lds
 s_add_u32 s54, s54, 128
 v_mfma_f32_16x16x32_bf16 v[248:251], a[56:59], a[140:143], v[248:251]
 s_and_b32 s54, s54, 384
 v_mfma_f32_16x16x32_bf16 v[252:255], a[60:63], a[140:143], v[252:255]
 s_waitcnt lgkmcnt(0)
 s_barrier
 v_mfma_f32_16x16x32_bf16 v[128:131], a[64:67], a[128:131], v[128:131]
 ds_read_b64_tr_b16 a[0:1], v54 offset:0
 s_add_u32 s53, s53, 2097152
 s_add_u32 s57, s53, s55
 v_mfma_f32_16x16x32_bf16 v[132:135], a[68:71], a[128:131], v[132:135]
 ds_read_b64_tr_b16 a[2:3], v54 offset:1024
 s_add_u32 m0, s67, 32768
 v_mfma_f32_16x16x32_bf16 v[136:139], a[72:75], a[128:131], v[136:139]
 buffer_load_dwordx4 v50, s[12:15], s57 offen offset:0 lds
 v_mfma_f32_16x16x32_bf16 v[140:143], a[76:79], a[128:131], v[140:143]
 ds_read_b64_tr_b16 a[4:5], v55 offset:0
 v_mfma_f32_16x16x32_bf16 v[144:147], a[80:83], a[128:131], v[144:147]
 s_waitcnt vmcnt(17)
 ds_read_b128 a[136:139], v48 offset:10240
 v_mfma_f32_16x16x32_bf16 v[148:151], a[84:87], a[128:131], v[148:151]
 ds_read_b128 a[140:143], v49 offset:10240
 v_mfma_f32_16x16x32_bf16 v[152:155], a[88:91], a[128:131], v[152:155]
 ds_read_b64_tr_b16 a[6:7], v55 offset:1024
 v_mfma_f32_16x16x32_bf16 v[156:159], a[92:95], a[128:131], v[156:159]
 buffer_load_dwordx4 v51, s[12:15], s57 offen offset:1024 lds
 v_mfma_f32_16x16x32_bf16 v[128:131], a[96:99], a[132:135], v[128:131]
 ds_read_b64_tr_b16 a[8:9], v56 offset:0
 v_mfma_f32_16x16x32_bf16 v[132:135], a[100:103], a[132:135], v[132:135]
 ds_read_b64_tr_b16 a[10:11], v56 offset:1024
 v_mfma_f32_16x16x32_bf16 v[136:139], a[104:107], a[132:135], v[136:139]
 ds_read_b64_tr_b16 a[12:13], v57 offset:0
 v_mfma_f32_16x16x32_bf16 v[140:143], a[108:111], a[132:135], v[140:143]
 v_mfma_f32_16x16x32_bf16 v[144:147], a[112:115], a[132:135], v[144:147]
 buffer_load_dwordx4 v52, s[12:15], s57 offen offset:2048 lds
 v_mfma_f32_16x16x32_bf16 v[148:151], a[116:119], a[132:135], v[148:151]
 ds_read_b64_tr_b16 a[14:15], v57 offset:1024
 v_mfma_f32_16x16x32_bf16 v[152:155], a[120:123], a[132:135], v[152:155]
 ds_read_b64_tr_b16 a[16:17], v58 offset:0
 v_mfma_f32_16x16x32_bf16 v[156:159], a[124:127], a[132:135], v[156:159]
 ds_read_b64_tr_b16 a[18:19], v58 offset:1024
 s_waitcnt lgkmcnt(7)
 v_mfma_f32_16x16x32_bf16 v[160:163], a[64:67], a[136:139], v[160:163]
 v_mfma_f32_16x16x32_bf16 v[164:167], a[68:71], a[136:139], v[164:167]
 buffer_load_dwordx4 v53, s[12:15], s57 offen offset:3072 lds
 s_add_u32 s55, s55, 524288
 v_mfma_f32_16x16x32_bf16 v[168:171], a[72:75], a[136:139], v[168:171]
 ds_read_b64_tr_b16 a[20:21], v59 offset:0
 s_and_b32 s55, s55, 1572864
 v_mfma_f32_16x16x32_bf16 v[172:175], a[76:79], a[136:139], v[172:175]
 ds_read_b64_tr_b16 a[22:23], v59 offset:1024
 v_mfma_f32_16x16x32_bf16 v[176:179], a[80:83], a[136:139], v[176:179]
 s_waitcnt vmcnt(18)
 ds_read_b128 a[128:131], v48 offset:12288
 v_mfma_f32_16x16x32_bf16 v[180:183], a[84:87], a[136:139], v[180:183]
 ds_read_b128 a[132:135], v49 offset:12288
 s_add_u32 s56, s70, s54
 v_mfma_f32_16x16x32_bf16 v[184:187], a[88:91], a[136:139], v[184:187]
 ds_read_b64_tr_b16 a[24:25], v60 offset:0
 s_add_u32 m0, s66, 8192
 v_mfma_f32_16x16x32_bf16 v[188:191], a[92:95], a[136:139], v[188:191]
 buffer_load_dwordx4 v46, s[8:11], s56 offen offset:0 lds
 v_mfma_f32_16x16x32_bf16 v[160:163], a[96:99], a[140:143], v[160:163]
 ds_read_b64_tr_b16 a[26:27], v60 offset:1024
 v_mfma_f32_16x16x32_bf16 v[164:167], a[100:103], a[140:143], v[164:167]
 ds_read_b64_tr_b16 a[28:29], v61 offset:0
 v_mfma_f32_16x16x32_bf16 v[168:171], a[104:107], a[140:143], v[168:171]
 ds_read_b64_tr_b16 a[30:31], v61 offset:1024
 v_mfma_f32_16x16x32_bf16 v[172:175], a[108:111], a[140:143], v[172:175]
 v_mfma_f32_16x16x32_bf16 v[176:179], a[112:115], a[140:143], v[176:179]
 buffer_load_dwordx4 v47, s[8:11], s56 offen offset:1024 lds
 v_mfma_f32_16x16x32_bf16 v[180:183], a[116:119], a[140:143], v[180:183]
 ds_read_b64_tr_b16 a[32:33], v54 offset:8192
 v_mfma_f32_16x16x32_bf16 v[184:187], a[120:123], a[140:143], v[184:187]
 ds_read_b64_tr_b16 a[34:35], v54 offset:9216
 v_mfma_f32_16x16x32_bf16 v[188:191], a[124:127], a[140:143], v[188:191]
 ds_read_b64_tr_b16 a[36:37], v55 offset:8192
 s_waitcnt lgkmcnt(7)
 v_mfma_f32_16x16x32_bf16 v[192:195], a[64:67], a[128:131], v[192:195]
 s_add_u32 s56, s71, s54
 v_mfma_f32_16x16x32_bf16 v[196:199], a[68:71], a[128:131], v[196:199]
 ds_read_b64_tr_b16 a[38:39], v55 offset:9216
 s_add_u32 m0, s66, 10240
 v_mfma_f32_16x16x32_bf16 v[200:203], a[72:75], a[128:131], v[200:203]
 buffer_load_dwordx4 v46, s[8:11], s56 offen offset:0 lds
 v_mfma_f32_16x16x32_bf16 v[204:207], a[76:79], a[128:131], v[204:207]
 ds_read_b64_tr_b16 a[40:41], v56 offset:8192
 v_mfma_f32_16x16x32_bf16 v[208:211], a[80:83], a[128:131], v[208:211]
 s_waitcnt vmcnt(19)
 ds_read_b128 a[136:139], v48 offset:14336
 v_mfma_f32_16x16x32_bf16 v[212:215], a[84:87], a[128:131], v[212:215]
 ds_read_b128 a[140:143], v49 offset:14336
 v_mfma_f32_16x16x32_bf16 v[216:219], a[88:91], a[128:131], v[216:219]
 ds_read_b64_tr_b16 a[42:43], v56 offset:9216
 v_mfma_f32_16x16x32_bf16 v[220:223], a[92:95], a[128:131], v[220:223]
 buffer_load_dwordx4 v47, s[8:11], s56 offen offset:1024 lds
 v_mfma_f32_16x16x32_bf16 v[192:195], a[96:99], a[132:135], v[192:195]
 ds_read_b64_tr_b16 a[44:45], v57 offset:8192
 v_mfma_f32_16x16x32_bf16 v[196:199], a[100:103], a[132:135], v[196:199]
 ds_read_b64_tr_b16 a[46:47], v57 offset:9216
 v_mfma_f32_16x16x32_bf16 v[200:203], a[104:107], a[132:135], v[200:203]
 ds_read_b64_tr_b16 a[48:49], v58 offset:8192
 v_mfma_f32_16x16x32_bf16 v[204:207], a[108:111], a[132:135], v[204:207]
 ds_read_b64_tr_b16 a[50:51], v58 offset:9216
 s_add_u32 s56, s72, s54
 v_mfma_f32_16x16x32_bf16 v[208:211], a[112:115], a[132:135], v[208:211]
 s_add_u32 m0, s66, 12288
 v_mfma_f32_16x16x32_bf16 v[212:215], a[116:119], a[132:135], v[212:215]
 buffer_load_dwordx4 v46, s[8:11], s56 offen offset:0 lds
 v_mfma_f32_16x16x32_bf16 v[216:219], a[120:123], a[132:135], v[216:219]
 ds_read_b64_tr_b16 a[52:53], v59 offset:8192
 v_mfma_f32_16x16x32_bf16 v[220:223], a[124:127], a[132:135], v[220:223]
 ds_read_b64_tr_b16 a[54:55], v59 offset:9216
 s_waitcnt lgkmcnt(7)
 v_mfma_f32_16x16x32_bf16 v[224:227], a[64:67], a[136:139], v[224:227]
 v_mfma_f32_16x16x32_bf16 v[228:231], a[68:71], a[136:139], v[228:231]
 ds_read_b64_tr_b16 a[56:57], v60 offset:8192
 v_mfma_f32_16x16x32_bf16 v[232:235], a[72:75], a[136:139], v[232:235]
 buffer_load_dwordx4 v47, s[8:11], s56 offen offset:1024 lds
 v_mfma_f32_16x16x32_bf16 v[236:239], a[76:79], a[136:139], v[236:239]
 ds_read_b64_tr_b16 a[58:59], v60 offset:9216
 v_mfma_f32_16x16x32_bf16 v[240:243], a[80:83], a[136:139], v[240:243]
 s_waitcnt vmcnt(16)
 ds_read_b128 a[128:131], v48 offset:0
 v_mfma_f32_16x16x32_bf16 v[244:247], a[84:87], a[136:139], v[244:247]
 ds_read_b128 a[132:135], v49 offset:0
 v_mfma_f32_16x16x32_bf16 v[248:251], a[88:91], a[136:139], v[248:251]
 ds_read_b64_tr_b16 a[60:61], v61 offset:8192
 s_add_u32 s56, s73, s54
 v_mfma_f32_16x16x32_bf16 v[252:255], a[92:95], a[136:139], v[252:255]
 ds_read_b64_tr_b16 a[62:63], v61 offset:9216
 s_add_u32 m0, s66, 14336
 v_mfma_f32_16x16x32_bf16 v[224:227], a[96:99], a[140:143], v[224:227]
 buffer_load_dwordx4 v46, s[8:11], s56 offen offset:0 lds
 v_mfma_f32_16x16x32_bf16 v[228:231], a[100:103], a[140:143], v[228:231]
 v_mfma_f32_16x16x32_bf16 v[232:235], a[104:107], a[140:143], v[232:235]
 v_mfma_f32_16x16x32_bf16 v[236:239], a[108:111], a[140:143], v[236:239]
 v_mfma_f32_16x16x32_bf16 v[240:243], a[112:115], a[140:143], v[240:243]
 v_mfma_f32_16x16x32_bf16 v[244:247], a[116:119], a[140:143], v[244:247]
 buffer_load_dwordx4 v47, s[8:11], s56 offen offset:1024 lds
 s_add_u32 s54, s54, 128
 v_mfma_f32_16x16x32_bf16 v[248:251], a[120:123], a[140:143], v[248:251]
 s_and_b32 s54, s54, 384
 v_mfma_f32_16x16x32_bf16 v[252:255], a[124:127], a[140:143], v[252:255]
 s_waitcnt lgkmcnt(0)
 s_barrier
 v_mfma_f32_16x16x32_bf16 v[128:131], a[0:3], a[128:131], v[128:131]
 ds_read_b64_tr_b16 a[64:65], v54 offset:16384
 s_add_u32 s57, s53, s55
 v_mfma_f32_16x16x32_bf16 v[132:135], a[4:7], a[128:131], v[132:135]
 ds_read_b64_tr_b16 a[66:67], v54 offset:17408
 s_add_u32 m0, s67, 0
 v_mfma_f32_16x16x32_bf16 v[136:139], a[8:11], a[128:131], v[136:139]
 buffer_load_dwordx4 v50, s[12:15], s57 offen offset:0 lds
 v_mfma_f32_16x16x32_bf16 v[140:143], a[12:15], a[128:131], v[140:143]
 ds_read_b64_tr_b16 a[68:69], v55 offset:16384
 v_mfma_f32_16x16x32_bf16 v[144:147], a[16:19], a[128:131], v[144:147]
 s_waitcnt vmcnt(17)
 ds_read_b128 a[136:139], v48 offset:2048
 v_mfma_f32_16x16x32_bf16 v[148:151], a[20:23], a[128:131], v[148:151]
 ds_read_b128 a[140:143], v49 offset:2048
 v_mfma_f32_16x16x32_bf16 v[152:155], a[24:27], a[128:131], v[152:155]
 ds_read_b64_tr_b16 a[70:71], v55 offset:17408
 v_mfma_f32_16x16x32_bf16 v[156:159], a[28:31], a[128:131], v[156:159]
 buffer_load_dwordx4 v51, s[12:15], s57 offen offset:1024 lds
 v_mfma_f32_16x16x32_bf16 v[128:131], a[32:35], a[132:135], v[128:131]
 ds_read_b64_tr_b16 a[72:73], v56 offset:16384
 v_mfma_f32_16x16x32_bf16 v[132:135], a[36:39], a[132:135], v[132:135]
 ds_read_b64_tr_b16 a[74:75], v56 offset:17408
 v_mfma_f32_16x16x32_bf16 v[136:139], a[40:43], a[132:135], v[136:139]
 ds_read_b64_tr_b16 a[76:77], v57 offset:16384
 v_mfma_f32_16x16x32_bf16 v[140:143], a[44:47], a[132:135], v[140:143]
 v_mfma_f32_16x16x32_bf16 v[144:147], a[48:51], a[132:135], v[144:147]
 buffer_load_dwordx4 v52, s[12:15], s57 offen offset:2048 lds
 v_mfma_f32_16x16x32_bf16 v[148:151], a[52:55], a[132:135], v[148:151]
 ds_read_b64_tr_b16 a[78:79], v57 offset:17408
 v_mfma_f32_16x16x32_bf16 v[152:155], a[56:59], a[132:135], v[152:155]
 ds_read_b64_tr_b16 a[80:81], v58 offset:16384
 v_mfma_f32_16x16x32_bf16 v[156:159], a[60:63], a[132:135], v[156:159]
 ds_read_b64_tr_b16 a[82:83], v58 offset:17408
 s_waitcnt lgkmcnt(7)
 v_mfma_f32_16x16x32_bf16 v[160:163], a[0:3], a[136:139], v[160:163]
 v_mfma_f32_16x16x32_bf16 v[164:167], a[4:7], a[136:139], v[164:167]
 buffer_load_dwordx4 v53, s[12:15], s57 offen offset:3072 lds
 s_add_u32 s55, s55, 524288
 s_add_u32 s7, s60, 65536
 v_mfma_f32_16x16x32_bf16 v[168:171], a[8:11], a[136:139], v[168:171]
 ds_read_b64_tr_b16 a[84:85], v59 offset:16384
 s_and_b32 s55, s55, 1572864
 v_mfma_f32_16x16x32_bf16 v[172:175], a[12:15], a[136:139], v[172:175]
 buffer_load_dwordx4 a[208:211], v8, s[16:19], s7 offen offset:0 nt
 v_mfma_f32_16x16x32_bf16 v[176:179], a[16:19], a[136:139], v[176:179]
 s_waitcnt vmcnt(18)
 ds_read_b128 a[128:131], v48 offset:4096
 s_add_u32 s70, s70, 512
 v_mfma_f32_16x16x32_bf16 v[180:183], a[20:23], a[136:139], v[180:183]
 ds_read_b128 a[132:135], v49 offset:4096
 s_add_u32 s56, s70, s54
 v_mfma_f32_16x16x32_bf16 v[184:187], a[24:27], a[136:139], v[184:187]
 ds_read_b64_tr_b16 a[86:87], v59 offset:17408
 s_add_u32 m0, s66, 0
 v_mfma_f32_16x16x32_bf16 v[188:191], a[28:31], a[136:139], v[188:191]
 buffer_load_dwordx4 v46, s[8:11], s56 offen offset:0 lds
 v_mfma_f32_16x16x32_bf16 v[160:163], a[32:35], a[140:143], v[160:163]
 ds_read_b64_tr_b16 a[88:89], v60 offset:16384
 v_mfma_f32_16x16x32_bf16 v[164:167], a[36:39], a[140:143], v[164:167]
 ds_read_b64_tr_b16 a[90:91], v60 offset:17408
 v_mfma_f32_16x16x32_bf16 v[168:171], a[40:43], a[140:143], v[168:171]
 ds_read_b64_tr_b16 a[92:93], v61 offset:16384
 v_mfma_f32_16x16x32_bf16 v[172:175], a[44:47], a[140:143], v[172:175]
 ds_read_b64_tr_b16 a[94:95], v61 offset:17408
 v_mfma_f32_16x16x32_bf16 v[176:179], a[48:51], a[140:143], v[176:179]
 buffer_load_dwordx4 v47, s[8:11], s56 offen offset:1024 lds
 v_mfma_f32_16x16x32_bf16 v[180:183], a[52:55], a[140:143], v[180:183]
 ds_read_b64_tr_b16 a[96:97], v54 offset:24576
 v_mfma_f32_16x16x32_bf16 v[184:187], a[56:59], a[140:143], v[184:187]
 buffer_load_dwordx4 a[212:215], v9, s[16:19], s7 offen offset:1024 nt
 v_mfma_f32_16x16x32_bf16 v[188:191], a[60:63], a[140:143], v[188:191]
 ds_read_b64_tr_b16 a[98:99], v54 offset:25600
 s_add_u32 s71, s71, 512
 s_waitcnt lgkmcnt(7)
 v_mfma_f32_16x16x32_bf16 v[192:195], a[0:3], a[128:131], v[192:195]
 ds_read_b64_tr_b16 a[100:101], v55 offset:24576
 s_add_u32 s56, s71, s54
 v_mfma_f32_16x16x32_bf16 v[196:199], a[4:7], a[128:131], v[196:199]
 ds_read_b64_tr_b16 a[102:103], v55 offset:25600
 s_add_u32 m0, s66, 2048
 v_mfma_f32_16x16x32_bf16 v[200:203], a[8:11], a[128:131], v[200:203]
 buffer_load_dwordx4 v46, s[8:11], s56 offen offset:0 lds
 v_mfma_f32_16x16x32_bf16 v[204:207], a[12:15], a[128:131], v[204:207]
 ds_read_b64_tr_b16 a[104:105], v56 offset:24576
 v_mfma_f32_16x16x32_bf16 v[208:211], a[16:19], a[128:131], v[208:211]
 s_waitcnt vmcnt(19)
 ds_read_b128 a[136:139], v48 offset:6144
 v_mfma_f32_16x16x32_bf16 v[212:215], a[20:23], a[128:131], v[212:215]
 ds_read_b128 a[140:143], v49 offset:6144
 v_mfma_f32_16x16x32_bf16 v[216:219], a[24:27], a[128:131], v[216:219]
 ds_read_b64_tr_b16 a[106:107], v56 offset:25600
 v_mfma_f32_16x16x32_bf16 v[220:223], a[28:31], a[128:131], v[220:223]
 buffer_load_dwordx4 v47, s[8:11], s56 offen offset:1024 lds
 v_mfma_f32_16x16x32_bf16 v[192:195], a[32:35], a[132:135], v[192:195]
 ds_read_b64_tr_b16 a[108:109], v57 offset:24576
 v_mfma_f32_16x16x32_bf16 v[196:199], a[36:39], a[132:135], v[196:199]
 buffer_load_dwordx4 a[216:219], v10, s[16:19], s7 offen offset:2048 nt
 v_mfma_f32_16x16x32_bf16 v[200:203], a[40:43], a[132:135], v[200:203]
 ds_read_b64_tr_b16 a[110:111], v57 offset:25600
 s_add_u32 s72, s72, 512
 v_mfma_f32_16x16x32_bf16 v[204:207], a[44:47], a[132:135], v[204:207]
 ds_read_b64_tr_b16 a[112:113], v58 offset:24576
 s_add_u32 s56, s72, s54
 v_mfma_f32_16x16x32_bf16 v[208:211], a[48:51], a[132:135], v[208:211]
 ds_read_b64_tr_b16 a[114:115], v58 offset:25600
 s_add_u32 m0, s66, 4096
 v_mfma_f32_16x16x32_bf16 v[212:215], a[52:55], a[132:135], v[212:215]
 buffer_load_dwordx4 v46, s[8:11], s56 offen offset:0 lds
 v_mfma_f32_16x16x32_bf16 v[216:219], a[56:59], a[132:135], v[216:219]
 ds_read_b64_tr_b16 a[116:117], v59 offset:24576
 v_mfma_f32_16x16x32_bf16 v[220:223], a[60:63], a[132:135], v[220:223]
 ds_read_b64_tr_b16 a[118:119], v59 offset:25600
 s_waitcnt lgkmcnt(7)
 v_mfma_f32_16x16x32_bf16 v[224:227], a[0:3], a[136:139], v[224:227]
 v_mfma_f32_16x16x32_bf16 v[228:231], a[4:7], a[136:139], v[228:231]
 ds_read_b64_tr_b16 a[120:121], v60 offset:24576
 v_mfma_f32_16x16x32_bf16 v[232:235], a[8:11], a[136:139], v[232:235]
 buffer_load_dwordx4 v47, s[8:11], s56 offen offset:1024 lds
 v_mfma_f32_16x16x32_bf16 v[236:239], a[12:15], a[136:139], v[236:239]
 ds_read_b64_tr_b16 a[122:123], v60 offset:25600
 v_mfma_f32_16x16x32_bf16 v[240:243], a[16:19], a[136:139], v[240:243]
 buffer_load_dwordx4 a[220:223], v11, s[16:19], s7 offen offset:3072 nt
 v_mfma_f32_16x16x32_bf16 v[244:247], a[20:23], a[136:139], v[244:247]
 s_waitcnt vmcnt(16)
 ds_read_b128 a[128:131], v48 offset:8192
 s_add_u32 s73, s73, 512
 v_mfma_f32_16x16x32_bf16 v[248:251], a[24:27], a[136:139], v[248:251]
 ds_read_b128 a[132:135], v49 offset:8192
 s_add_u32 s56, s73, s54
 v_mfma_f32_16x16x32_bf16 v[252:255], a[28:31], a[136:139], v[252:255]
 ds_read_b64_tr_b16 a[124:125], v61 offset:24576
 s_add_u32 m0, s66, 6144
 v_mfma_f32_16x16x32_bf16 v[224:227], a[32:35], a[140:143], v[224:227]
 buffer_load_dwordx4 v46, s[8:11], s56 offen offset:0 lds
 v_mfma_f32_16x16x32_bf16 v[228:231], a[36:39], a[140:143], v[228:231]
 ds_read_b64_tr_b16 a[126:127], v61 offset:25600
 v_mfma_f32_16x16x32_bf16 v[232:235], a[40:43], a[140:143], v[232:235]
 v_mfma_f32_16x16x32_bf16 v[236:239], a[44:47], a[140:143], v[236:239]
 v_mfma_f32_16x16x32_bf16 v[240:243], a[48:51], a[140:143], v[240:243]
 v_mfma_f32_16x16x32_bf16 v[244:247], a[52:55], a[140:143], v[244:247]
 buffer_load_dwordx4 v47, s[8:11], s56 offen offset:1024 lds
 s_add_u32 s54, s54, 128
 v_mfma_f32_16x16x32_bf16 v[248:251], a[56:59], a[140:143], v[248:251]
 s_and_b32 s54, s54, 384
 v_mfma_f32_16x16x32_bf16 v[252:255], a[60:63], a[140:143], v[252:255]
 s_waitcnt lgkmcnt(0)
 s_barrier
 v_mfma_f32_16x16x32_bf16 v[128:131], a[64:67], a[128:131], v[128:131]
 ds_read_b64_tr_b16 a[0:1], v54 offset:32768
 s_add_u32 s57, s53, s55
 v_mfma_f32_16x16x32_bf16 v[132:135], a[68:71], a[128:131], v[132:135]
 ds_read_b64_tr_b16 a[2:3], v54 offset:33792
 s_add_u32 m0, s67, 16384
 v_mfma_f32_16x16x32_bf16 v[136:139], a[72:75], a[128:131], v[136:139]
 buffer_load_dwordx4 v50, s[12:15], s57 offen offset:0 lds
 v_mfma_f32_16x16x32_bf16 v[140:143], a[76:79], a[128:131], v[140:143]
 ds_read_b64_tr_b16 a[4:5], v55 offset:32768
 v_mfma_f32_16x16x32_bf16 v[144:147], a[80:83], a[128:131], v[144:147]
 s_waitcnt vmcnt(17)
 ds_read_b128 a[136:139], v48 offset:10240
 v_mfma_f32_16x16x32_bf16 v[148:151], a[84:87], a[128:131], v[148:151]
 ds_read_b128 a[140:143], v49 offset:10240
 v_mfma_f32_16x16x32_bf16 v[152:155], a[88:91], a[128:131], v[152:155]
 ds_read_b64_tr_b16 a[6:7], v55 offset:33792
 v_mfma_f32_16x16x32_bf16 v[156:159], a[92:95], a[128:131], v[156:159]
 buffer_load_dwordx4 v51, s[12:15], s57 offen offset:1024 lds
 v_mfma_f32_16x16x32_bf16 v[128:131], a[96:99], a[132:135], v[128:131]
 ds_read_b64_tr_b16 a[8:9], v56 offset:32768
 v_mfma_f32_16x16x32_bf16 v[132:135], a[100:103], a[132:135], v[132:135]
 ds_read_b64_tr_b16 a[10:11], v56 offset:33792
 v_mfma_f32_16x16x32_bf16 v[136:139], a[104:107], a[132:135], v[136:139]
 ds_read_b64_tr_b16 a[12:13], v57 offset:32768
 v_mfma_f32_16x16x32_bf16 v[140:143], a[108:111], a[132:135], v[140:143]
 v_mfma_f32_16x16x32_bf16 v[144:147], a[112:115], a[132:135], v[144:147]
 buffer_load_dwordx4 v52, s[12:15], s57 offen offset:2048 lds
 v_mfma_f32_16x16x32_bf16 v[148:151], a[116:119], a[132:135], v[148:151]
 ds_read_b64_tr_b16 a[14:15], v57 offset:33792
 v_mfma_f32_16x16x32_bf16 v[152:155], a[120:123], a[132:135], v[152:155]
 ds_read_b64_tr_b16 a[16:17], v58 offset:32768
 v_mfma_f32_16x16x32_bf16 v[156:159], a[124:127], a[132:135], v[156:159]
 ds_read_b64_tr_b16 a[18:19], v58 offset:33792
 s_waitcnt lgkmcnt(7)
 v_mfma_f32_16x16x32_bf16 v[160:163], a[64:67], a[136:139], v[160:163]
 v_mfma_f32_16x16x32_bf16 v[164:167], a[68:71], a[136:139], v[164:167]
 buffer_load_dwordx4 v53, s[12:15], s57 offen offset:3072 lds
 s_add_u32 s55, s55, 524288
 v_mfma_f32_16x16x32_bf16 v[168:171], a[72:75], a[136:139], v[168:171]
 ds_read_b64_tr_b16 a[20:21], v59 offset:32768
 s_and_b32 s55, s55, 1572864
 v_mfma_f32_16x16x32_bf16 v[172:175], a[76:79], a[136:139], v[172:175]
 ds_read_b64_tr_b16 a[22:23], v59 offset:33792
 v_mfma_f32_16x16x32_bf16 v[176:179], a[80:83], a[136:139], v[176:179]
 s_waitcnt vmcnt(18)
 ds_read_b128 a[128:131], v48 offset:12288
 v_mfma_f32_16x16x32_bf16 v[180:183], a[84:87], a[136:139], v[180:183]
 ds_read_b128 a[132:135], v49 offset:12288
 s_add_u32 s56, s70, s54
 v_mfma_f32_16x16x32_bf16 v[184:187], a[88:91], a[136:139], v[184:187]
 ds_read_b64_tr_b16 a[24:25], v60 offset:32768
 s_add_u32 m0, s66, 8192
 v_mfma_f32_16x16x32_bf16 v[188:191], a[92:95], a[136:139], v[188:191]
 buffer_load_dwordx4 v46, s[8:11], s56 offen offset:0 lds
 v_mfma_f32_16x16x32_bf16 v[160:163], a[96:99], a[140:143], v[160:163]
 ds_read_b64_tr_b16 a[26:27], v60 offset:33792
 v_mfma_f32_16x16x32_bf16 v[164:167], a[100:103], a[140:143], v[164:167]
 ds_read_b64_tr_b16 a[28:29], v61 offset:32768
 v_mfma_f32_16x16x32_bf16 v[168:171], a[104:107], a[140:143], v[168:171]
 ds_read_b64_tr_b16 a[30:31], v61 offset:33792
 v_mfma_f32_16x16x32_bf16 v[172:175], a[108:111], a[140:143], v[172:175]
 v_mfma_f32_16x16x32_bf16 v[176:179], a[112:115], a[140:143], v[176:179]
 buffer_load_dwordx4 v47, s[8:11], s56 offen offset:1024 lds
 v_mfma_f32_16x16x32_bf16 v[180:183], a[116:119], a[140:143], v[180:183]
 ds_read_b64_tr_b16 a[32:33], v54 offset:40960
 v_mfma_f32_16x16x32_bf16 v[184:187], a[120:123], a[140:143], v[184:187]
 ds_read_b64_tr_b16 a[34:35], v54 offset:41984
 v_mfma_f32_16x16x32_bf16 v[188:191], a[124:127], a[140:143], v[188:191]
 ds_read_b64_tr_b16 a[36:37], v55 offset:40960
 s_waitcnt lgkmcnt(7)
 v_mfma_f32_16x16x32_bf16 v[192:195], a[64:67], a[128:131], v[192:195]
 s_add_u32 s56, s71, s54
 v_mfma_f32_16x16x32_bf16 v[196:199], a[68:71], a[128:131], v[196:199]
 ds_read_b64_tr_b16 a[38:39], v55 offset:41984
 s_add_u32 m0, s66, 10240
 v_mfma_f32_16x16x32_bf16 v[200:203], a[72:75], a[128:131], v[200:203]
 buffer_load_dwordx4 v46, s[8:11], s56 offen offset:0 lds
 v_mfma_f32_16x16x32_bf16 v[204:207], a[76:79], a[128:131], v[204:207]
 ds_read_b64_tr_b16 a[40:41], v56 offset:40960
 v_mfma_f32_16x16x32_bf16 v[208:211], a[80:83], a[128:131], v[208:211]
 s_waitcnt vmcnt(19)
 ds_read_b128 a[136:139], v48 offset:14336
 v_mfma_f32_16x16x32_bf16 v[212:215], a[84:87], a[128:131], v[212:215]
 ds_read_b128 a[140:143], v49 offset:14336
 v_mfma_f32_16x16x32_bf16 v[216:219], a[88:91], a[128:131], v[216:219]
 ds_read_b64_tr_b16 a[42:43], v56 offset:41984
 v_mfma_f32_16x16x32_bf16 v[220:223], a[92:95], a[128:131], v[220:223]
 buffer_load_dwordx4 v47, s[8:11], s56 offen offset:1024 lds
 v_mfma_f32_16x16x32_bf16 v[192:195], a[96:99], a[132:135], v[192:195]
 ds_read_b64_tr_b16 a[44:45], v57 offset:40960
 v_mfma_f32_16x16x32_bf16 v[196:199], a[100:103], a[132:135], v[196:199]
 ds_read_b64_tr_b16 a[46:47], v57 offset:41984
 v_mfma_f32_16x16x32_bf16 v[200:203], a[104:107], a[132:135], v[200:203]
 ds_read_b64_tr_b16 a[48:49], v58 offset:40960
 v_mfma_f32_16x16x32_bf16 v[204:207], a[108:111], a[132:135], v[204:207]
 ds_read_b64_tr_b16 a[50:51], v58 offset:41984
 s_add_u32 s56, s72, s54
 v_mfma_f32_16x16x32_bf16 v[208:211], a[112:115], a[132:135], v[208:211]
 s_add_u32 m0, s66, 12288
 v_mfma_f32_16x16x32_bf16 v[212:215], a[116:119], a[132:135], v[212:215]
 buffer_load_dwordx4 v46, s[8:11], s56 offen offset:0 lds
 v_mfma_f32_16x16x32_bf16 v[216:219], a[120:123], a[132:135], v[216:219]
 ds_read_b64_tr_b16 a[52:53], v59 offset:40960
 v_mfma_f32_16x16x32_bf16 v[220:223], a[124:127], a[132:135], v[220:223]
 ds_read_b64_tr_b16 a[54:55], v59 offset:41984
 s_waitcnt lgkmcnt(7)
 v_mfma_f32_16x16x32_bf16 v[224:227], a[64:67], a[136:139], v[224:227]
 v_mfma_f32_16x16x32_bf16 v[228:231], a[68:71], a[136:139], v[228:231]
 ds_read_b64_tr_b16 a[56:57], v60 offset:40960
 v_mfma_f32_16x16x32_bf16 v[232:235], a[72:75], a[136:139], v[232:235]
 buffer_load_dwordx4 v47, s[8:11], s56 offen offset:1024 lds
 v_mfma_f32_16x16x32_bf16 v[236:239], a[76:79], a[136:139], v[236:239]
 ds_read_b64_tr_b16 a[58:59], v60 offset:41984
 v_mfma_f32_16x16x32_bf16 v[240:243], a[80:83], a[136:139], v[240:243]
 s_waitcnt vmcnt(16)
 ds_read_b128 a[128:131], v48 offset:0
 v_mfma_f32_16x16x32_bf16 v[244:247], a[84:87], a[136:139], v[244:247]
 ds_read_b128 a[132:135], v49 offset:0
 v_mfma_f32_16x16x32_bf16 v[248:251], a[88:91], a[136:139], v[248:251]
 ds_read_b64_tr_b16 a[60:61], v61 offset:40960
 s_add_u32 s56, s73, s54
 v_mfma_f32_16x16x32_bf16 v[252:255], a[92:95], a[136:139], v[252:255]
 ds_read_b64_tr_b16 a[62:63], v61 offset:41984
 s_add_u32 m0, s66, 14336
 v_mfma_f32_16x16x32_bf16 v[224:227], a[96:99], a[140:143], v[224:227]
 buffer_load_dwordx4 v46, s[8:11], s56 offen offset:0 lds
 v_mfma_f32_16x16x32_bf16 v[228:231], a[100:103], a[140:143], v[228:231]
 v_mfma_f32_16x16x32_bf16 v[232:235], a[104:107], a[140:143], v[232:235]
 v_mfma_f32_16x16x32_bf16 v[236:239], a[108:111], a[140:143], v[236:239]
 v_mfma_f32_16x16x32_bf16 v[240:243], a[112:115], a[140:143], v[240:243]
 v_mfma_f32_16x16x32_bf16 v[244:247], a[116:119], a[140:143], v[244:247]
 buffer_load_dwordx4 v47, s[8:11], s56 offen offset:1024 lds
 s_add_u32 s54, s54, 128
 v_mfma_f32_16x16x32_bf16 v[248:251], a[120:123], a[140:143], v[248:251]
 s_and_b32 s54, s54, 384
 v_mfma_f32_16x16x32_bf16 v[252:255], a[124:127], a[140:143], v[252:255]
 s_waitcnt lgkmcnt(0)
 s_barrier
 v_mfma_f32_16x16x32_bf16 v[128:131], a[0:3], a[128:131], v[128:131]
 ds_read_b64_tr_b16 a[64:65], v54 offset:0
 s_add_u32 s57, s53, s55
 v_mfma_f32_16x16x32_bf16 v[132:135], a[4:7], a[128:131], v[132:135]
 ds_read_b64_tr_b16 a[66:67], v54 offset:1024
 s_add_u32 m0, s67, 32768
 v_mfma_f32_16x16x32_bf16 v[136:139], a[8:11], a[128:131], v[136:139]
 buffer_load_dwordx4 v50, s[12:15], s57 offen offset:0 lds
 v_mfma_f32_16x16x32_bf16 v[140:143], a[12:15], a[128:131], v[140:143]
 ds_read_b64_tr_b16 a[68:69], v55 offset:0
 v_mfma_f32_16x16x32_bf16 v[144:147], a[16:19], a[128:131], v[144:147]
 s_waitcnt vmcnt(17)
 ds_read_b128 a[136:139], v48 offset:2048
 v_mfma_f32_16x16x32_bf16 v[148:151], a[20:23], a[128:131], v[148:151]
 ds_read_b128 a[140:143], v49 offset:2048
 v_mfma_f32_16x16x32_bf16 v[152:155], a[24:27], a[128:131], v[152:155]
 ds_read_b64_tr_b16 a[70:71], v55 offset:1024
 v_mfma_f32_16x16x32_bf16 v[156:159], a[28:31], a[128:131], v[156:159]
 buffer_load_dwordx4 v51, s[12:15], s57 offen offset:1024 lds
 v_mfma_f32_16x16x32_bf16 v[128:131], a[32:35], a[132:135], v[128:131]
 ds_read_b64_tr_b16 a[72:73], v56 offset:0
 v_mfma_f32_16x16x32_bf16 v[132:135], a[36:39], a[132:135], v[132:135]
 ds_read_b64_tr_b16 a[74:75], v56 offset:1024
 v_mfma_f32_16x16x32_bf16 v[136:139], a[40:43], a[132:135], v[136:139]
 ds_read_b64_tr_b16 a[76:77], v57 offset:0
 v_mfma_f32_16x16x32_bf16 v[140:143], a[44:47], a[132:135], v[140:143]
 v_mfma_f32_16x16x32_bf16 v[144:147], a[48:51], a[132:135], v[144:147]
 buffer_load_dwordx4 v52, s[12:15], s57 offen offset:2048 lds
 v_mfma_f32_16x16x32_bf16 v[148:151], a[52:55], a[132:135], v[148:151]
 ds_read_b64_tr_b16 a[78:79], v57 offset:1024
 v_mfma_f32_16x16x32_bf16 v[152:155], a[56:59], a[132:135], v[152:155]
 ds_read_b64_tr_b16 a[80:81], v58 offset:0
 v_mfma_f32_16x16x32_bf16 v[156:159], a[60:63], a[132:135], v[156:159]
 ds_read_b64_tr_b16 a[82:83], v58 offset:1024
 s_waitcnt lgkmcnt(7)
 v_mfma_f32_16x16x32_bf16 v[160:163], a[0:3], a[136:139], v[160:163]
 v_mfma_f32_16x16x32_bf16 v[164:167], a[4:7], a[136:139], v[164:167]
 buffer_load_dwordx4 v53, s[12:15], s57 offen offset:3072 lds
 s_add_u32 s55, s55, 524288
 v_mfma_f32_16x16x32_bf16 v[168:171], a[8:11], a[136:139], v[168:171]
 ds_read_b64_tr_b16 a[84:85], v59 offset:0
 s_and_b32 s55, s55, 1572864
 v_mfma_f32_16x16x32_bf16 v[172:175], a[12:15], a[136:139], v[172:175]
 ds_read_b64_tr_b16 a[86:87], v59 offset:1024
 v_mfma_f32_16x16x32_bf16 v[176:179], a[16:19], a[136:139], v[176:179]
 s_waitcnt vmcnt(18)
 ds_read_b128 a[128:131], v48 offset:4096
 v_mfma_f32_16x16x32_bf16 v[180:183], a[20:23], a[136:139], v[180:183]
 ds_read_b128 a[132:135], v49 offset:4096
 s_add_u32 s56, s70, s54
 v_mfma_f32_16x16x32_bf16 v[184:187], a[24:27], a[136:139], v[184:187]
 ds_read_b64_tr_b16 a[88:89], v60 offset:0
 s_add_u32 m0, s66, 0
 v_mfma_f32_16x16x32_bf16 v[188:191], a[28:31], a[136:139], v[188:191]
 buffer_load_dwordx4 v46, s[8:11], s56 offen offset:0 lds
 v_mfma_f32_16x16x32_bf16 v[160:163], a[32:35], a[140:143], v[160:163]
 ds_read_b64_tr_b16 a[90:91], v60 offset:1024
 v_mfma_f32_16x16x32_bf16 v[164:167], a[36:39], a[140:143], v[164:167]
 ds_read_b64_tr_b16 a[92:93], v61 offset:0
 v_mfma_f32_16x16x32_bf16 v[168:171], a[40:43], a[140:143], v[168:171]
 ds_read_b64_tr_b16 a[94:95], v61 offset:1024
 v_mfma_f32_16x16x32_bf16 v[172:175], a[44:47], a[140:143], v[172:175]
 v_mfma_f32_16x16x32_bf16 v[176:179], a[48:51], a[140:143], v[176:179]
 buffer_load_dwordx4 v47, s[8:11], s56 offen offset:1024 lds
 v_mfma_f32_16x16x32_bf16 v[180:183], a[52:55], a[140:143], v[180:183]
 ds_read_b64_tr_b16 a[96:97], v54 offset:8192
 v_mfma_f32_16x16x32_bf16 v[184:187], a[56:59], a[140:143], v[184:187]
 ds_read_b64_tr_b16 a[98:99], v54 offset:9216
 v_mfma_f32_16x16x32_bf16 v[188:191], a[60:63], a[140:143], v[188:191]
 ds_read_b64_tr_b16 a[100:101], v55 offset:8192
 s_waitcnt lgkmcnt(7)
 v_mfma_f32_16x16x32_bf16 v[192:195], a[0:3], a[128:131], v[192:195]
 s_add_u32 s56, s71, s54
 v_mfma_f32_16x16x32_bf16 v[196:199], a[4:7], a[128:131], v[196:199]
 ds_read_b64_tr_b16 a[102:103], v55 offset:9216
 s_add_u32 m0, s66, 2048
 v_mfma_f32_16x16x32_bf16 v[200:203], a[8:11], a[128:131], v[200:203]
 buffer_load_dwordx4 v46, s[8:11], s56 offen offset:0 lds
 v_mfma_f32_16x16x32_bf16 v[204:207], a[12:15], a[128:131], v[204:207]
 ds_read_b64_tr_b16 a[104:105], v56 offset:8192
 v_mfma_f32_16x16x32_bf16 v[208:211], a[16:19], a[128:131], v[208:211]
 s_waitcnt vmcnt(19)
 ds_read_b128 a[136:139], v48 offset:6144
 v_mfma_f32_16x16x32_bf16 v[212:215], a[20:23], a[128:131], v[212:215]
 ds_read_b128 a[140:143], v49 offset:6144
 v_mfma_f32_16x16x32_bf16 v[216:219], a[24:27], a[128:131], v[216:219]
 ds_read_b64_tr_b16 a[106:107], v56 offset:9216
 v_mfma_f32_16x16x32_bf16 v[220:223], a[28:31], a[128:131], v[220:223]
 buffer_load_dwordx4 v47, s[8:11], s56 offen offset:1024 lds
 v_mfma_f32_16x16x32_bf16 v[192:195], a[32:35], a[132:135], v[192:195]
 ds_read_b64_tr_b16 a[108:109], v57 offset:8192
 v_mfma_f32_16x16x32_bf16 v[196:199], a[36:39], a[132:135], v[196:199]
 ds_read_b64_tr_b16 a[110:111], v57 offset:9216
 v_mfma_f32_16x16x32_bf16 v[200:203], a[40:43], a[132:135], v[200:203]
 ds_read_b64_tr_b16 a[112:113], v58 offset:8192
 v_mfma_f32_16x16x32_bf16 v[204:207], a[44:47], a[132:135], v[204:207]
 ds_read_b64_tr_b16 a[114:115], v58 offset:9216
 s_add_u32 s56, s72, s54
 v_mfma_f32_16x16x32_bf16 v[208:211], a[48:51], a[132:135], v[208:211]
 s_add_u32 m0, s66, 4096
 v_mfma_f32_16x16x32_bf16 v[212:215], a[52:55], a[132:135], v[212:215]
 buffer_load_dwordx4 v46, s[8:11], s56 offen offset:0 lds
 v_mfma_f32_16x16x32_bf16 v[216:219], a[56:59], a[132:135], v[216:219]
 ds_read_b64_tr_b16 a[116:117], v59 offset:8192
 v_mfma_f32_16x16x32_bf16 v[220:223], a[60:63], a[132:135], v[220:223]
 ds_read_b64_tr_b16 a[118:119], v59 offset:9216
 s_waitcnt lgkmcnt(7)
 v_mfma_f32_16x16x32_bf16 v[224:227], a[0:3], a[136:139], v[224:227]
 v_mfma_f32_16x16x32_bf16 v[228:231], a[4:7], a[136:139], v[228:231]
 ds_read_b64_tr_b16 a[120:121], v60 offset:8192
 v_mfma_f32_16x16x32_bf16 v[232:235], a[8:11], a[136:139], v[232:235]
 buffer_load_dwordx4 v47, s[8:11], s56 offen offset:1024 lds
 v_mfma_f32_16x16x32_bf16 v[236:239], a[12:15], a[136:139], v[236:239]
 ds_read_b64_tr_b16 a[122:123], v60 offset:9216
 v_mfma_f32_16x16x32_bf16 v[240:243], a[16:19], a[136:139], v[240:243]
 s_waitcnt vmcnt(16)
 ds_read_b128 a[128:131], v48 offset:8192
 v_mfma_f32_16x16x32_bf16 v[244:247], a[20:23], a[136:139], v[244:247]
 ds_read_b128 a[132:135], v49 offset:8192
 v_mfma_f32_16x16x32_bf16 v[248:251], a[24:27], a[136:139], v[248:251]
 ds_read_b64_tr_b16 a[124:125], v61 offset:8192
 s_add_u32 s56, s73, s54
 v_mfma_f32_16x16x32_bf16 v[252:255], a[28:31], a[136:139], v[252:255]
 ds_read_b64_tr_b16 a[126:127], v61 offset:9216
 s_add_u32 m0, s66, 6144
 v_mfma_f32_16x16x32_bf16 v[224:227], a[32:35], a[140:143], v[224:227]
 buffer_load_dwordx4 v46, s[8:11], s56 offen offset:0 lds
 v_mfma_f32_16x16x32_bf16 v[228:231], a[36:39], a[140:143], v[228:231]
 v_mfma_f32_16x16x32_bf16 v[232:235], a[40:43], a[140:143], v[232:235]
 v_mfma_f32_16x16x32_bf16 v[236:239], a[44:47], a[140:143], v[236:239]
 v_mfma_f32_16x16x32_bf16 v[240:243], a[48:51], a[140:143], v[240:243]
 v_mfma_f32_16x16x32_bf16 v[244:247], a[52:55], a[140:143], v[244:247]
 buffer_load_dwordx4 v47, s[8:11], s56 offen offset:1024 lds
 s_add_u32 s54, s54, 128
 v_mfma_f32_16x16x32_bf16 v[248:251], a[56:59], a[140:143], v[248:251]
 s_and_b32 s54, s54, 384
 v_mfma_f32_16x16x32_bf16 v[252:255], a[60:63], a[140:143], v[252:255]
 s_waitcnt lgkmcnt(0)
 s_barrier
 v_mfma_f32_16x16x32_bf16 v[128:131], a[64:67], a[128:131], v[128:131]
 ds_read_b64_tr_b16 a[0:1], v54 offset:16384
 s_add_u32 s53, s53, 2097152
 s_add_u32 s57, s53, s55
 v_mfma_f32_16x16x32_bf16 v[132:135], a[68:71], a[128:131], v[132:135]
 ds_read_b64_tr_b16 a[2:3], v54 offset:17408
 s_add_u32 m0, s67, 0
 v_mfma_f32_16x16x32_bf16 v[136:139], a[72:75], a[128:131], v[136:139]
 buffer_load_dwordx4 v50, s[12:15], s57 offen offset:0 lds
 v_mfma_f32_16x16x32_bf16 v[140:143], a[76:79], a[128:131], v[140:143]
 ds_read_b64_tr_b16 a[4:5], v55 offset:16384
 v_mfma_f32_16x16x32_bf16 v[144:147], a[80:83], a[128:131], v[144:147]
 s_waitcnt vmcnt(17)
 ds_read_b128 a[136:139], v48 offset:10240
 v_mfma_f32_16x16x32_bf16 v[148:151], a[84:87], a[128:131], v[148:151]
 ds_read_b128 a[140:143], v49 offset:10240
 v_mfma_f32_16x16x32_bf16 v[152:155], a[88:91], a[128:131], v[152:155]
 ds_read_b64_tr_b16 a[6:7], v55 offset:17408
 v_mfma_f32_16x16x32_bf16 v[156:159], a[92:95], a[128:131], v[156:159]
 buffer_load_dwordx4 v51, s[12:15], s57 offen offset:1024 lds
 v_mfma_f32_16x16x32_bf16 v[128:131], a[96:99], a[132:135], v[128:131]
 ds_read_b64_tr_b16 a[8:9], v56 offset:16384
 v_mfma_f32_16x16x32_bf16 v[132:135], a[100:103], a[132:135], v[132:135]
 ds_read_b64_tr_b16 a[10:11], v56 offset:17408
 v_mfma_f32_16x16x32_bf16 v[136:139], a[104:107], a[132:135], v[136:139]
 ds_read_b64_tr_b16 a[12:13], v57 offset:16384
 v_mfma_f32_16x16x32_bf16 v[140:143], a[108:111], a[132:135], v[140:143]
 v_mfma_f32_16x16x32_bf16 v[144:147], a[112:115], a[132:135], v[144:147]
 buffer_load_dwordx4 v52, s[12:15], s57 offen offset:2048 lds
 v_mfma_f32_16x16x32_bf16 v[148:151], a[116:119], a[132:135], v[148:151]
 ds_read_b64_tr_b16 a[14:15], v57 offset:17408
 v_mfma_f32_16x16x32_bf16 v[152:155], a[120:123], a[132:135], v[152:155]
 ds_read_b64_tr_b16 a[16:17], v58 offset:16384
 v_mfma_f32_16x16x32_bf16 v[156:159], a[124:127], a[132:135], v[156:159]
 ds_read_b64_tr_b16 a[18:19], v58 offset:17408
 s_waitcnt lgkmcnt(7)
 v_mfma_f32_16x16x32_bf16 v[160:163], a[64:67], a[136:139], v[160:163]
 v_mfma_f32_16x16x32_bf16 v[164:167], a[68:71], a[136:139], v[164:167]
 buffer_load_dwordx4 v53, s[12:15], s57 offen offset:3072 lds
 s_add_u32 s55, s55, 524288
 s_add_u32 s7, s60, 81920
 v_mfma_f32_16x16x32_bf16 v[168:171], a[72:75], a[136:139], v[168:171]
 ds_read_b64_tr_b16 a[20:21], v59 offset:16384
 s_and_b32 s55, s55, 1572864
 v_mfma_f32_16x16x32_bf16 v[172:175], a[76:79], a[136:139], v[172:175]
 buffer_load_dwordx4 a[224:227], v8, s[16:19], s7 offen offset:0 nt
 v_mfma_f32_16x16x32_bf16 v[176:179], a[80:83], a[136:139], v[176:179]
 s_waitcnt vmcnt(18)
 ds_read_b128 a[128:131], v48 offset:12288
 v_mfma_f32_16x16x32_bf16 v[180:183], a[84:87], a[136:139], v[180:183]
 ds_read_b128 a[132:135], v49 offset:12288
 s_add_u32 s56, s70, s54
 v_mfma_f32_16x16x32_bf16 v[184:187], a[88:91], a[136:139], v[184:187]
 ds_read_b64_tr_b16 a[22:23], v59 offset:17408
 s_add_u32 m0, s66, 8192
 v_mfma_f32_16x16x32_bf16 v[188:191], a[92:95], a[136:139], v[188:191]
 buffer_load_dwordx4 v46, s[8:11], s56 offen offset:0 lds
 v_mfma_f32_16x16x32_bf16 v[160:163], a[96:99], a[140:143], v[160:163]
 ds_read_b64_tr_b16 a[24:25], v60 offset:16384
 v_mfma_f32_16x16x32_bf16 v[164:167], a[100:103], a[140:143], v[164:167]
 ds_read_b64_tr_b16 a[26:27], v60 offset:17408
 v_mfma_f32_16x16x32_bf16 v[168:171], a[104:107], a[140:143], v[168:171]
 ds_read_b64_tr_b16 a[28:29], v61 offset:16384
 v_mfma_f32_16x16x32_bf16 v[172:175], a[108:111], a[140:143], v[172:175]
 ds_read_b64_tr_b16 a[30:31], v61 offset:17408
 v_mfma_f32_16x16x32_bf16 v[176:179], a[112:115], a[140:143], v[176:179]
 buffer_load_dwordx4 v47, s[8:11], s56 offen offset:1024 lds
 v_mfma_f32_16x16x32_bf16 v[180:183], a[116:119], a[140:143], v[180:183]
 ds_read_b64_tr_b16 a[32:33], v54 offset:24576
 v_mfma_f32_16x16x32_bf16 v[184:187], a[120:123], a[140:143], v[184:187]
 buffer_load_dwordx4 a[228:231], v9, s[16:19], s7 offen offset:1024 nt
 v_mfma_f32_16x16x32_bf16 v[188:191], a[124:127], a[140:143], v[188:191]
 ds_read_b64_tr_b16 a[34:35], v54 offset:25600
 s_waitcnt lgkmcnt(7)
 v_mfma_f32_16x16x32_bf16 v[192:195], a[64:67], a[128:131], v[192:195]
 ds_read_b64_tr_b16 a[36:37], v55 offset:24576
 s_add_u32 s56, s71, s54
 v_mfma_f32_16x16x32_bf16 v[196:199], a[68:71], a[128:131], v[196:199]
 ds_read_b64_tr_b16 a[38:39], v55 offset:25600
 s_add_u32 m0, s66, 10240
 v_mfma_f32_16x16x32_bf16 v[200:203], a[72:75], a[128:131], v[200:203]
 buffer_load_dwordx4 v46, s[8:11], s56 offen offset:0 lds
 v_mfma_f32_16x16x32_bf16 v[204:207], a[76:79], a[128:131], v[204:207]
 ds_read_b64_tr_b16 a[40:41], v56 offset:24576
 v_mfma_f32_16x16x32_bf16 v[208:211], a[80:83], a[128:131], v[208:211]
 s_waitcnt vmcnt(19)
 ds_read_b128 a[136:139], v48 offset:14336
 v_mfma_f32_16x16x32_bf16 v[212:215], a[84:87], a[128:131], v[212:215]
 ds_read_b128 a[140:143], v49 offset:14336
 v_mfma_f32_16x16x32_bf16 v[216:219], a[88:91], a[128:131], v[216:219]
 ds_read_b64_tr_b16 a[42:43], v56 offset:25600
 v_mfma_f32_16x16x32_bf16 v[220:223], a[92:95], a[128:131], v[220:223]
 buffer_load_dwordx4 v47, s[8:11], s56 offen offset:1024 lds
 v_mfma_f32_16x16x32_bf16 v[192:195], a[96:99], a[132:135], v[192:195]
 ds_read_b64_tr_b16 a[44:45], v57 offset:24576
 v_mfma_f32_16x16x32_bf16 v[196:199], a[100:103], a[132:135], v[196:199]
 buffer_load_dwordx4 a[232:235], v10, s[16:19], s7 offen offset:2048 nt
 v_mfma_f32_16x16x32_bf16 v[200:203], a[104:107], a[132:135], v[200:203]
 ds_read_b64_tr_b16 a[46:47], v57 offset:25600
 v_mfma_f32_16x16x32_bf16 v[204:207], a[108:111], a[132:135], v[204:207]
 ds_read_b64_tr_b16 a[48:49], v58 offset:24576
 s_add_u32 s56, s72, s54
 v_mfma_f32_16x16x32_bf16 v[208:211], a[112:115], a[132:135], v[208:211]
 ds_read_b64_tr_b16 a[50:51], v58 offset:25600
 s_add_u32 m0, s66, 12288
 v_mfma_f32_16x16x32_bf16 v[212:215], a[116:119], a[132:135], v[212:215]
 buffer_load_dwordx4 v46, s[8:11], s56 offen offset:0 lds
 v_mfma_f32_16x16x32_bf16 v[216:219], a[120:123], a[132:135], v[216:219]
 ds_read_b64_tr_b16 a[52:53], v59 offset:24576
 v_mfma_f32_16x16x32_bf16 v[220:223], a[124:127], a[132:135], v[220:223]
 ds_read_b64_tr_b16 a[54:55], v59 offset:25600
 s_waitcnt lgkmcnt(7)
 v_mfma_f32_16x16x32_bf16 v[224:227], a[64:67], a[136:139], v[224:227]
 v_mfma_f32_16x16x32_bf16 v[228:231], a[68:71], a[136:139], v[228:231]
 ds_read_b64_tr_b16 a[56:57], v60 offset:24576
 v_mfma_f32_16x16x32_bf16 v[232:235], a[72:75], a[136:139], v[232:235]
 buffer_load_dwordx4 v47, s[8:11], s56 offen offset:1024 lds
 v_mfma_f32_16x16x32_bf16 v[236:239], a[76:79], a[136:139], v[236:239]
 ds_read_b64_tr_b16 a[58:59], v60 offset:25600
 v_mfma_f32_16x16x32_bf16 v[240:243], a[80:83], a[136:139], v[240:243]
 buffer_load_dwordx4 a[236:239], v11, s[16:19], s7 offen offset:3072 nt
 v_mfma_f32_16x16x32_bf16 v[244:247], a[84:87], a[136:139], v[244:247]
 s_waitcnt vmcnt(16)
 ds_read_b128 a[128:131], v48 offset:0
 v_mfma_f32_16x16x32_bf16 v[248:251], a[88:91], a[136:139], v[248:251]
 ds_read_b128 a[132:135], v49 offset:0
 s_add_u32 s56, s73, s54
 v_mfma_f32_16x16x32_bf16 v[252:255], a[92:95], a[136:139], v[252:255]
 ds_read_b64_tr_b16 a[60:61], v61 offset:24576
 s_add_u32 m0, s66, 14336
 v_mfma_f32_16x16x32_bf16 v[224:227], a[96:99], a[140:143], v[224:227]
 buffer_load_dwordx4 v46, s[8:11], s56 offen offset:0 lds
 v_mfma_f32_16x16x32_bf16 v[228:231], a[100:103], a[140:143], v[228:231]
 ds_read_b64_tr_b16 a[62:63], v61 offset:25600
 v_mfma_f32_16x16x32_bf16 v[232:235], a[104:107], a[140:143], v[232:235]
 v_mfma_f32_16x16x32_bf16 v[236:239], a[108:111], a[140:143], v[236:239]
 v_mfma_f32_16x16x32_bf16 v[240:243], a[112:115], a[140:143], v[240:243]
 v_mfma_f32_16x16x32_bf16 v[244:247], a[116:119], a[140:143], v[244:247]
 buffer_load_dwordx4 v47, s[8:11], s56 offen offset:1024 lds
 s_add_u32 s54, s54, 128
 v_mfma_f32_16x16x32_bf16 v[248:251], a[120:123], a[140:143], v[248:251]
 s_and_b32 s54, s54, 384
 v_mfma_f32_16x16x32_bf16 v[252:255], a[124:127], a[140:143], v[252:255]
 s_waitcnt lgkmcnt(0)
 s_barrier
 v_mfma_f32_16x16x32_bf16 v[128:131], a[0:3], a[128:131], v[128:131]
 ds_read_b64_tr_b16 a[64:65], v54 offset:32768
 s_add_u32 s57, s53, s55
 v_mfma_f32_16x16x32_bf16 v[132:135], a[4:7], a[128:131], v[132:135]
 ds_read_b64_tr_b16 a[66:67], v54 offset:33792
 s_add_u32 m0, s67, 16384
 v_mfma_f32_16x16x32_bf16 v[136:139], a[8:11], a[128:131], v[136:139]
 buffer_load_dwordx4 v50, s[12:15], s57 offen offset:0 lds
 v_mfma_f32_16x16x32_bf16 v[140:143], a[12:15], a[128:131], v[140:143]
 ds_read_b64_tr_b16 a[68:69], v55 offset:32768
 v_mfma_f32_16x16x32_bf16 v[144:147], a[16:19], a[128:131], v[144:147]
 s_waitcnt vmcnt(17)
 ds_read_b128 a[136:139], v48 offset:2048
 v_mfma_f32_16x16x32_bf16 v[148:151], a[20:23], a[128:131], v[148:151]
 ds_read_b128 a[140:143], v49 offset:2048
 v_mfma_f32_16x16x32_bf16 v[152:155], a[24:27], a[128:131], v[152:155]
 ds_read_b64_tr_b16 a[70:71], v55 offset:33792
 v_mfma_f32_16x16x32_bf16 v[156:159], a[28:31], a[128:131], v[156:159]
 buffer_load_dwordx4 v51, s[12:15], s57 offen offset:1024 lds
 v_mfma_f32_16x16x32_bf16 v[128:131], a[32:35], a[132:135], v[128:131]
 ds_read_b64_tr_b16 a[72:73], v56 offset:32768
 v_mfma_f32_16x16x32_bf16 v[132:135], a[36:39], a[132:135], v[132:135]
 ds_read_b64_tr_b16 a[74:75], v56 offset:33792
 v_mfma_f32_16x16x32_bf16 v[136:139], a[40:43], a[132:135], v[136:139]
 ds_read_b64_tr_b16 a[76:77], v57 offset:32768
 v_mfma_f32_16x16x32_bf16 v[140:143], a[44:47], a[132:135], v[140:143]
 v_mfma_f32_16x16x32_bf16 v[144:147], a[48:51], a[132:135], v[144:147]
 buffer_load_dwordx4 v52, s[12:15], s57 offen offset:2048 lds
 v_mfma_f32_16x16x32_bf16 v[148:151], a[52:55], a[132:135], v[148:151]
 ds_read_b64_tr_b16 a[78:79], v57 offset:33792
 v_mfma_f32_16x16x32_bf16 v[152:155], a[56:59], a[132:135], v[152:155]
 ds_read_b64_tr_b16 a[80:81], v58 offset:32768
 v_mfma_f32_16x16x32_bf16 v[156:159], a[60:63], a[132:135], v[156:159]
 ds_read_b64_tr_b16 a[82:83], v58 offset:33792
 s_waitcnt lgkmcnt(7)
 v_mfma_f32_16x16x32_bf16 v[160:163], a[0:3], a[136:139], v[160:163]
 v_mfma_f32_16x16x32_bf16 v[164:167], a[4:7], a[136:139], v[164:167]
 buffer_load_dwordx4 v53, s[12:15], s57 offen offset:3072 lds
 s_add_u32 s55, s55, 524288
 s_add_u32 s59, s60, 0
 v_mfma_f32_16x16x32_bf16 v[168:171], a[8:11], a[136:139], v[168:171]
 ds_read_b64_tr_b16 a[84:85], v59 offset:32768
 s_and_b32 s55, s55, 1572864
 s_add_u32 m0, s65, 0
 v_mfma_f32_16x16x32_bf16 v[172:175], a[12:15], a[136:139], v[172:175]
 buffer_load_dwordx4 v8, s[16:19], s59 offen offset:0 nt lds
 v_mfma_f32_16x16x32_bf16 v[176:179], a[16:19], a[136:139], v[176:179]
 s_waitcnt vmcnt(19)
 ds_read_b128 a[128:131], v48 offset:4096
 s_add_u32 s70, s70, 512
 v_mfma_f32_16x16x32_bf16 v[180:183], a[20:23], a[136:139], v[180:183]
 ds_read_b128 a[132:135], v49 offset:4096
 s_add_u32 s56, s70, s54
 v_mfma_f32_16x16x32_bf16 v[184:187], a[24:27], a[136:139], v[184:187]
 ds_read_b64_tr_b16 a[86:87], v59 offset:33792
 s_add_u32 m0, s66, 0
 v_mfma_f32_16x16x32_bf16 v[188:191], a[28:31], a[136:139], v[188:191]
 buffer_load_dwordx4 v46, s[8:11], s56 offen offset:0 lds
 v_mfma_f32_16x16x32_bf16 v[160:163], a[32:35], a[140:143], v[160:163]
 ds_read_b64_tr_b16 a[88:89], v60 offset:32768
 v_mfma_f32_16x16x32_bf16 v[164:167], a[36:39], a[140:143], v[164:167]
 ds_read_b64_tr_b16 a[90:91], v60 offset:33792
 v_mfma_f32_16x16x32_bf16 v[168:171], a[40:43], a[140:143], v[168:171]
 ds_read_b64_tr_b16 a[92:93], v61 offset:32768
 v_mfma_f32_16x16x32_bf16 v[172:175], a[44:47], a[140:143], v[172:175]
 ds_read_b64_tr_b16 a[94:95], v61 offset:33792
 v_mfma_f32_16x16x32_bf16 v[176:179], a[48:51], a[140:143], v[176:179]
 buffer_load_dwordx4 v47, s[8:11], s56 offen offset:1024 lds
 s_add_u32 s59, s60, 0
 v_mfma_f32_16x16x32_bf16 v[180:183], a[52:55], a[140:143], v[180:183]
 ds_read_b64_tr_b16 a[96:97], v54 offset:40960
 s_add_u32 m0, s65, 0
 v_mfma_f32_16x16x32_bf16 v[184:187], a[56:59], a[140:143], v[184:187]
 buffer_load_dwordx4 v9, s[16:19], s59 offen offset:1024 nt lds
 v_mfma_f32_16x16x32_bf16 v[188:191], a[60:63], a[140:143], v[188:191]
 ds_read_b64_tr_b16 a[98:99], v54 offset:41984
 s_add_u32 s71, s71, 512
 s_waitcnt lgkmcnt(7)
 v_mfma_f32_16x16x32_bf16 v[192:195], a[0:3], a[128:131], v[192:195]
 ds_read_b64_tr_b16 a[100:101], v55 offset:40960
 s_add_u32 s56, s71, s54
 v_mfma_f32_16x16x32_bf16 v[196:199], a[4:7], a[128:131], v[196:199]
 ds_read_b64_tr_b16 a[102:103], v55 offset:41984
 s_add_u32 m0, s66, 2048
 v_mfma_f32_16x16x32_bf16 v[200:203], a[8:11], a[128:131], v[200:203]
 buffer_load_dwordx4 v46, s[8:11], s56 offen offset:0 lds
 v_mfma_f32_16x16x32_bf16 v[204:207], a[12:15], a[128:131], v[204:207]
 ds_read_b64_tr_b16 a[104:105], v56 offset:40960
 v_mfma_f32_16x16x32_bf16 v[208:211], a[16:19], a[128:131], v[208:211]
 s_waitcnt vmcnt(21)
 ds_read_b128 a[136:139], v48 offset:6144
 v_mfma_f32_16x16x32_bf16 v[212:215], a[20:23], a[128:131], v[212:215]
 ds_read_b128 a[140:143], v49 offset:6144
 v_mfma_f32_16x16x32_bf16 v[216:219], a[24:27], a[128:131], v[216:219]
 ds_read_b64_tr_b16 a[106:107], v56 offset:41984
 v_mfma_f32_16x16x32_bf16 v[220:223], a[28:31], a[128:131], v[220:223]
 buffer_load_dwordx4 v47, s[8:11], s56 offen offset:1024 lds
 s_add_u32 s59, s60, 0
 v_mfma_f32_16x16x32_bf16 v[192:195], a[32:35], a[132:135], v[192:195]
 ds_read_b64_tr_b16 a[108:109], v57 offset:40960
 s_add_u32 m0, s65, 0
 v_mfma_f32_16x16x32_bf16 v[196:199], a[36:39], a[132:135], v[196:199]
 buffer_load_dwordx4 v10, s[16:19], s59 offen offset:2048 nt lds
 v_mfma_f32_16x16x32_bf16 v[200:203], a[40:43], a[132:135], v[200:203]
 ds_read_b64_tr_b16 a[110:111], v57 offset:41984
 s_add_u32 s72, s72, 512
 v_mfma_f32_16x16x32_bf16 v[204:207], a[44:47], a[132:135], v[204:207]
 ds_read_b64_tr_b16 a[112:113], v58 offset:40960
 s_add_u32 s56, s72, s54
 v_mfma_f32_16x16x32_bf16 v[208:211], a[48:51], a[132:135], v[208:211]
 ds_read_b64_tr_b16 a[114:115], v58 offset:41984
 s_add_u32 m0, s66, 4096
 v_mfma_f32_16x16x32_bf16 v[212:215], a[52:55], a[132:135], v[212:215]
 buffer_load_dwordx4 v46, s[8:11], s56 offen offset:0 lds
 v_mfma_f32_16x16x32_bf16 v[216:219], a[56:59], a[132:135], v[216:219]
 ds_read_b64_tr_b16 a[116:117], v59 offset:40960
 v_mfma_f32_16x16x32_bf16 v[220:223], a[60:63], a[132:135], v[220:223]
 ds_read_b64_tr_b16 a[118:119], v59 offset:41984
 s_waitcnt lgkmcnt(7)
 v_mfma_f32_16x16x32_bf16 v[224:227], a[0:3], a[136:139], v[224:227]
 v_mfma_f32_16x16x32_bf16 v[228:231], a[4:7], a[136:139], v[228:231]
 ds_read_b64_tr_b16 a[120:121], v60 offset:40960
 v_mfma_f32_16x16x32_bf16 v[232:235], a[8:11], a[136:139], v[232:235]
 buffer_load_dwordx4 v47, s[8:11], s56 offen offset:1024 lds
 s_add_u32 s59, s60, 0
 v_mfma_f32_16x16x32_bf16 v[236:239], a[12:15], a[136:139], v[236:239]
 ds_read_b64_tr_b16 a[122:123], v60 offset:41984
 s_add_u32 m0, s65, 0
 v_mfma_f32_16x16x32_bf16 v[240:243], a[16:19], a[136:139], v[240:243]
 buffer_load_dwordx4 v11, s[16:19], s59 offen offset:3072 nt lds
 v_mfma_f32_16x16x32_bf16 v[244:247], a[20:23], a[136:139], v[244:247]
 s_waitcnt vmcnt(20)
 ds_read_b128 a[128:131], v48 offset:8192
 s_add_u32 s73, s73, 512
 v_mfma_f32_16x16x32_bf16 v[248:251], a[24:27], a[136:139], v[248:251]
 ds_read_b128 a[132:135], v49 offset:8192
 s_add_u32 s56, s73, s54
 v_mfma_f32_16x16x32_bf16 v[252:255], a[28:31], a[136:139], v[252:255]
 ds_read_b64_tr_b16 a[124:125], v61 offset:40960
 s_add_u32 m0, s66, 6144
 v_mfma_f32_16x16x32_bf16 v[224:227], a[32:35], a[140:143], v[224:227]
 buffer_load_dwordx4 v46, s[8:11], s56 offen offset:0 lds
 v_mfma_f32_16x16x32_bf16 v[228:231], a[36:39], a[140:143], v[228:231]
 ds_read_b64_tr_b16 a[126:127], v61 offset:41984
 v_mfma_f32_16x16x32_bf16 v[232:235], a[40:43], a[140:143], v[232:235]
 v_mfma_f32_16x16x32_bf16 v[236:239], a[44:47], a[140:143], v[236:239]
 v_mfma_f32_16x16x32_bf16 v[240:243], a[48:51], a[140:143], v[240:243]
 v_mfma_f32_16x16x32_bf16 v[244:247], a[52:55], a[140:143], v[244:247]
 buffer_load_dwordx4 v47, s[8:11], s56 offen offset:1024 lds
 s_add_u32 s54, s54, 128
 v_mfma_f32_16x16x32_bf16 v[248:251], a[56:59], a[140:143], v[248:251]
 s_and_b32 s54, s54, 384
 v_mfma_f32_16x16x32_bf16 v[252:255], a[60:63], a[140:143], v[252:255]
 s_waitcnt lgkmcnt(0)
 s_barrier
 v_mfma_f32_16x16x32_bf16 v[128:131], a[64:67], a[128:131], v[128:131]
 ds_read_b64_tr_b16 a[0:1], v54 offset:0
 s_add_u32 s57, s53, s55
 v_mfma_f32_16x16x32_bf16 v[132:135], a[68:71], a[128:131], v[132:135]
 ds_read_b64_tr_b16 a[2:3], v54 offset:1024
 s_add_u32 m0, s67, 32768
 v_mfma_f32_16x16x32_bf16 v[136:139], a[72:75], a[128:131], v[136:139]
 buffer_load_dwordx4 v50, s[12:15], s57 offen offset:0 lds
 v_mfma_f32_16x16x32_bf16 v[140:143], a[76:79], a[128:131], v[140:143]
 ds_read_b64_tr_b16 a[4:5], v55 offset:0
 v_mfma_f32_16x16x32_bf16 v[144:147], a[80:83], a[128:131], v[144:147]
 s_waitcnt vmcnt(21)
 ds_read_b128 a[136:139], v48 offset:10240
 v_mfma_f32_16x16x32_bf16 v[148:151], a[84:87], a[128:131], v[148:151]
 ds_read_b128 a[140:143], v49 offset:10240
 v_mfma_f32_16x16x32_bf16 v[152:155], a[88:91], a[128:131], v[152:155]
 ds_read_b64_tr_b16 a[6:7], v55 offset:1024
 v_mfma_f32_16x16x32_bf16 v[156:159], a[92:95], a[128:131], v[156:159]
 buffer_load_dwordx4 v51, s[12:15], s57 offen offset:1024 lds
 v_mfma_f32_16x16x32_bf16 v[128:131], a[96:99], a[132:135], v[128:131]
 ds_read_b64_tr_b16 a[8:9], v56 offset:0
 v_mfma_f32_16x16x32_bf16 v[132:135], a[100:103], a[132:135], v[132:135]
 ds_read_b64_tr_b16 a[10:11], v56 offset:1024
 v_mfma_f32_16x16x32_bf16 v[136:139], a[104:107], a[132:135], v[136:139]
 ds_read_b64_tr_b16 a[12:13], v57 offset:0
 v_mfma_f32_16x16x32_bf16 v[140:143], a[108:111], a[132:135], v[140:143]
 v_mfma_f32_16x16x32_bf16 v[144:147], a[112:115], a[132:135], v[144:147]
 buffer_load_dwordx4 v52, s[12:15], s57 offen offset:2048 lds
 v_mfma_f32_16x16x32_bf16 v[148:151], a[116:119], a[132:135], v[148:151]
 ds_read_b64_tr_b16 a[14:15], v57 offset:1024
 v_mfma_f32_16x16x32_bf16 v[152:155], a[120:123], a[132:135], v[152:155]
 ds_read_b64_tr_b16 a[16:17], v58 offset:0
 v_mfma_f32_16x16x32_bf16 v[156:159], a[124:127], a[132:135], v[156:159]
 ds_read_b64_tr_b16 a[18:19], v58 offset:1024
 s_waitcnt lgkmcnt(7)
 v_mfma_f32_16x16x32_bf16 v[160:163], a[64:67], a[136:139], v[160:163]
 v_mfma_f32_16x16x32_bf16 v[164:167], a[68:71], a[136:139], v[164:167]
 buffer_load_dwordx4 v53, s[12:15], s57 offen offset:3072 lds
 s_add_u32 s55, s55, 524288
 v_mfma_f32_16x16x32_bf16 v[168:171], a[72:75], a[136:139], v[168:171]
 ds_read_b64_tr_b16 a[20:21], v59 offset:0
 s_and_b32 s55, s55, 1572864
 v_mfma_f32_16x16x32_bf16 v[172:175], a[76:79], a[136:139], v[172:175]
 ds_read_b64_tr_b16 a[22:23], v59 offset:1024
 v_mfma_f32_16x16x32_bf16 v[176:179], a[80:83], a[136:139], v[176:179]
 s_waitcnt vmcnt(22)
 ds_read_b128 a[128:131], v48 offset:12288
 v_mfma_f32_16x16x32_bf16 v[180:183], a[84:87], a[136:139], v[180:183]
 ds_read_b128 a[132:135], v49 offset:12288
 s_add_u32 s56, s70, s54
 v_mfma_f32_16x16x32_bf16 v[184:187], a[88:91], a[136:139], v[184:187]
 ds_read_b64_tr_b16 a[24:25], v60 offset:0
 s_add_u32 m0, s66, 8192
 v_mfma_f32_16x16x32_bf16 v[188:191], a[92:95], a[136:139], v[188:191]
 buffer_load_dwordx4 v46, s[8:11], s56 offen offset:0 lds
 v_mfma_f32_16x16x32_bf16 v[160:163], a[96:99], a[140:143], v[160:163]
 ds_read_b64_tr_b16 a[26:27], v60 offset:1024
 v_mfma_f32_16x16x32_bf16 v[164:167], a[100:103], a[140:143], v[164:167]
 ds_read_b64_tr_b16 a[28:29], v61 offset:0
 v_mfma_f32_16x16x32_bf16 v[168:171], a[104:107], a[140:143], v[168:171]
 ds_read_b64_tr_b16 a[30:31], v61 offset:1024
 v_mfma_f32_16x16x32_bf16 v[172:175], a[108:111], a[140:143], v[172:175]
 v_mfma_f32_16x16x32_bf16 v[176:179], a[112:115], a[140:143], v[176:179]
 buffer_load_dwordx4 v47, s[8:11], s56 offen offset:1024 lds
 v_mfma_f32_16x16x32_bf16 v[180:183], a[116:119], a[140:143], v[180:183]
 ds_read_b64_tr_b16 a[32:33], v54 offset:8192
 v_mfma_f32_16x16x32_bf16 v[184:187], a[120:123], a[140:143], v[184:187]
 ds_read_b64_tr_b16 a[34:35], v54 offset:9216
 v_mfma_f32_16x16x32_bf16 v[188:191], a[124:127], a[140:143], v[188:191]
 ds_read_b64_tr_b16 a[36:37], v55 offset:8192
 s_waitcnt lgkmcnt(7)
 v_mfma_f32_16x16x32_bf16 v[192:195], a[64:67], a[128:131], v[192:195]
 s_add_u32 s56, s71, s54
 v_mfma_f32_16x16x32_bf16 v[196:199], a[68:71], a[128:131], v[196:199]
 ds_read_b64_tr_b16 a[38:39], v55 offset:9216
 s_add_u32 m0, s66, 10240
 v_mfma_f32_16x16x32_bf16 v[200:203], a[72:75], a[128:131], v[200:203]
 buffer_load_dwordx4 v46, s[8:11], s56 offen offset:0 lds
 v_mfma_f32_16x16x32_bf16 v[204:207], a[76:79], a[128:131], v[204:207]
 ds_read_b64_tr_b16 a[40:41], v56 offset:8192
 v_mfma_f32_16x16x32_bf16 v[208:211], a[80:83], a[128:131], v[208:211]
 s_waitcnt vmcnt(23)
 ds_read_b128 a[136:139], v48 offset:14336
 v_mfma_f32_16x16x32_bf16 v[212:215], a[84:87], a[128:131], v[212:215]
 ds_read_b128 a[140:143], v49 offset:14336
 v_mfma_f32_16x16x32_bf16 v[216:219], a[88:91], a[128:131], v[216:219]
 ds_read_b64_tr_b16 a[42:43], v56 offset:9216
 v_mfma_f32_16x16x32_bf16 v[220:223], a[92:95], a[128:131], v[220:223]
 buffer_load_dwordx4 v47, s[8:11], s56 offen offset:1024 lds
 v_mfma_f32_16x16x32_bf16 v[192:195], a[96:99], a[132:135], v[192:195]
 ds_read_b64_tr_b16 a[44:45], v57 offset:8192
 v_mfma_f32_16x16x32_bf16 v[196:199], a[100:103], a[132:135], v[196:199]
 ds_read_b64_tr_b16 a[46:47], v57 offset:9216
 v_mfma_f32_16x16x32_bf16 v[200:203], a[104:107], a[132:135], v[200:203]
 ds_read_b64_tr_b16 a[48:49], v58 offset:8192
 v_mfma_f32_16x16x32_bf16 v[204:207], a[108:111], a[132:135], v[204:207]
 ds_read_b64_tr_b16 a[50:51], v58 offset:9216
 s_add_u32 s56, s72, s54
 v_mfma_f32_16x16x32_bf16 v[208:211], a[112:115], a[132:135], v[208:211]
 s_add_u32 m0, s66, 12288
 v_mfma_f32_16x16x32_bf16 v[212:215], a[116:119], a[132:135], v[212:215]
 buffer_load_dwordx4 v46, s[8:11], s56 offen offset:0 lds
 v_mfma_f32_16x16x32_bf16 v[216:219], a[120:123], a[132:135], v[216:219]
 ds_read_b64_tr_b16 a[52:53], v59 offset:8192
 v_mfma_f32_16x16x32_bf16 v[220:223], a[124:127], a[132:135], v[220:223]
 ds_read_b64_tr_b16 a[54:55], v59 offset:9216
 s_waitcnt lgkmcnt(7)
 v_mfma_f32_16x16x32_bf16 v[224:227], a[64:67], a[136:139], v[224:227]
 v_mfma_f32_16x16x32_bf16 v[228:231], a[68:71], a[136:139], v[228:231]
 ds_read_b64_tr_b16 a[56:57], v60 offset:8192
 v_mfma_f32_16x16x32_bf16 v[232:235], a[72:75], a[136:139], v[232:235]
 buffer_load_dwordx4 v47, s[8:11], s56 offen offset:1024 lds
 v_mfma_f32_16x16x32_bf16 v[236:239], a[76:79], a[136:139], v[236:239]
 ds_read_b64_tr_b16 a[58:59], v60 offset:9216
 v_mfma_f32_16x16x32_bf16 v[240:243], a[80:83], a[136:139], v[240:243]
 s_waitcnt vmcnt(19)
 ds_read_b128 a[128:131], v48 offset:0
 v_mfma_f32_16x16x32_bf16 v[244:247], a[84:87], a[136:139], v[244:247]
 ds_read_b128 a[132:135], v49 offset:0
 v_mfma_f32_16x16x32_bf16 v[248:251], a[88:91], a[136:139], v[248:251]
 ds_read_b64_tr_b16 a[60:61], v61 offset:8192
 s_add_u32 s56, s73, s54
 v_mfma_f32_16x16x32_bf16 v[252:255], a[92:95], a[136:139], v[252:255]
 ds_read_b64_tr_b16 a[62:63], v61 offset:9216
 s_add_u32 m0, s66, 14336
 v_mfma_f32_16x16x32_bf16 v[224:227], a[96:99], a[140:143], v[224:227]
 buffer_load_dwordx4 v46, s[8:11], s56 offen offset:0 lds
 v_mfma_f32_16x16x32_bf16 v[228:231], a[100:103], a[140:143], v[228:231]
 v_mfma_f32_16x16x32_bf16 v[232:235], a[104:107], a[140:143], v[232:235]
 v_mfma_f32_16x16x32_bf16 v[236:239], a[108:111], a[140:143], v[236:239]
 v_mfma_f32_16x16x32_bf16 v[240:243], a[112:115], a[140:143], v[240:243]
 v_mfma_f32_16x16x32_bf16 v[244:247], a[116:119], a[140:143], v[244:247]
 buffer_load_dwordx4 v47, s[8:11], s56 offen offset:1024 lds
 s_add_u32 s54, s54, 128
 v_mfma_f32_16x16x32_bf16 v[248:251], a[120:123], a[140:143], v[248:251]
 s_and_b32 s54, s54, 384
 v_mfma_f32_16x16x32_bf16 v[252:255], a[124:127], a[140:143], v[252:255]
 s_waitcnt lgkmcnt(0)
 s_barrier
 v_mfma_f32_16x16x32_bf16 v[128:131], a[0:3], a[128:131], v[128:131]
 ds_read_b64_tr_b16 a[64:65], v54 offset:16384
 s_add_u32 s57, s53, s55
 v_mfma_f32_16x16x32_bf16 v[132:135], a[4:7], a[128:131], v[132:135]
 ds_read_b64_tr_b16 a[66:67], v54 offset:17408
 s_add_u32 m0, s67, 0
 v_mfma_f32_16x16x32_bf16 v[136:139], a[8:11], a[128:131], v[136:139]
 buffer_load_dwordx4 v50, s[12:15], s57 offen offset:0 lds
 v_mfma_f32_16x16x32_bf16 v[140:143], a[12:15], a[128:131], v[140:143]
 ds_read_b64_tr_b16 a[68:69], v55 offset:16384
 v_mfma_f32_16x16x32_bf16 v[144:147], a[16:19], a[128:131], v[144:147]
 s_waitcnt vmcnt(19)
 ds_read_b128 a[136:139], v48 offset:2048
 v_mfma_f32_16x16x32_bf16 v[148:151], a[20:23], a[128:131], v[148:151]
 ds_read_b128 a[140:143], v49 offset:2048
 v_mfma_f32_16x16x32_bf16 v[152:155], a[24:27], a[128:131], v[152:155]
 ds_read_b64_tr_b16 a[70:71], v55 offset:17408
 v_mfma_f32_16x16x32_bf16 v[156:159], a[28:31], a[128:131], v[156:159]
 buffer_load_dwordx4 v51, s[12:15], s57 offen offset:1024 lds
 v_mfma_f32_16x16x32_bf16 v[128:131], a[32:35], a[132:135], v[128:131]
 ds_read_b64_tr_b16 a[72:73], v56 offset:16384
 v_mfma_f32_16x16x32_bf16 v[132:135], a[36:39], a[132:135], v[132:135]
 ds_read_b64_tr_b16 a[74:75], v56 offset:17408
 v_mfma_f32_16x16x32_bf16 v[136:139], a[40:43], a[132:135], v[136:139]
 ds_read_b64_tr_b16 a[76:77], v57 offset:16384
 v_mfma_f32_16x16x32_bf16 v[140:143], a[44:47], a[132:135], v[140:143]
 v_mfma_f32_16x16x32_bf16 v[144:147], a[48:51], a[132:135], v[144:147]
 buffer_load_dwordx4 v52, s[12:15], s57 offen offset:2048 lds
 v_mfma_f32_16x16x32_bf16 v[148:151], a[52:55], a[132:135], v[148:151]
 ds_read_b64_tr_b16 a[78:79], v57 offset:17408
 v_mfma_f32_16x16x32_bf16 v[152:155], a[56:59], a[132:135], v[152:155]
 ds_read_b64_tr_b16 a[80:81], v58 offset:16384
 v_mfma_f32_16x16x32_bf16 v[156:159], a[60:63], a[132:135], v[156:159]
 ds_read_b64_tr_b16 a[82:83], v58 offset:17408
 s_waitcnt lgkmcnt(7)
 v_mfma_f32_16x16x32_bf16 v[160:163], a[0:3], a[136:139], v[160:163]
 v_mfma_f32_16x16x32_bf16 v[164:167], a[4:7], a[136:139], v[164:167]
 buffer_load_dwordx4 v53, s[12:15], s57 offen offset:3072 lds
 s_add_u32 s55, s55, 524288
 s_add_u32 s59, s60, 16384
 v_mfma_f32_16x16x32_bf16 v[168:171], a[8:11], a[136:139], v[168:171]
 ds_read_b64_tr_b16 a[84:85], v59 offset:16384
 s_and_b32 s55, s55, 1572864
 s_add_u32 m0, s65, 16384
 v_mfma_f32_16x16x32_bf16 v[172:175], a[12:15], a[136:139], v[172:175]
 buffer_load_dwordx4 v8, s[16:19], s59 offen offset:0 nt lds
 v_mfma_f32_16x16x32_bf16 v[176:179], a[16:19], a[136:139], v[176:179]
 s_waitcnt vmcnt(20)
 ds_read_b128 a[128:131], v48 offset:4096
 v_mfma_f32_16x16x32_bf16 v[180:183], a[20:23], a[136:139], v[180:183]
 ds_read_b128 a[132:135], v49 offset:4096
 s_add_u32 s56, s70, s54
 v_mfma_f32_16x16x32_bf16 v[184:187], a[24:27], a[136:139], v[184:187]
 ds_read_b64_tr_b16 a[86:87], v59 offset:17408
 s_add_u32 m0, s66, 0
 v_mfma_f32_16x16x32_bf16 v[188:191], a[28:31], a[136:139], v[188:191]
 buffer_load_dwordx4 v46, s[8:11], s56 offen offset:0 lds
 v_mfma_f32_16x16x32_bf16 v[160:163], a[32:35], a[140:143], v[160:163]
 ds_read_b64_tr_b16 a[88:89], v60 offset:16384
 v_mfma_f32_16x16x32_bf16 v[164:167], a[36:39], a[140:143], v[164:167]
 ds_read_b64_tr_b16 a[90:91], v60 offset:17408
 v_mfma_f32_16x16x32_bf16 v[168:171], a[40:43], a[140:143], v[168:171]
 ds_read_b64_tr_b16 a[92:93], v61 offset:16384
 v_mfma_f32_16x16x32_bf16 v[172:175], a[44:47], a[140:143], v[172:175]
 ds_read_b64_tr_b16 a[94:95], v61 offset:17408
 v_mfma_f32_16x16x32_bf16 v[176:179], a[48:51], a[140:143], v[176:179]
 buffer_load_dwordx4 v47, s[8:11], s56 offen offset:1024 lds
 s_add_u32 s59, s60, 16384
 v_mfma_f32_16x16x32_bf16 v[180:183], a[52:55], a[140:143], v[180:183]
 ds_read_b64_tr_b16 a[96:97], v54 offset:24576
 s_add_u32 m0, s65, 16384
 v_mfma_f32_16x16x32_bf16 v[184:187], a[56:59], a[140:143], v[184:187]
 buffer_load_dwordx4 v9, s[16:19], s59 offen offset:1024 nt lds
 v_mfma_f32_16x16x32_bf16 v[188:191], a[60:63], a[140:143], v[188:191]
 ds_read_b64_tr_b16 a[98:99], v54 offset:25600
 s_waitcnt lgkmcnt(7)
 v_mfma_f32_16x16x32_bf16 v[192:195], a[0:3], a[128:131], v[192:195]
 ds_read_b64_tr_b16 a[100:101], v55 offset:24576
 s_add_u32 s56, s71, s54
 v_mfma_f32_16x16x32_bf16 v[196:199], a[4:7], a[128:131], v[196:199]
 ds_read_b64_tr_b16 a[102:103], v55 offset:25600
 s_add_u32 m0, s66, 2048
 v_mfma_f32_16x16x32_bf16 v[200:203], a[8:11], a[128:131], v[200:203]
 buffer_load_dwordx4 v46, s[8:11], s56 offen offset:0 lds
 v_mfma_f32_16x16x32_bf16 v[204:207], a[12:15], a[128:131], v[204:207]
 ds_read_b64_tr_b16 a[104:105], v56 offset:24576
 v_mfma_f32_16x16x32_bf16 v[208:211], a[16:19], a[128:131], v[208:211]
 s_waitcnt vmcnt(21)
 ds_read_b128 a[136:139], v48 offset:6144
 v_mfma_f32_16x16x32_bf16 v[212:215], a[20:23], a[128:131], v[212:215]
 ds_read_b128 a[140:143], v49 offset:6144
 v_mfma_f32_16x16x32_bf16 v[216:219], a[24:27], a[128:131], v[216:219]
 ds_read_b64_tr_b16 a[106:107], v56 offset:25600
 v_mfma_f32_16x16x32_bf16 v[220:223], a[28:31], a[128:131], v[220:223]
 buffer_load_dwordx4 v47, s[8:11], s56 offen offset:1024 lds
 s_add_u32 s59, s60, 16384
 v_mfma_f32_16x16x32_bf16 v[192:195], a[32:35], a[132:135], v[192:195]
 ds_read_b64_tr_b16 a[108:109], v57 offset:24576
 s_add_u32 m0, s65, 16384
 v_mfma_f32_16x16x32_bf16 v[196:199], a[36:39], a[132:135], v[196:199]
 buffer_load_dwordx4 v10, s[16:19], s59 offen offset:2048 nt lds
 v_mfma_f32_16x16x32_bf16 v[200:203], a[40:43], a[132:135], v[200:203]
 ds_read_b64_tr_b16 a[110:111], v57 offset:25600
 v_mfma_f32_16x16x32_bf16 v[204:207], a[44:47], a[132:135], v[204:207]
 ds_read_b64_tr_b16 a[112:113], v58 offset:24576
 s_add_u32 s56, s72, s54
 v_mfma_f32_16x16x32_bf16 v[208:211], a[48:51], a[132:135], v[208:211]
 ds_read_b64_tr_b16 a[114:115], v58 offset:25600
 s_add_u32 m0, s66, 4096
 v_mfma_f32_16x16x32_bf16 v[212:215], a[52:55], a[132:135], v[212:215]
 buffer_load_dwordx4 v46, s[8:11], s56 offen offset:0 lds
 v_mfma_f32_16x16x32_bf16 v[216:219], a[56:59], a[132:135], v[216:219]
 ds_read_b64_tr_b16 a[116:117], v59 offset:24576
 v_mfma_f32_16x16x32_bf16 v[220:223], a[60:63], a[132:135], v[220:223]
 ds_read_b64_tr_b16 a[118:119], v59 offset:25600
 s_waitcnt lgkmcnt(7)
 v_mfma_f32_16x16x32_bf16 v[224:227], a[0:3], a[136:139], v[224:227]
 v_mfma_f32_16x16x32_bf16 v[228:231], a[4:7], a[136:139], v[228:231]
 ds_read_b64_tr_b16 a[120:121], v60 offset:24576
 v_mfma_f32_16x16x32_bf16 v[232:235], a[8:11], a[136:139], v[232:235]
 buffer_load_dwordx4 v47, s[8:11], s56 offen offset:1024 lds
 s_add_u32 s59, s60, 16384
 v_mfma_f32_16x16x32_bf16 v[236:239], a[12:15], a[136:139], v[236:239]
 ds_read_b64_tr_b16 a[122:123], v60 offset:25600
 s_add_u32 m0, s65, 16384
 v_mfma_f32_16x16x32_bf16 v[240:243], a[16:19], a[136:139], v[240:243]
 buffer_load_dwordx4 v11, s[16:19], s59 offen offset:3072 nt lds
 v_mfma_f32_16x16x32_bf16 v[244:247], a[20:23], a[136:139], v[244:247]
 s_waitcnt vmcnt(20)
 ds_read_b128 a[128:131], v48 offset:8192
 v_mfma_f32_16x16x32_bf16 v[248:251], a[24:27], a[136:139], v[248:251]
 ds_read_b128 a[132:135], v49 offset:8192
 s_add_u32 s56, s73, s54
 v_mfma_f32_16x16x32_bf16 v[252:255], a[28:31], a[136:139], v[252:255]
 ds_read_b64_tr_b16 a[124:125], v61 offset:24576
 s_add_u32 m0, s66, 6144
 v_mfma_f32_16x16x32_bf16 v[224:227], a[32:35], a[140:143], v[224:227]
 buffer_load_dwordx4 v46, s[8:11], s56 offen offset:0 lds
 v_mfma_f32_16x16x32_bf16 v[228:231], a[36:39], a[140:143], v[228:231]
 ds_read_b64_tr_b16 a[126:127], v61 offset:25600
 v_mfma_f32_16x16x32_bf16 v[232:235], a[40:43], a[140:143], v[232:235]
 v_mfma_f32_16x16x32_bf16 v[236:239], a[44:47], a[140:143], v[236:239]
 v_mfma_f32_16x16x32_bf16 v[240:243], a[48:51], a[140:143], v[240:243]
 v_mfma_f32_16x16x32_bf16 v[244:247], a[52:55], a[140:143], v[244:247]
 buffer_load_dwordx4 v47, s[8:11], s56 offen offset:1024 lds
 s_add_u32 s54, s54, 128
 v_mfma_f32_16x16x32_bf16 v[248:251], a[56:59], a[140:143], v[248:251]
 s_and_b32 s54, s54, 384
 v_mfma_f32_16x16x32_bf16 v[252:255], a[60:63], a[140:143], v[252:255]
 s_waitcnt lgkmcnt(0)
 s_barrier
 v_mfma_f32_16x16x32_bf16 v[128:131], a[64:67], a[128:131], v[128:131]
 ds_read_b64_tr_b16 a[0:1], v54 offset:32768
 v_mfma_f32_16x16x32_bf16 v[132:135], a[68:71], a[128:131], v[132:135]
 ds_read_b64_tr_b16 a[2:3], v54 offset:33792
 v_mfma_f32_16x16x32_bf16 v[136:139], a[72:75], a[128:131], v[136:139]
 v_mfma_f32_16x16x32_bf16 v[140:143], a[76:79], a[128:131], v[140:143]
 ds_read_b64_tr_b16 a[4:5], v55 offset:32768
 v_mfma_f32_16x16x32_bf16 v[144:147], a[80:83], a[128:131], v[144:147]
 s_waitcnt vmcnt(20)
 ds_read_b128 a[136:139], v48 offset:10240
 v_mfma_f32_16x16x32_bf16 v[148:151], a[84:87], a[128:131], v[148:151]
 ds_read_b128 a[140:143], v49 offset:10240
 v_mfma_f32_16x16x32_bf16 v[152:155], a[88:91], a[128:131], v[152:155]
 ds_read_b64_tr_b16 a[6:7], v55 offset:33792
 v_mfma_f32_16x16x32_bf16 v[156:159], a[92:95], a[128:131], v[156:159]
 ds_read_b64_tr_b16 a[8:9], v56 offset:32768
 v_mfma_f32_16x16x32_bf16 v[128:131], a[96:99], a[132:135], v[128:131]
 ds_read_b64_tr_b16 a[10:11], v56 offset:33792
 v_mfma_f32_16x16x32_bf16 v[132:135], a[100:103], a[132:135], v[132:135]
 v_mfma_f32_16x16x32_bf16 v[136:139], a[104:107], a[132:135], v[136:139]
 ds_read_b64_tr_b16 a[12:13], v57 offset:32768
 v_mfma_f32_16x16x32_bf16 v[140:143], a[108:111], a[132:135], v[140:143]
 v_mfma_f32_16x16x32_bf16 v[144:147], a[112:115], a[132:135], v[144:147]
 ds_read_b64_tr_b16 a[14:15], v57 offset:33792
 v_mfma_f32_16x16x32_bf16 v[148:151], a[116:119], a[132:135], v[148:151]
 v_mfma_f32_16x16x32_bf16 v[152:155], a[120:123], a[132:135], v[152:155]
 ds_read_b64_tr_b16 a[16:17], v58 offset:32768
 v_mfma_f32_16x16x32_bf16 v[156:159], a[124:127], a[132:135], v[156:159]
 ds_read_b64_tr_b16 a[18:19], v58 offset:33792
 s_waitcnt lgkmcnt(7)
 v_mfma_f32_16x16x32_bf16 v[160:163], a[64:67], a[136:139], v[160:163]
 v_mfma_f32_16x16x32_bf16 v[164:167], a[68:71], a[136:139], v[164:167]
 ds_read_b64_tr_b16 a[20:21], v59 offset:32768
 s_add_u32 s7, s60, 98304
 v_mfma_f32_16x16x32_bf16 v[168:171], a[72:75], a[136:139], v[168:171]
 v_mfma_f32_16x16x32_bf16 v[172:175], a[76:79], a[136:139], v[172:175]
 buffer_load_dwordx4 a[240:243], v8, s[16:19], s7 offen offset:0 nt
 v_mfma_f32_16x16x32_bf16 v[176:179], a[80:83], a[136:139], v[176:179]
 s_waitcnt vmcnt(18)
 ds_read_b128 a[128:131], v48 offset:12288
 v_mfma_f32_16x16x32_bf16 v[180:183], a[84:87], a[136:139], v[180:183]
 ds_read_b128 a[132:135], v49 offset:12288
 s_add_u32 s56, s70, s54
 v_mfma_f32_16x16x32_bf16 v[184:187], a[88:91], a[136:139], v[184:187]
 ds_read_b64_tr_b16 a[22:23], v59 offset:33792
 s_add_u32 m0, s66, 8192
 v_mfma_f32_16x16x32_bf16 v[188:191], a[92:95], a[136:139], v[188:191]
 buffer_load_dwordx4 v46, s[8:11], s56 offen offset:0 lds
 v_mfma_f32_16x16x32_bf16 v[160:163], a[96:99], a[140:143], v[160:163]
 ds_read_b64_tr_b16 a[24:25], v60 offset:32768
 v_mfma_f32_16x16x32_bf16 v[164:167], a[100:103], a[140:143], v[164:167]
 ds_read_b64_tr_b16 a[26:27], v60 offset:33792
 v_mfma_f32_16x16x32_bf16 v[168:171], a[104:107], a[140:143], v[168:171]
 ds_read_b64_tr_b16 a[28:29], v61 offset:32768
 v_mfma_f32_16x16x32_bf16 v[172:175], a[108:111], a[140:143], v[172:175]
 ds_read_b64_tr_b16 a[30:31], v61 offset:33792
 v_mfma_f32_16x16x32_bf16 v[176:179], a[112:115], a[140:143], v[176:179]
 buffer_load_dwordx4 v47, s[8:11], s56 offen offset:1024 lds
 v_mfma_f32_16x16x32_bf16 v[180:183], a[116:119], a[140:143], v[180:183]
 ds_read_b64_tr_b16 a[32:33], v54 offset:40960
 v_mfma_f32_16x16x32_bf16 v[184:187], a[120:123], a[140:143], v[184:187]
 buffer_load_dwordx4 a[244:247], v9, s[16:19], s7 offen offset:1024 nt
 v_mfma_f32_16x16x32_bf16 v[188:191], a[124:127], a[140:143], v[188:191]
 ds_read_b64_tr_b16 a[34:35], v54 offset:41984
 s_waitcnt lgkmcnt(7)
 v_mfma_f32_16x16x32_bf16 v[192:195], a[64:67], a[128:131], v[192:195]
 ds_read_b64_tr_b16 a[36:37], v55 offset:40960
 s_add_u32 s56, s71, s54
 v_mfma_f32_16x16x32_bf16 v[196:199], a[68:71], a[128:131], v[196:199]
 ds_read_b64_tr_b16 a[38:39], v55 offset:41984
 s_add_u32 m0, s66, 10240
 v_mfma_f32_16x16x32_bf16 v[200:203], a[72:75], a[128:131], v[200:203]
 buffer_load_dwordx4 v46, s[8:11], s56 offen offset:0 lds
 v_mfma_f32_16x16x32_bf16 v[204:207], a[76:79], a[128:131], v[204:207]
 ds_read_b64_tr_b16 a[40:41], v56 offset:40960
 v_mfma_f32_16x16x32_bf16 v[208:211], a[80:83], a[128:131], v[208:211]
 s_waitcnt vmcnt(19)
 ds_read_b128 a[136:139], v48 offset:14336
 v_mfma_f32_16x16x32_bf16 v[212:215], a[84:87], a[128:131], v[212:215]
 ds_read_b128 a[140:143], v49 offset:14336
 v_mfma_f32_16x16x32_bf16 v[216:219], a[88:91], a[128:131], v[216:219]
 ds_read_b64_tr_b16 a[42:43], v56 offset:41984
 v_mfma_f32_16x16x32_bf16 v[220:223], a[92:95], a[128:131], v[220:223]
 buffer_load_dwordx4 v47, s[8:11], s56 offen offset:1024 lds
 v_mfma_f32_16x16x32_bf16 v[192:195], a[96:99], a[132:135], v[192:195]
 ds_read_b64_tr_b16 a[44:45], v57 offset:40960
 v_mfma_f32_16x16x32_bf16 v[196:199], a[100:103], a[132:135], v[196:199]
 buffer_load_dwordx4 a[248:251], v10, s[16:19], s7 offen offset:2048 nt
 v_mfma_f32_16x16x32_bf16 v[200:203], a[104:107], a[132:135], v[200:203]
 ds_read_b64_tr_b16 a[46:47], v57 offset:41984
 v_mfma_f32_16x16x32_bf16 v[204:207], a[108:111], a[132:135], v[204:207]
 ds_read_b64_tr_b16 a[48:49], v58 offset:40960
 s_add_u32 s56, s72, s54
 v_mfma_f32_16x16x32_bf16 v[208:211], a[112:115], a[132:135], v[208:211]
 ds_read_b64_tr_b16 a[50:51], v58 offset:41984
 s_add_u32 m0, s66, 12288
 v_mfma_f32_16x16x32_bf16 v[212:215], a[116:119], a[132:135], v[212:215]
 buffer_load_dwordx4 v46, s[8:11], s56 offen offset:0 lds
 v_mfma_f32_16x16x32_bf16 v[216:219], a[120:123], a[132:135], v[216:219]
 ds_read_b64_tr_b16 a[52:53], v59 offset:40960
 v_mfma_f32_16x16x32_bf16 v[220:223], a[124:127], a[132:135], v[220:223]
 ds_read_b64_tr_b16 a[54:55], v59 offset:41984
 s_waitcnt lgkmcnt(7)
 v_mfma_f32_16x16x32_bf16 v[224:227], a[64:67], a[136:139], v[224:227]
 v_mfma_f32_16x16x32_bf16 v[228:231], a[68:71], a[136:139], v[228:231]
 ds_read_b64_tr_b16 a[56:57], v60 offset:40960
 v_mfma_f32_16x16x32_bf16 v[232:235], a[72:75], a[136:139], v[232:235]
 buffer_load_dwordx4 v47, s[8:11], s56 offen offset:1024 lds
 v_mfma_f32_16x16x32_bf16 v[236:239], a[76:79], a[136:139], v[236:239]
 ds_read_b64_tr_b16 a[58:59], v60 offset:41984
 v_mfma_f32_16x16x32_bf16 v[240:243], a[80:83], a[136:139], v[240:243]
 buffer_load_dwordx4 a[252:255], v11, s[16:19], s7 offen offset:3072 nt
 v_mfma_f32_16x16x32_bf16 v[244:247], a[84:87], a[136:139], v[244:247]
 s_waitcnt vmcnt(15)
 ds_read_b128 a[128:131], v48 offset:0
 v_mfma_f32_16x16x32_bf16 v[248:251], a[88:91], a[136:139], v[248:251]
 ds_read_b128 a[132:135], v49 offset:0
 s_add_u32 s56, s73, s54
 v_mfma_f32_16x16x32_bf16 v[252:255], a[92:95], a[136:139], v[252:255]
 ds_read_b64_tr_b16 a[60:61], v61 offset:40960
 s_add_u32 m0, s66, 14336
 v_mfma_f32_16x16x32_bf16 v[224:227], a[96:99], a[140:143], v[224:227]
 buffer_load_dwordx4 v46, s[8:11], s56 offen offset:0 lds
 v_mfma_f32_16x16x32_bf16 v[228:231], a[100:103], a[140:143], v[228:231]
 ds_read_b64_tr_b16 a[62:63], v61 offset:41984
 v_mfma_f32_16x16x32_bf16 v[232:235], a[104:107], a[140:143], v[232:235]
 v_mfma_f32_16x16x32_bf16 v[236:239], a[108:111], a[140:143], v[236:239]
 v_mfma_f32_16x16x32_bf16 v[240:243], a[112:115], a[140:143], v[240:243]
 v_mfma_f32_16x16x32_bf16 v[244:247], a[116:119], a[140:143], v[244:247]
 buffer_load_dwordx4 v47, s[8:11], s56 offen offset:1024 lds
 s_add_u32 s54, s54, 128
 v_mfma_f32_16x16x32_bf16 v[248:251], a[120:123], a[140:143], v[248:251]
 s_and_b32 s54, s54, 384
 v_mfma_f32_16x16x32_bf16 v[252:255], a[124:127], a[140:143], v[252:255]
 s_waitcnt lgkmcnt(0)
 s_barrier
 v_mfma_f32_16x16x32_bf16 v[128:131], a[0:3], a[128:131], v[128:131]
 ds_read_b64_tr_b16 a[64:65], v54 offset:0
 v_mfma_f32_16x16x32_bf16 v[132:135], a[4:7], a[128:131], v[132:135]
 ds_read_b64_tr_b16 a[66:67], v54 offset:1024
 v_mfma_f32_16x16x32_bf16 v[136:139], a[8:11], a[128:131], v[136:139]
 v_mfma_f32_16x16x32_bf16 v[140:143], a[12:15], a[128:131], v[140:143]
 ds_read_b64_tr_b16 a[68:69], v55 offset:0
 v_mfma_f32_16x16x32_bf16 v[144:147], a[16:19], a[128:131], v[144:147]
 s_waitcnt vmcnt(14)
 ds_read_b128 a[136:139], v48 offset:2048
 v_mfma_f32_16x16x32_bf16 v[148:151], a[20:23], a[128:131], v[148:151]
 ds_read_b128 a[140:143], v49 offset:2048
 v_mfma_f32_16x16x32_bf16 v[152:155], a[24:27], a[128:131], v[152:155]
 ds_read_b64_tr_b16 a[70:71], v55 offset:1024
 v_mfma_f32_16x16x32_bf16 v[156:159], a[28:31], a[128:131], v[156:159]
 ds_read_b64_tr_b16 a[72:73], v56 offset:0
 v_mfma_f32_16x16x32_bf16 v[128:131], a[32:35], a[132:135], v[128:131]
 ds_read_b64_tr_b16 a[74:75], v56 offset:1024
 v_mfma_f32_16x16x32_bf16 v[132:135], a[36:39], a[132:135], v[132:135]
 v_mfma_f32_16x16x32_bf16 v[136:139], a[40:43], a[132:135], v[136:139]
 ds_read_b64_tr_b16 a[76:77], v57 offset:0
 v_mfma_f32_16x16x32_bf16 v[140:143], a[44:47], a[132:135], v[140:143]
 v_mfma_f32_16x16x32_bf16 v[144:147], a[48:51], a[132:135], v[144:147]
 ds_read_b64_tr_b16 a[78:79], v57 offset:1024
 v_mfma_f32_16x16x32_bf16 v[148:151], a[52:55], a[132:135], v[148:151]
 v_mfma_f32_16x16x32_bf16 v[152:155], a[56:59], a[132:135], v[152:155]
 ds_read_b64_tr_b16 a[80:81], v58 offset:0
 v_mfma_f32_16x16x32_bf16 v[156:159], a[60:63], a[132:135], v[156:159]
 ds_read_b64_tr_b16 a[82:83], v58 offset:1024
 s_waitcnt lgkmcnt(7)
 v_mfma_f32_16x16x32_bf16 v[160:163], a[0:3], a[136:139], v[160:163]
 v_mfma_f32_16x16x32_bf16 v[164:167], a[4:7], a[136:139], v[164:167]
 ds_read_b64_tr_b16 a[84:85], v59 offset:0
 s_add_u32 s59, s60, 32768
 v_mfma_f32_16x16x32_bf16 v[168:171], a[8:11], a[136:139], v[168:171]
 s_add_u32 m0, s65, 32768
 v_mfma_f32_16x16x32_bf16 v[172:175], a[12:15], a[136:139], v[172:175]
 buffer_load_dwordx4 v8, s[16:19], s59 offen offset:0 nt lds
 v_mfma_f32_16x16x32_bf16 v[176:179], a[16:19], a[136:139], v[176:179]
 s_waitcnt vmcnt(12)
 ds_read_b128 a[128:131], v48 offset:4096
 v_mfma_f32_16x16x32_bf16 v[180:183], a[20:23], a[136:139], v[180:183]
 ds_read_b128 a[132:135], v49 offset:4096
 v_mfma_f32_16x16x32_bf16 v[184:187], a[24:27], a[136:139], v[184:187]
 ds_read_b64_tr_b16 a[86:87], v59 offset:1024
 v_mfma_f32_16x16x32_bf16 v[188:191], a[28:31], a[136:139], v[188:191]
 ds_read_b64_tr_b16 a[88:89], v60 offset:0
 v_mfma_f32_16x16x32_bf16 v[160:163], a[32:35], a[140:143], v[160:163]
 ds_read_b64_tr_b16 a[90:91], v60 offset:1024
 v_mfma_f32_16x16x32_bf16 v[164:167], a[36:39], a[140:143], v[164:167]
 ds_read_b64_tr_b16 a[92:93], v61 offset:0
 v_mfma_f32_16x16x32_bf16 v[168:171], a[40:43], a[140:143], v[168:171]
 ds_read_b64_tr_b16 a[94:95], v61 offset:1024
 v_mfma_f32_16x16x32_bf16 v[172:175], a[44:47], a[140:143], v[172:175]
 v_mfma_f32_16x16x32_bf16 v[176:179], a[48:51], a[140:143], v[176:179]
 ds_read_b64_tr_b16 a[96:97], v54 offset:8192
 s_add_u32 s59, s60, 32768
 v_mfma_f32_16x16x32_bf16 v[180:183], a[52:55], a[140:143], v[180:183]
 ds_read_b64_tr_b16 a[98:99], v54 offset:9216
 s_add_u32 m0, s65, 32768
 v_mfma_f32_16x16x32_bf16 v[184:187], a[56:59], a[140:143], v[184:187]
 buffer_load_dwordx4 v9, s[16:19], s59 offen offset:1024 nt lds
 v_mfma_f32_16x16x32_bf16 v[188:191], a[60:63], a[140:143], v[188:191]
 ds_read_b64_tr_b16 a[100:101], v55 offset:8192
 s_waitcnt lgkmcnt(8)
 v_mfma_f32_16x16x32_bf16 v[192:195], a[0:3], a[128:131], v[192:195]
 v_mfma_f32_16x16x32_bf16 v[196:199], a[4:7], a[128:131], v[196:199]
 ds_read_b64_tr_b16 a[102:103], v55 offset:9216
 v_mfma_f32_16x16x32_bf16 v[200:203], a[8:11], a[128:131], v[200:203]
 v_mfma_f32_16x16x32_bf16 v[204:207], a[12:15], a[128:131], v[204:207]
 ds_read_b64_tr_b16 a[104:105], v56 offset:8192
 v_mfma_f32_16x16x32_bf16 v[208:211], a[16:19], a[128:131], v[208:211]
 s_waitcnt vmcnt(10)
 ds_read_b128 a[136:139], v48 offset:6144
 v_mfma_f32_16x16x32_bf16 v[212:215], a[20:23], a[128:131], v[212:215]
 ds_read_b128 a[140:143], v49 offset:6144
 v_mfma_f32_16x16x32_bf16 v[216:219], a[24:27], a[128:131], v[216:219]
 ds_read_b64_tr_b16 a[106:107], v56 offset:9216
 v_mfma_f32_16x16x32_bf16 v[220:223], a[28:31], a[128:131], v[220:223]
 ds_read_b64_tr_b16 a[108:109], v57 offset:8192
 s_add_u32 s59, s60, 32768
 v_mfma_f32_16x16x32_bf16 v[192:195], a[32:35], a[132:135], v[192:195]
 ds_read_b64_tr_b16 a[110:111], v57 offset:9216
 s_add_u32 m0, s65, 32768
 v_mfma_f32_16x16x32_bf16 v[196:199], a[36:39], a[132:135], v[196:199]
 buffer_load_dwordx4 v10, s[16:19], s59 offen offset:2048 nt lds
 v_mfma_f32_16x16x32_bf16 v[200:203], a[40:43], a[132:135], v[200:203]
 ds_read_b64_tr_b16 a[112:113], v58 offset:8192
 v_mfma_f32_16x16x32_bf16 v[204:207], a[44:47], a[132:135], v[204:207]
 ds_read_b64_tr_b16 a[114:115], v58 offset:9216
 v_mfma_f32_16x16x32_bf16 v[208:211], a[48:51], a[132:135], v[208:211]
 v_mfma_f32_16x16x32_bf16 v[212:215], a[52:55], a[132:135], v[212:215]
 ds_read_b64_tr_b16 a[116:117], v59 offset:8192
 v_mfma_f32_16x16x32_bf16 v[216:219], a[56:59], a[132:135], v[216:219]
 v_mfma_f32_16x16x32_bf16 v[220:223], a[60:63], a[132:135], v[220:223]
 ds_read_b64_tr_b16 a[118:119], v59 offset:9216
 s_waitcnt lgkmcnt(7)
 v_mfma_f32_16x16x32_bf16 v[224:227], a[0:3], a[136:139], v[224:227]
 v_mfma_f32_16x16x32_bf16 v[228:231], a[4:7], a[136:139], v[228:231]
 ds_read_b64_tr_b16 a[120:121], v60 offset:8192
 v_mfma_f32_16x16x32_bf16 v[232:235], a[8:11], a[136:139], v[232:235]
 ds_read_b64_tr_b16 a[122:123], v60 offset:9216
 s_add_u32 s59, s60, 32768
 v_mfma_f32_16x16x32_bf16 v[236:239], a[12:15], a[136:139], v[236:239]
 s_add_u32 m0, s65, 32768
 v_mfma_f32_16x16x32_bf16 v[240:243], a[16:19], a[136:139], v[240:243]
 buffer_load_dwordx4 v11, s[16:19], s59 offen offset:3072 nt lds
 v_mfma_f32_16x16x32_bf16 v[244:247], a[20:23], a[136:139], v[244:247]
 s_waitcnt vmcnt(10)
 ds_read_b128 a[128:131], v48 offset:8192
 v_mfma_f32_16x16x32_bf16 v[248:251], a[24:27], a[136:139], v[248:251]
 ds_read_b128 a[132:135], v49 offset:8192
 v_mfma_f32_16x16x32_bf16 v[252:255], a[28:31], a[136:139], v[252:255]
 ds_read_b64_tr_b16 a[124:125], v61 offset:8192
 v_mfma_f32_16x16x32_bf16 v[224:227], a[32:35], a[140:143], v[224:227]
 ds_read_b64_tr_b16 a[126:127], v61 offset:9216
 v_mfma_f32_16x16x32_bf16 v[228:231], a[36:39], a[140:143], v[228:231]
 v_mfma_f32_16x16x32_bf16 v[232:235], a[40:43], a[140:143], v[232:235]
 v_mfma_f32_16x16x32_bf16 v[236:239], a[44:47], a[140:143], v[236:239]
 v_mfma_f32_16x16x32_bf16 v[240:243], a[48:51], a[140:143], v[240:243]
 v_mfma_f32_16x16x32_bf16 v[244:247], a[52:55], a[140:143], v[244:247]
 v_mfma_f32_16x16x32_bf16 v[248:251], a[56:59], a[140:143], v[248:251]
 v_mfma_f32_16x16x32_bf16 v[252:255], a[60:63], a[140:143], v[252:255]
 s_waitcnt lgkmcnt(0)
 s_barrier
 v_mfma_f32_16x16x32_bf16 v[128:131], a[64:67], a[128:131], v[128:131]
 v_mfma_f32_16x16x32_bf16 v[132:135], a[68:71], a[128:131], v[132:135]
 v_mfma_f32_16x16x32_bf16 v[136:139], a[72:75], a[128:131], v[136:139]
 v_mfma_f32_16x16x32_bf16 v[140:143], a[76:79], a[128:131], v[140:143]
 v_mfma_f32_16x16x32_bf16 v[144:147], a[80:83], a[128:131], v[144:147]
 s_waitcnt vmcnt(8)
 ds_read_b128 a[136:139], v48 offset:10240
 v_mfma_f32_16x16x32_bf16 v[148:151], a[84:87], a[128:131], v[148:151]
 ds_read_b128 a[140:143], v49 offset:10240
 v_mfma_f32_16x16x32_bf16 v[152:155], a[88:91], a[128:131], v[152:155]
 v_mfma_f32_16x16x32_bf16 v[156:159], a[92:95], a[128:131], v[156:159]
 v_mfma_f32_16x16x32_bf16 v[128:131], a[96:99], a[132:135], v[128:131]
 v_mfma_f32_16x16x32_bf16 v[132:135], a[100:103], a[132:135], v[132:135]
 v_mfma_f32_16x16x32_bf16 v[136:139], a[104:107], a[132:135], v[136:139]
 v_mfma_f32_16x16x32_bf16 v[140:143], a[108:111], a[132:135], v[140:143]
 v_mfma_f32_16x16x32_bf16 v[144:147], a[112:115], a[132:135], v[144:147]
 v_mfma_f32_16x16x32_bf16 v[148:151], a[116:119], a[132:135], v[148:151]
 v_mfma_f32_16x16x32_bf16 v[152:155], a[120:123], a[132:135], v[152:155]
 v_mfma_f32_16x16x32_bf16 v[156:159], a[124:127], a[132:135], v[156:159]
 s_waitcnt lgkmcnt(0)
 v_mfma_f32_16x16x32_bf16 v[160:163], a[64:67], a[136:139], v[160:163]
 v_mfma_f32_16x16x32_bf16 v[164:167], a[68:71], a[136:139], v[164:167]
 v_mfma_f32_16x16x32_bf16 v[168:171], a[72:75], a[136:139], v[168:171]
 v_mfma_f32_16x16x32_bf16 v[172:175], a[76:79], a[136:139], v[172:175]
 v_mfma_f32_16x16x32_bf16 v[176:179], a[80:83], a[136:139], v[176:179]
 s_waitcnt vmcnt(6)
 ds_read_b128 a[128:131], v48 offset:12288
 v_mfma_f32_16x16x32_bf16 v[180:183], a[84:87], a[136:139], v[180:183]
 ds_read_b128 a[132:135], v49 offset:12288
 v_mfma_f32_16x16x32_bf16 v[184:187], a[88:91], a[136:139], v[184:187]
 v_mfma_f32_16x16x32_bf16 v[188:191], a[92:95], a[136:139], v[188:191]
 v_mfma_f32_16x16x32_bf16 v[160:163], a[96:99], a[140:143], v[160:163]
 v_mfma_f32_16x16x32_bf16 v[164:167], a[100:103], a[140:143], v[164:167]
 v_mfma_f32_16x16x32_bf16 v[168:171], a[104:107], a[140:143], v[168:171]
 v_mfma_f32_16x16x32_bf16 v[172:175], a[108:111], a[140:143], v[172:175]
 v_mfma_f32_16x16x32_bf16 v[176:179], a[112:115], a[140:143], v[176:179]
 v_mfma_f32_16x16x32_bf16 v[180:183], a[116:119], a[140:143], v[180:183]
 v_mfma_f32_16x16x32_bf16 v[184:187], a[120:123], a[140:143], v[184:187]
 v_mfma_f32_16x16x32_bf16 v[188:191], a[124:127], a[140:143], v[188:191]
 s_waitcnt lgkmcnt(0)
 v_mfma_f32_16x16x32_bf16 v[192:195], a[64:67], a[128:131], v[192:195]
 v_mfma_f32_16x16x32_bf16 v[196:199], a[68:71], a[128:131], v[196:199]
 v_mfma_f32_16x16x32_bf16 v[200:203], a[72:75], a[128:131], v[200:203]
 v_mfma_f32_16x16x32_bf16 v[204:207], a[76:79], a[128:131], v[204:207]
 v_mfma_f32_16x16x32_bf16 v[208:211], a[80:83], a[128:131], v[208:211]
 s_waitcnt vmcnt(4)
 ds_read_b128 a[136:139], v48 offset:14336
 v_mfma_f32_16x16x32_bf16 v[212:215], a[84:87], a[128:131], v[212:215]
 ds_read_b128 a[140:143], v49 offset:14336
 v_mfma_f32_16x16x32_bf16 v[216:219], a[88:91], a[128:131], v[216:219]
 v_mfma_f32_16x16x32_bf16 v[220:223], a[92:95], a[128:131], v[220:223]
 v_mfma_f32_16x16x32_bf16 v[192:195], a[96:99], a[132:135], v[192:195]
 v_mfma_f32_16x16x32_bf16 v[196:199], a[100:103], a[132:135], v[196:199]
 v_mfma_f32_16x16x32_bf16 v[200:203], a[104:107], a[132:135], v[200:203]
 v_mfma_f32_16x16x32_bf16 v[204:207], a[108:111], a[132:135], v[204:207]
 v_mfma_f32_16x16x32_bf16 v[208:211], a[112:115], a[132:135], v[208:211]
 v_mfma_f32_16x16x32_bf16 v[212:215], a[116:119], a[132:135], v[212:215]
 v_mfma_f32_16x16x32_bf16 v[216:219], a[120:123], a[132:135], v[216:219]
 v_mfma_f32_16x16x32_bf16 v[220:223], a[124:127], a[132:135], v[220:223]
 s_waitcnt lgkmcnt(0)
 v_mfma_f32_16x16x32_bf16 v[224:227], a[64:67], a[136:139], v[224:227]
 v_mfma_f32_16x16x32_bf16 v[228:231], a[68:71], a[136:139], v[228:231]
 v_mfma_f32_16x16x32_bf16 v[232:235], a[72:75], a[136:139], v[232:235]
 v_mfma_f32_16x16x32_bf16 v[236:239], a[76:79], a[136:139], v[236:239]
 v_mfma_f32_16x16x32_bf16 v[240:243], a[80:83], a[136:139], v[240:243]
 v_mfma_f32_16x16x32_bf16 v[244:247], a[84:87], a[136:139], v[244:247]
 v_mfma_f32_16x16x32_bf16 v[248:251], a[88:91], a[136:139], v[248:251]
 v_mfma_f32_16x16x32_bf16 v[252:255], a[92:95], a[136:139], v[252:255]
 v_mfma_f32_16x16x32_bf16 v[224:227], a[96:99], a[140:143], v[224:227]
 v_mfma_f32_16x16x32_bf16 v[228:231], a[100:103], a[140:143], v[228:231]
 v_mfma_f32_16x16x32_bf16 v[232:235], a[104:107], a[140:143], v[232:235]
 v_mfma_f32_16x16x32_bf16 v[236:239], a[108:111], a[140:143], v[236:239]
 v_mfma_f32_16x16x32_bf16 v[240:243], a[112:115], a[140:143], v[240:243]
 v_mfma_f32_16x16x32_bf16 v[244:247], a[116:119], a[140:143], v[244:247]
 v_mfma_f32_16x16x32_bf16 v[248:251], a[120:123], a[140:143], v[248:251]
 v_mfma_f32_16x16x32_bf16 v[252:255], a[124:127], a[140:143], v[252:255]
 s_waitcnt vmcnt(0)
 s_barrier
 v_add_u32 v1, s65, v38
 v_add_u32 v3, 0x10000, v1
 ds_write_b128 v1, a[192:195] offset:49152
 ds_write_b128 v1, a[196:199] offset:50176
 ds_write_b128 v1, a[200:203] offset:51200
 ds_write_b128 v1, a[204:207] offset:52224
 ds_write_b128 v3, a[208:211] offset:0
 ds_write_b128 v3, a[212:215] offset:1024
 ds_write_b128 v3, a[216:219] offset:2048
 ds_write_b128 v3, a[220:223] offset:3072
 ds_write_b128 v3, a[224:227] offset:16384
 ds_write_b128 v3, a[228:231] offset:17408
 ds_write_b128 v3, a[232:235] offset:18432
 ds_write_b128 v3, a[236:239] offset:19456
 ds_write_b128 v3, a[240:243] offset:32768
 ds_write_b128 v3, a[244:247] offset:33792
 ds_write_b128 v3, a[248:251] offset:34816
 ds_write_b128 v3, a[252:255] offset:35840
 v_cvt_pk_bf16_f32 v56, v128, v129
 v_cvt_pk_bf16_f32 v57, v130, v131
 v_cvt_pk_bf16_f32 v58, v132, v133
 v_cvt_pk_bf16_f32 v59, v134, v135
 v_cndmask_b32 v64, v56, v58, s[68:69]
 v_cndmask_b32 v65, v57, v59, s[68:69]
 v_cndmask_b32 v66, v58, v56, s[68:69]
 v_cndmask_b32 v67, v59, v57, s[68:69]
 v_cvt_pk_bf16_f32 v56, v136, v137
 v_cvt_pk_bf16_f32 v57, v138, v139
 v_cvt_pk_bf16_f32 v58, v140, v141
 v_cvt_pk_bf16_f32 v59, v142, v143
 v_cndmask_b32 v68, v56, v58, s[68:69]
 v_cndmask_b32 v69, v57, v59, s[68:69]
 v_cndmask_b32 v70, v58, v56, s[68:69]
 v_cndmask_b32 v71, v59, v57, s[68:69]
 v_cvt_pk_bf16_f32 v56, v144, v145
 v_cvt_pk_bf16_f32 v57, v146, v147
 v_cvt_pk_bf16_f32 v58, v148, v149
 v_cvt_pk_bf16_f32 v59, v150, v151
 v_cndmask_b32 v72, v56, v58, s[68:69]
 v_cndmask_b32 v73, v57, v59, s[68:69]
 v_cndmask_b32 v74, v58, v56, s[68:69]
 v_cndmask_b32 v75, v59, v57, s[68:69]
 v_cvt_pk_bf16_f32 v56, v152, v153
 v_cvt_pk_bf16_f32 v57, v154, v155
 v_cvt_pk_bf16_f32 v58, v156, v157
 v_cvt_pk_bf16_f32 v59, v158, v159
 v_cndmask_b32 v76, v56, v58, s[68:69]
 v_cndmask_b32 v77, v57, v59, s[68:69]
 v_cndmask_b32 v78, v58, v56, s[68:69]
 v_cndmask_b32 v79, v59, v57, s[68:69]
 v_cvt_pk_bf16_f32 v56, v160, v161
 v_cvt_pk_bf16_f32 v57, v162, v163
 v_cvt_pk_bf16_f32 v58, v164, v165
 v_cvt_pk_bf16_f32 v59, v166, v167
 v_cndmask_b32 v80, v56, v58, s[68:69]
 v_cndmask_b32 v81, v57, v59, s[68:69]
 v_cndmask_b32 v82, v58, v56, s[68:69]
 v_cndmask_b32 v83, v59, v57, s[68:69]
 v_cvt_pk_bf16_f32 v56, v168, v169
 v_cvt_pk_bf16_f32 v57, v170, v171
 v_cvt_pk_bf16_f32 v58, v172, v173
 v_cvt_pk_bf16_f32 v59, v174, v175
 v_cndmask_b32 v84, v56, v58, s[68:69]
 v_cndmask_b32 v85, v57, v59, s[68:69]
 v_cndmask_b32 v86, v58, v56, s[68:69]
 v_cndmask_b32 v87, v59, v57, s[68:69]
 v_cvt_pk_bf16_f32 v56, v176, v177
 v_cvt_pk_bf16_f32 v57, v178, v179
 v_cvt_pk_bf16_f32 v58, v180, v181
 v_cvt_pk_bf16_f32 v59, v182, v183
 v_cndmask_b32 v88, v56, v58, s[68:69]
 v_cndmask_b32 v89, v57, v59, s[68:69]
 v_cndmask_b32 v90, v58, v56, s[68:69]
 v_cndmask_b32 v91, v59, v57, s[68:69]
 v_cvt_pk_bf16_f32 v56, v184, v185
 v_cvt_pk_bf16_f32 v57, v186, v187
 v_cvt_pk_bf16_f32 v58, v188, v189
 v_cvt_pk_bf16_f32 v59, v190, v191
 v_cndmask_b32 v92, v56, v58, s[68:69]
 v_cndmask_b32 v93, v57, v59, s[68:69]
 v_cndmask_b32 v94, v58, v56, s[68:69]
 v_cndmask_b32 v95, v59, v57, s[68:69]
 v_cvt_pk_bf16_f32 v56, v192, v193
 v_cvt_pk_bf16_f32 v57, v194, v195
 v_cvt_pk_bf16_f32 v58, v196, v197
 v_cvt_pk_bf16_f32 v59, v198, v199
 v_cndmask_b32 v96, v56, v58, s[68:69]
 v_cndmask_b32 v97, v57, v59, s[68:69]
 v_cndmask_b32 v98, v58, v56, s[68:69]
 v_cndmask_b32 v99, v59, v57, s[68:69]
 v_cvt_pk_bf16_f32 v56, v200, v201
 v_cvt_pk_bf16_f32 v57, v202, v203
 v_cvt_pk_bf16_f32 v58, v204, v205
 v_cvt_pk_bf16_f32 v59, v206, v207
 v_cndmask_b32 v100, v56, v58, s[68:69]
 v_cndmask_b32 v101, v57, v59, s[68:69]
 v_cndmask_b32 v102, v58, v56, s[68:69]
 v_cndmask_b32 v103, v59, v57, s[68:69]
 v_cvt_pk_bf16_f32 v56, v208, v209
 v_cvt_pk_bf16_f32 v57, v210, v211
 v_cvt_pk_bf16_f32 v58, v212, v213
 v_cvt_pk_bf16_f32 v59, v214, v215
 v_cndmask_b32 v104, v56, v58, s[68:69]
 v_cndmask_b32 v105, v57, v59, s[68:69]
 v_cndmask_b32 v106, v58, v56, s[68:69]
 v_cndmask_b32 v107, v59, v57, s[68:69]
 v_cvt_pk_bf16_f32 v56, v216, v217
 v_cvt_pk_bf16_f32 v57, v218, v219
 v_cvt_pk_bf16_f32 v58, v220, v221
 v_cvt_pk_bf16_f32 v59, v222, v223
 v_cndmask_b32 v108, v56, v58, s[68:69]
 v_cndmask_b32 v109, v57, v59, s[68:69]
 v_cndmask_b32 v110, v58, v56, s[68:69]
 v_cndmask_b32 v111, v59, v57, s[68:69]
 v_cvt_pk_bf16_f32 v56, v224, v225
 v_cvt_pk_bf16_f32 v57, v226, v227
 v_cvt_pk_bf16_f32 v58, v228, v229
 v_cvt_pk_bf16_f32 v59, v230, v231
 v_cndmask_b32 v112, v56, v58, s[68:69]
 v_cndmask_b32 v113, v57, v59, s[68:69]
 v_cndmask_b32 v114, v58, v56, s[68:69]
 v_cndmask_b32 v115, v59, v57, s[68:69]
 v_cvt_pk_bf16_f32 v56, v232, v233
 v_cvt_pk_bf16_f32 v57, v234, v235
 v_cvt_pk_bf16_f32 v58, v236, v237
 v_cvt_pk_bf16_f32 v59, v238, v239
 v_cndmask_b32 v116, v56, v58, s[68:69]
 v_cndmask_b32 v117, v57, v59, s[68:69]
 v_cndmask_b32 v118, v58, v56, s[68:69]
 v_cndmask_b32 v119, v59, v57, s[68:69]
 v_cvt_pk_bf16_f32 v56, v240, v241
 v_cvt_pk_bf16_f32 v57, v242, v243
 v_cvt_pk_bf16_f32 v58, v244, v245
 v_cvt_pk_bf16_f32 v59, v246, v247
 v_cndmask_b32 v120, v56, v58, s[68:69]
 v_cndmask_b32 v121, v57, v59, s[68:69]
 v_cndmask_b32 v122, v58, v56, s[68:69]
 v_cndmask_b32 v123, v59, v57, s[68:69]
 v_cvt_pk_bf16_f32 v56, v248, v249
 v_cvt_pk_bf16_f32 v57, v250, v251
 v_cvt_pk_bf16_f32 v58, v252, v253
 v_cvt_pk_bf16_f32 v59, v254, v255
 v_cndmask_b32 v124, v56, v58, s[68:69]
 v_cndmask_b32 v125, v57, v59, s[68:69]
 v_cndmask_b32 v126, v58, v56, s[68:69]
 v_cndmask_b32 v127, v59, v57, s[68:69]
 s_add_u32 m0, s65, 114688
 s_add_u32 s59, s60, 114688
 buffer_load_dwordx4 v8, s[16:19], s59 offen offset:0 nt lds
 buffer_load_dwordx4 v9, s[16:19], s59 offen offset:1024 nt lds
 buffer_load_dwordx4 v10, s[16:19], s59 offen offset:2048 nt lds
 buffer_load_dwordx4 v11, s[16:19], s59 offen offset:3072 nt lds
 s_waitcnt lgkmcnt(0)
L_ITEM:
 s_cmp_lt_u32 s62, 3
 s_cselect_b32 s26, 67108864, 0
 s_cselect_b32 s5, 0, 1
 s_cmp_eq_u32 s62, 0
 s_cbranch_scc0 L_QC0
 v_accvgpr_write_b32 a172, v64
 v_accvgpr_write_b32 a173, v65
 v_accvgpr_write_b32 a174, v66
 v_accvgpr_write_b32 a175, v67
 v_accvgpr_write_b32 a176, v68
 v_accvgpr_write_b32 a177, v69
 v_accvgpr_write_b32 a178, v70
 v_accvgpr_write_b32 a179, v71
 v_accvgpr_write_b32 a180, v72
 v_accvgpr_write_b32 a181, v73
 v_accvgpr_write_b32 a182, v74
 v_accvgpr_write_b32 a183, v75
 v_accvgpr_write_b32 a184, v76
 v_accvgpr_write_b32 a185, v77
 v_accvgpr_write_b32 a186, v78
 v_accvgpr_write_b32 a187, v79
L_QC0:
 s_cmp_eq_u32 s62, 1
 s_cbranch_scc0 L_QC1
 v_accvgpr_write_b32 a172, v80
 v_accvgpr_write_b32 a173, v81
 v_accvgpr_write_b32 a174, v82
 v_accvgpr_write_b32 a175, v83
 v_accvgpr_write_b32 a176, v84
 v_accvgpr_write_b32 a177, v85
 v_accvgpr_write_b32 a178, v86
 v_accvgpr_write_b32 a179, v87
 v_accvgpr_write_b32 a180, v88
 v_accvgpr_write_b32 a181, v89
 v_accvgpr_write_b32 a182, v90
 v_accvgpr_write_b32 a183, v91
 v_accvgpr_write_b32 a184, v92
 v_accvgpr_write_b32 a185, v93
 v_accvgpr_write_b32 a186, v94
 v_accvgpr_write_b32 a187, v95
L_QC1:
 s_cmp_eq_u32 s62, 2
 s_cbranch_scc0 L_QC2
 v_accvgpr_write_b32 a172, v96
 v_accvgpr_write_b32 a173, v97
 v_accvgpr_write_b32 a174, v98
 v_accvgpr_write_b32 a175, v99
 v_accvgpr_write_b32 a176, v100
 v_accvgpr_write_b32 a177, v101
 v_accvgpr_write_b32 a178, v102
 v_accvgpr_write_b32 a179, v103
 v_accvgpr_write_b32 a180, v104
 v_accvgpr_write_b32 a181, v105
 v_accvgpr_write_b32 a182, v106
 v_accvgpr_write_b32 a183, v107
 v_accvgpr_write_b32 a184, v108
 v_accvgpr_write_b32 a185, v109
 v_accvgpr_write_b32 a186, v110
 v_accvgpr_write_b32 a187, v111
L_QC2:
 s_cmp_eq_u32 s62, 3
 s_cbranch_scc0 L_QC3
 v_accvgpr_write_b32 a172, v112
 v_accvgpr_write_b32 a173, v113
 v_accvgpr_write_b32 a174, v114
 v_accvgpr_write_b32 a175, v115
 v_accvgpr_write_b32 a176, v116
 v_accvgpr_write_b32 a177, v117
 v_accvgpr_write_b32 a178, v118
 v_accvgpr_write_b32 a179, v119
 v_accvgpr_write_b32 a180, v120
 v_accvgpr_write_b32 a181, v121
 v_accvgpr_write_b32 a182, v122
 v_accvgpr_write_b32 a183, v123
 v_accvgpr_write_b32 a184, v124
 v_accvgpr_write_b32 a185, v125
 v_accvgpr_write_b32 a186, v126
 v_accvgpr_write_b32 a187, v127
L_QC3:
 s_waitcnt vmcnt(12)
 s_barrier
 ds_read_b128 a[0:3], v14 offset:0
 ds_read_b128 a[4:7], v15 offset:0
 ds_read_b128 a[8:11], v16 offset:0
 ds_read_b128 a[12:15], v17 offset:0
 ds_read_b128 a[16:19], v14 offset:4096
 ds_read_b128 a[20:23], v15 offset:4096
 ds_read_b128 a[24:27], v16 offset:4096
 ds_read_b128 a[28:31], v17 offset:4096
 ds_read_b128 a[32:35], v14 offset:8192
 ds_read_b128 a[36:39], v15 offset:8192
 ds_read_b128 a[40:43], v16 offset:8192
 ds_read_b128 a[44:47], v17 offset:8192
 ds_read_b128 a[48:51], v14 offset:12288
 ds_read_b128 a[52:55], v15 offset:12288
 ds_read_b128 a[56:59], v16 offset:12288
 ds_read_b128 a[60:63], v17 offset:12288
 s_waitcnt vmcnt(8)
 s_cmp_eq_u32 s62, 0
 s_cbranch_scc1 L_TS0
 s_waitcnt vmcnt(4)
L_TS0:
 s_barrier
 s_cmp_eq_u32 s62, 0
 s_cbranch_scc1 L_PS0
 s_add_u32 m0, s65, 65536
 s_add_u32 s59, s60, 65536
 buffer_load_dwordx4 v8, s[16:19], s59 offen offset:0 nt lds
 buffer_load_dwordx4 v9, s[16:19], s59 offen offset:1024 nt lds
 buffer_load_dwordx4 v10, s[16:19], s59 offen offset:2048 nt lds
 buffer_load_dwordx4 v11, s[16:19], s59 offen offset:3072 nt lds
L_PS0:
 s_waitcnt lgkmcnt(12)
 v_mfma_f32_16x16x32_bf16 v[128:131], a[0:3], a[172:175], 0
 ds_read_b128 a[64:67], v14 offset:16384
 v_mfma_f32_16x16x32_bf16 v[128:131], a[4:7], a[176:179], v[128:131]
 ds_read_b128 a[68:71], v15 offset:16384
 v_mfma_f32_16x16x32_bf16 v[128:131], a[8:11], a[180:183], v[128:131]
 ds_read_b128 a[72:75], v16 offset:16384
 ds_read_b128 a[76:79], v17 offset:16384
 v_mfma_f32_16x16x32_bf16 v[128:131], a[12:15], a[184:187], v[128:131]
 s_waitcnt lgkmcnt(12)
 v_mfma_f32_16x16x32_bf16 v[132:135], a[16:19], a[172:175], 0
 ds_read_b128 a[80:83], v14 offset:20480
 v_mfma_f32_16x16x32_bf16 v[132:135], a[20:23], a[176:179], v[132:135]
 ds_read_b128 a[84:87], v15 offset:20480
 v_mfma_f32_16x16x32_bf16 v[132:135], a[24:27], a[180:183], v[132:135]
 ds_read_b128 a[88:91], v16 offset:20480
 ds_read_b128 a[92:95], v17 offset:20480
 v_mfma_f32_16x16x32_bf16 v[132:135], a[28:31], a[184:187], v[132:135]
 s_waitcnt lgkmcnt(12)
 v_mfma_f32_16x16x32_bf16 v[136:139], a[32:35], a[172:175], 0
 ds_read_b128 a[96:99], v14 offset:24576
 v_mfma_f32_16x16x32_bf16 v[136:139], a[36:39], a[176:179], v[136:139]
 ds_read_b128 a[100:103], v15 offset:24576
 v_mfma_f32_16x16x32_bf16 v[136:139], a[40:43], a[180:183], v[136:139]
 ds_read_b128 a[104:107], v16 offset:24576
 ds_read_b128 a[108:111], v17 offset:24576
 v_mfma_f32_16x16x32_bf16 v[136:139], a[44:47], a[184:187], v[136:139]
 s_waitcnt lgkmcnt(12)
 v_mfma_f32_16x16x32_bf16 v[140:143], a[48:51], a[172:175], 0
 ds_read_b128 a[112:115], v14 offset:28672
 v_mfma_f32_16x16x32_bf16 v[140:143], a[52:55], a[176:179], v[140:143]
 ds_read_b128 a[116:119], v15 offset:28672
 v_mfma_f32_16x16x32_bf16 v[140:143], a[56:59], a[180:183], v[140:143]
 ds_read_b128 a[120:123], v16 offset:28672
 ds_read_b128 a[124:127], v17 offset:28672
 v_mfma_f32_16x16x32_bf16 v[140:143], a[60:63], a[184:187], v[140:143]
 s_waitcnt vmcnt(8)
 s_cmp_eq_u32 s62, 0
 s_cbranch_scc1 L_TS1
 s_waitcnt vmcnt(4)
L_TS1:
 s_barrier
 s_cmp_eq_u32 s62, 0
 s_cbranch_scc1 L_PS1
 s_add_u32 m0, s65, 81920
 s_add_u32 s59, s60, 81920
 buffer_load_dwordx4 v8, s[16:19], s59 offen offset:0 nt lds
 buffer_load_dwordx4 v9, s[16:19], s59 offen offset:1024 nt lds
 buffer_load_dwordx4 v10, s[16:19], s59 offen offset:2048 nt lds
 buffer_load_dwordx4 v11, s[16:19], s59 offen offset:3072 nt lds
L_PS1:
 s_waitcnt lgkmcnt(12)
 v_mfma_f32_16x16x32_bf16 v[144:147], a[64:67], a[172:175], 0
 ds_read_b128 a[0:3], v14 offset:32768
 v_max3_f32 v4, v128, v129, v130
 v_mfma_f32_16x16x32_bf16 v[144:147], a[68:71], a[176:179], v[144:147]
 ds_read_b128 a[4:7], v15 offset:32768
 v_max_f32 v4, v4, v131
 v_mfma_f32_16x16x32_bf16 v[144:147], a[72:75], a[180:183], v[144:147]
 ds_read_b128 a[8:11], v16 offset:32768
 ds_read_b128 a[12:15], v17 offset:32768
 v_mfma_f32_16x16x32_bf16 v[144:147], a[76:79], a[184:187], v[144:147]
 s_waitcnt lgkmcnt(12)
 v_mfma_f32_16x16x32_bf16 v[148:151], a[80:83], a[172:175], 0
 ds_read_b128 a[16:19], v14 offset:36864
 v_max3_f32 v5, v132, v133, v134
 v_mfma_f32_16x16x32_bf16 v[148:151], a[84:87], a[176:179], v[148:151]
 ds_read_b128 a[20:23], v15 offset:36864
 v_max_f32 v5, v5, v135
 v_mfma_f32_16x16x32_bf16 v[148:151], a[88:91], a[180:183], v[148:151]
 ds_read_b128 a[24:27], v16 offset:36864
 ds_read_b128 a[28:31], v17 offset:36864
 v_mfma_f32_16x16x32_bf16 v[148:151], a[92:95], a[184:187], v[148:151]
 s_waitcnt lgkmcnt(12)
 v_mfma_f32_16x16x32_bf16 v[152:155], a[96:99], a[172:175], 0
 ds_read_b128 a[32:35], v14 offset:40960
 v_max3_f32 v6, v136, v137, v138
 v_mfma_f32_16x16x32_bf16 v[152:155], a[100:103], a[176:179], v[152:155]
 ds_read_b128 a[36:39], v15 offset:40960
 v_max_f32 v6, v6, v139
 v_mfma_f32_16x16x32_bf16 v[152:155], a[104:107], a[180:183], v[152:155]
 ds_read_b128 a[40:43], v16 offset:40960
 ds_read_b128 a[44:47], v17 offset:40960
 v_mfma_f32_16x16x32_bf16 v[152:155], a[108:111], a[184:187], v[152:155]
 s_waitcnt lgkmcnt(12)
 v_mfma_f32_16x16x32_bf16 v[156:159], a[112:115], a[172:175], 0
 ds_read_b128 a[48:51], v14 offset:45056
 v_max3_f32 v7, v140, v141, v142
 v_mfma_f32_16x16x32_bf16 v[156:159], a[116:119], a[176:179], v[156:159]
 ds_read_b128 a[52:55], v15 offset:45056
 v_max_f32 v7, v7, v143
 v_mfma_f32_16x16x32_bf16 v[156:159], a[120:123], a[180:183], v[156:159]
 ds_read_b128 a[56:59], v16 offset:45056
 ds_read_b128 a[60:63], v17 offset:45056
 v_mfma_f32_16x16x32_bf16 v[156:159], a[124:127], a[184:187], v[156:159]
 s_waitcnt vmcnt(8)
 s_cmp_eq_u32 s62, 0
 s_cbranch_scc1 L_TS2
 s_waitcnt vmcnt(4)
L_TS2:
 s_barrier
 s_cmp_eq_u32 s62, 0
 s_cbranch_scc1 L_PS2
 s_add_u32 m0, s65, 98304
 s_add_u32 s59, s60, 98304
 buffer_load_dwordx4 v8, s[16:19], s59 offen offset:0 nt lds
 buffer_load_dwordx4 v9, s[16:19], s59 offen offset:1024 nt lds
 buffer_load_dwordx4 v10, s[16:19], s59 offen offset:2048 nt lds
 buffer_load_dwordx4 v11, s[16:19], s59 offen offset:3072 nt lds
L_PS2:
 s_waitcnt lgkmcnt(12)
 v_mfma_f32_16x16x32_bf16 v[160:163], a[0:3], a[172:175], 0
 ds_read_b128 a[64:67], v14 offset:49152
 v_max3_f32 v4, v4, v144, v145
 v_mfma_f32_16x16x32_bf16 v[160:163], a[4:7], a[176:179], v[160:163]
 ds_read_b128 a[68:71], v15 offset:49152
 v_max3_f32 v4, v4, v146, v147
 v_mfma_f32_16x16x32_bf16 v[160:163], a[8:11], a[180:183], v[160:163]
 ds_read_b128 a[72:75], v16 offset:49152
 ds_read_b128 a[76:79], v17 offset:49152
 v_mfma_f32_16x16x32_bf16 v[160:163], a[12:15], a[184:187], v[160:163]
 s_waitcnt lgkmcnt(12)
 v_mfma_f32_16x16x32_bf16 v[164:167], a[16:19], a[172:175], 0
 ds_read_b128 a[80:83], v14 offset:53248
 v_max3_f32 v5, v5, v148, v149
 v_mfma_f32_16x16x32_bf16 v[164:167], a[20:23], a[176:179], v[164:167]
 ds_read_b128 a[84:87], v15 offset:53248
 v_max3_f32 v5, v5, v150, v151
 v_mfma_f32_16x16x32_bf16 v[164:167], a[24:27], a[180:183], v[164:167]
 ds_read_b128 a[88:91], v16 offset:53248
 ds_read_b128 a[92:95], v17 offset:53248
 v_mfma_f32_16x16x32_bf16 v[164:167], a[28:31], a[184:187], v[164:167]
 s_waitcnt lgkmcnt(12)
 v_mfma_f32_16x16x32_bf16 v[168:171], a[32:35], a[172:175], 0
 ds_read_b128 a[96:99], v14 offset:57344
 v_max3_f32 v6, v6, v152, v153
 v_mfma_f32_16x16x32_bf16 v[168:171], a[36:39], a[176:179], v[168:171]
 ds_read_b128 a[100:103], v15 offset:57344
 v_max3_f32 v6, v6, v154, v155
 v_mfma_f32_16x16x32_bf16 v[168:171], a[40:43], a[180:183], v[168:171]
 ds_read_b128 a[104:107], v16 offset:57344
 ds_read_b128 a[108:111], v17 offset:57344
 v_mfma_f32_16x16x32_bf16 v[168:171], a[44:47], a[184:187], v[168:171]
 s_waitcnt lgkmcnt(12)
 v_mfma_f32_16x16x32_bf16 v[172:175], a[48:51], a[172:175], 0
 ds_read_b128 a[112:115], v14 offset:61440
 v_max3_f32 v7, v7, v156, v157
 v_mfma_f32_16x16x32_bf16 v[172:175], a[52:55], a[176:179], v[172:175]
 ds_read_b128 a[116:119], v15 offset:61440
 v_max3_f32 v7, v7, v158, v159
 v_mfma_f32_16x16x32_bf16 v[172:175], a[56:59], a[180:183], v[172:175]
 ds_read_b128 a[120:123], v16 offset:61440
 ds_read_b128 a[124:127], v17 offset:61440
 v_mfma_f32_16x16x32_bf16 v[172:175], a[60:63], a[184:187], v[172:175]
 s_waitcnt vmcnt(8)
 s_cmp_eq_u32 s62, 0
 s_cbranch_scc1 L_TS3
 s_waitcnt vmcnt(4)
L_TS3:
 s_barrier
 s_cmp_eq_u32 s62, 0
 s_cbranch_scc1 L_PS3
 s_add_u32 m0, s65, 114688
 s_add_u32 s59, s60, 114688
 buffer_load_dwordx4 v8, s[16:19], s59 offen offset:0 nt lds
 buffer_load_dwordx4 v9, s[16:19], s59 offen offset:1024 nt lds
 buffer_load_dwordx4 v10, s[16:19], s59 offen offset:2048 nt lds
 buffer_load_dwordx4 v11, s[16:19], s59 offen offset:3072 nt lds
L_PS3:
 s_waitcnt lgkmcnt(12)
 v_mfma_f32_16x16x32_bf16 v[176:179], a[64:67], a[172:175], 0
 ds_read_b128 a[0:3], v18 offset:0
 v_max3_f32 v4, v4, v160, v161
 v_mfma_f32_16x16x32_bf16 v[176:179], a[68:71], a[176:179], v[176:179]
 ds_read_b128 a[4:7], v19 offset:0
 v_max3_f32 v4, v4, v162, v163
 v_mfma_f32_16x16x32_bf16 v[176:179], a[72:75], a[180:183], v[176:179]
 ds_read_b128 a[8:11], v20 offset:0
 ds_read_b128 a[12:15], v21 offset:0
 v_mfma_f32_16x16x32_bf16 v[176:179], a[76:79], a[184:187], v[176:179]
 s_waitcnt lgkmcnt(12)
 v_mfma_f32_16x16x32_bf16 v[180:183], a[80:83], a[172:175], 0
 ds_read_b128 a[16:19], v18 offset:4096
 v_max3_f32 v5, v5, v164, v165
 v_mfma_f32_16x16x32_bf16 v[180:183], a[84:87], a[176:179], v[180:183]
 ds_read_b128 a[20:23], v19 offset:4096
 v_max3_f32 v5, v5, v166, v167
 v_mfma_f32_16x16x32_bf16 v[180:183], a[88:91], a[180:183], v[180:183]
 ds_read_b128 a[24:27], v20 offset:4096
 ds_read_b128 a[28:31], v21 offset:4096
 v_mfma_f32_16x16x32_bf16 v[180:183], a[92:95], a[184:187], v[180:183]
 s_waitcnt lgkmcnt(12)
 v_mfma_f32_16x16x32_bf16 v[184:187], a[96:99], a[172:175], 0
 ds_read_b128 a[32:35], v18 offset:8192
 v_max3_f32 v6, v6, v168, v169
 v_mfma_f32_16x16x32_bf16 v[184:187], a[100:103], a[176:179], v[184:187]
 ds_read_b128 a[36:39], v19 offset:8192
 v_max3_f32 v6, v6, v170, v171
 v_mfma_f32_16x16x32_bf16 v[184:187], a[104:107], a[180:183], v[184:187]
 ds_read_b128 a[40:43], v20 offset:8192
 ds_read_b128 a[44:47], v21 offset:8192
 v_mfma_f32_16x16x32_bf16 v[184:187], a[108:111], a[184:187], v[184:187]
 s_waitcnt lgkmcnt(12)
 v_mfma_f32_16x16x32_bf16 v[188:191], a[112:115], a[172:175], 0
 ds_read_b128 a[48:51], v18 offset:12288
 v_max3_f32 v7, v7, v172, v173
 v_mfma_f32_16x16x32_bf16 v[188:191], a[116:119], a[176:179], v[188:191]
 ds_read_b128 a[52:55], v19 offset:12288
 v_max3_f32 v7, v7, v174, v175
 v_mfma_f32_16x16x32_bf16 v[188:191], a[120:123], a[180:183], v[188:191]
 ds_read_b128 a[56:59], v20 offset:12288
 ds_read_b128 a[60:63], v21 offset:12288
 v_mfma_f32_16x16x32_bf16 v[188:191], a[124:127], a[184:187], v[188:191]
 s_waitcnt vmcnt(8)
 s_waitcnt vmcnt(4)
 s_barrier
 s_add_u32 m0, s65, 0
 s_add_u32 s59, s60, 0
 s_waitcnt lgkmcnt(12)
 v_mfma_f32_16x16x32_bf16 v[192:195], a[0:3], a[172:175], 0
 ds_read_b128 a[64:67], v18 offset:16384
 v_max3_f32 v4, v4, v176, v177
 v_mfma_f32_16x16x32_bf16 v[192:195], a[4:7], a[176:179], v[192:195]
 ds_read_b128 a[68:71], v19 offset:16384
 v_max3_f32 v4, v4, v178, v179
 v_mfma_f32_16x16x32_bf16 v[192:195], a[8:11], a[180:183], v[192:195]
 ds_read_b128 a[72:75], v20 offset:16384
 ds_read_b128 a[76:79], v21 offset:16384
 v_mfma_f32_16x16x32_bf16 v[192:195], a[12:15], a[184:187], v[192:195]
 buffer_load_dwordx4 v12, s[20:23], s59 offen offset:0 nt lds
 s_waitcnt lgkmcnt(12)
 v_mfma_f32_16x16x32_bf16 v[196:199], a[16:19], a[172:175], 0
 ds_read_b128 a[80:83], v18 offset:20480
 v_max3_f32 v5, v5, v180, v181
 v_mfma_f32_16x16x32_bf16 v[196:199], a[20:23], a[176:179], v[196:199]
 ds_read_b128 a[84:87], v19 offset:20480
 v_max3_f32 v5, v5, v182, v183
 v_mfma_f32_16x16x32_bf16 v[196:199], a[24:27], a[180:183], v[196:199]
 ds_read_b128 a[88:91], v20 offset:20480
 ds_read_b128 a[92:95], v21 offset:20480
 v_mfma_f32_16x16x32_bf16 v[196:199], a[28:31], a[184:187], v[196:199]
 buffer_load_dwordx4 v13, s[20:23], s59 offen offset:1024 nt lds
 s_waitcnt lgkmcnt(12)
 v_mfma_f32_16x16x32_bf16 v[200:203], a[32:35], a[172:175], 0
 ds_read_b128 a[96:99], v18 offset:24576
 v_max3_f32 v6, v6, v184, v185
 v_mfma_f32_16x16x32_bf16 v[200:203], a[36:39], a[176:179], v[200:203]
 ds_read_b128 a[100:103], v19 offset:24576
 v_max3_f32 v6, v6, v186, v187
 v_mfma_f32_16x16x32_bf16 v[200:203], a[40:43], a[180:183], v[200:203]
 ds_read_b128 a[104:107], v20 offset:24576
 ds_read_b128 a[108:111], v21 offset:24576
 v_mfma_f32_16x16x32_bf16 v[200:203], a[44:47], a[184:187], v[200:203]
 buffer_load_dwordx4 v12, s[20:23], s59 offen offset:2048 nt lds
 s_waitcnt lgkmcnt(12)
 v_mfma_f32_16x16x32_bf16 v[204:207], a[48:51], a[172:175], 0
 ds_read_b128 a[112:115], v18 offset:28672
 v_max3_f32 v7, v7, v188, v189
 v_mfma_f32_16x16x32_bf16 v[204:207], a[52:55], a[176:179], v[204:207]
 ds_read_b128 a[116:119], v19 offset:28672
 v_max3_f32 v7, v7, v190, v191
 v_mfma_f32_16x16x32_bf16 v[204:207], a[56:59], a[180:183], v[204:207]
 ds_read_b128 a[120:123], v20 offset:28672
 ds_read_b128 a[124:127], v21 offset:28672
 v_mfma_f32_16x16x32_bf16 v[204:207], a[60:63], a[184:187], v[204:207]
 buffer_load_dwordx4 v13, s[20:23], s59 offen offset:3072 nt lds
 s_waitcnt vmcnt(8)
 s_waitcnt vmcnt(4)
 s_barrier
 s_add_u32 m0, s65, 16384
 s_add_u32 s59, s60, 16384
 s_waitcnt lgkmcnt(12)
 v_mfma_f32_16x16x32_bf16 v[208:211], a[64:67], a[172:175], 0
 ds_read_b128 a[0:3], v18 offset:32768
 v_max3_f32 v4, v4, v192, v193
 v_mfma_f32_16x16x32_bf16 v[208:211], a[68:71], a[176:179], v[208:211]
 ds_read_b128 a[4:7], v19 offset:32768
 v_max3_f32 v4, v4, v194, v195
 v_mfma_f32_16x16x32_bf16 v[208:211], a[72:75], a[180:183], v[208:211]
 ds_read_b128 a[8:11], v20 offset:32768
 ds_read_b128 a[12:15], v21 offset:32768
 v_mfma_f32_16x16x32_bf16 v[208:211], a[76:79], a[184:187], v[208:211]
 buffer_load_dwordx4 v12, s[20:23], s59 offen offset:0 nt lds
 s_waitcnt lgkmcnt(12)
 v_mfma_f32_16x16x32_bf16 v[212:215], a[80:83], a[172:175], 0
 ds_read_b128 a[16:19], v18 offset:36864
 v_max3_f32 v5, v5, v196, v197
 v_mfma_f32_16x16x32_bf16 v[212:215], a[84:87], a[176:179], v[212:215]
 ds_read_b128 a[20:23], v19 offset:36864
 v_max3_f32 v5, v5, v198, v199
 v_mfma_f32_16x16x32_bf16 v[212:215], a[88:91], a[180:183], v[212:215]
 ds_read_b128 a[24:27], v20 offset:36864
 ds_read_b128 a[28:31], v21 offset:36864
 v_mfma_f32_16x16x32_bf16 v[212:215], a[92:95], a[184:187], v[212:215]
 buffer_load_dwordx4 v13, s[20:23], s59 offen offset:1024 nt lds
 s_waitcnt lgkmcnt(12)
 v_mfma_f32_16x16x32_bf16 v[216:219], a[96:99], a[172:175], 0
 ds_read_b128 a[32:35], v18 offset:40960
 v_max3_f32 v6, v6, v200, v201
 v_mfma_f32_16x16x32_bf16 v[216:219], a[100:103], a[176:179], v[216:219]
 ds_read_b128 a[36:39], v19 offset:40960
 v_max3_f32 v6, v6, v202, v203
 v_mfma_f32_16x16x32_bf16 v[216:219], a[104:107], a[180:183], v[216:219]
 ds_read_b128 a[40:43], v20 offset:40960
 ds_read_b128 a[44:47], v21 offset:40960
 v_mfma_f32_16x16x32_bf16 v[216:219], a[108:111], a[184:187], v[216:219]
 buffer_load_dwordx4 v12, s[20:23], s59 offen offset:2048 nt lds
 s_waitcnt lgkmcnt(12)
 v_mfma_f32_16x16x32_bf16 v[220:223], a[112:115], a[172:175], 0
 ds_read_b128 a[48:51], v18 offset:45056
 v_max3_f32 v7, v7, v204, v205
 v_mfma_f32_16x16x32_bf16 v[220:223], a[116:119], a[176:179], v[220:223]
 ds_read_b128 a[52:55], v19 offset:45056
 v_max3_f32 v7, v7, v206, v207
 v_mfma_f32_16x16x32_bf16 v[220:223], a[120:123], a[180:183], v[220:223]
 ds_read_b128 a[56:59], v20 offset:45056
 ds_read_b128 a[60:63], v21 offset:45056
 v_mfma_f32_16x16x32_bf16 v[220:223], a[124:127], a[184:187], v[220:223]
 buffer_load_dwordx4 v13, s[20:23], s59 offen offset:3072 nt lds
 s_waitcnt vmcnt(8)
 s_waitcnt vmcnt(4)
 s_barrier
 s_add_u32 m0, s65, 32768
 s_add_u32 s59, s60, 32768
 s_waitcnt lgkmcnt(12)
 v_mfma_f32_16x16x32_bf16 v[224:227], a[0:3], a[172:175], 0
 ds_read_b128 a[64:67], v18 offset:49152
 v_max3_f32 v4, v4, v208, v209
 v_mfma_f32_16x16x32_bf16 v[224:227], a[4:7], a[176:179], v[224:227]
 ds_read_b128 a[68:71], v19 offset:49152
 v_max3_f32 v4, v4, v210, v211
 v_mfma_f32_16x16x32_bf16 v[224:227], a[8:11], a[180:183], v[224:227]
 ds_read_b128 a[72:75], v20 offset:49152
 ds_read_b128 a[76:79], v21 offset:49152
 v_mfma_f32_16x16x32_bf16 v[224:227], a[12:15], a[184:187], v[224:227]
 buffer_load_dwordx4 v12, s[20:23], s59 offen offset:0 nt lds
 s_waitcnt lgkmcnt(12)
 v_mfma_f32_16x16x32_bf16 v[228:231], a[16:19], a[172:175], 0
 ds_read_b128 a[80:83], v18 offset:53248
 v_max3_f32 v5, v5, v212, v213
 v_mfma_f32_16x16x32_bf16 v[228:231], a[20:23], a[176:179], v[228:231]
 ds_read_b128 a[84:87], v19 offset:53248
 v_max3_f32 v5, v5, v214, v215
 v_mfma_f32_16x16x32_bf16 v[228:231], a[24:27], a[180:183], v[228:231]
 ds_read_b128 a[88:91], v20 offset:53248
 ds_read_b128 a[92:95], v21 offset:53248
 v_mfma_f32_16x16x32_bf16 v[228:231], a[28:31], a[184:187], v[228:231]
 buffer_load_dwordx4 v13, s[20:23], s59 offen offset:1024 nt lds
 s_waitcnt lgkmcnt(12)
 v_mfma_f32_16x16x32_bf16 v[232:235], a[32:35], a[172:175], 0
 ds_read_b128 a[96:99], v18 offset:57344
 v_max3_f32 v6, v6, v216, v217
 v_mfma_f32_16x16x32_bf16 v[232:235], a[36:39], a[176:179], v[232:235]
 ds_read_b128 a[100:103], v19 offset:57344
 v_max3_f32 v6, v6, v218, v219
 v_mfma_f32_16x16x32_bf16 v[232:235], a[40:43], a[180:183], v[232:235]
 ds_read_b128 a[104:107], v20 offset:57344
 ds_read_b128 a[108:111], v21 offset:57344
 v_mfma_f32_16x16x32_bf16 v[232:235], a[44:47], a[184:187], v[232:235]
 buffer_load_dwordx4 v12, s[20:23], s59 offen offset:2048 nt lds
 s_waitcnt lgkmcnt(12)
 v_mfma_f32_16x16x32_bf16 v[236:239], a[48:51], a[172:175], 0
 ds_read_b128 a[112:115], v18 offset:61440
 v_max3_f32 v7, v7, v220, v221
 v_mfma_f32_16x16x32_bf16 v[236:239], a[52:55], a[176:179], v[236:239]
 ds_read_b128 a[116:119], v19 offset:61440
 v_max3_f32 v7, v7, v222, v223
 v_mfma_f32_16x16x32_bf16 v[236:239], a[56:59], a[180:183], v[236:239]
 ds_read_b128 a[120:123], v20 offset:61440
 ds_read_b128 a[124:127], v21 offset:61440
 v_mfma_f32_16x16x32_bf16 v[236:239], a[60:63], a[184:187], v[236:239]
 buffer_load_dwordx4 v13, s[20:23], s59 offen offset:3072 nt lds
 s_waitcnt vmcnt(8)
 s_waitcnt vmcnt(4)
 s_barrier
 s_add_u32 m0, s65, 49152
 s_add_u32 s59, s60, 49152
 s_waitcnt lgkmcnt(12)
 v_mfma_f32_16x16x32_bf16 v[240:243], a[64:67], a[172:175], 0
 ds_read_b64_tr_b16 a[0:1], v22 offset:0
 ds_read_b64_tr_b16 a[2:3], v22 offset:4096
 v_max3_f32 v4, v4, v224, v225
 v_mfma_f32_16x16x32_bf16 v[240:243], a[68:71], a[176:179], v[240:243]
 ds_read_b64_tr_b16 a[4:5], v23 offset:0
 ds_read_b64_tr_b16 a[6:7], v23 offset:4096
 v_mfma_f32_16x16x32_bf16 v[240:243], a[72:75], a[180:183], v[240:243]
 ds_read_b64_tr_b16 a[8:9], v24 offset:0
 ds_read_b64_tr_b16 a[10:11], v24 offset:4096
 v_max3_f32 v4, v4, v226, v227
 v_mfma_f32_16x16x32_bf16 v[240:243], a[76:79], a[184:187], v[240:243]
 buffer_load_dwordx4 v12, s[20:23], s59 offen offset:0 nt lds
 ds_read_b64_tr_b16 a[12:13], v25 offset:0
 ds_read_b64_tr_b16 a[14:15], v25 offset:4096
 s_waitcnt lgkmcnt(15)
 v_mfma_f32_16x16x32_bf16 v[244:247], a[80:83], a[172:175], 0
 ds_read_b64_tr_b16 a[16:17], v26 offset:0
 ds_read_b64_tr_b16 a[18:19], v26 offset:4096
 v_max3_f32 v5, v5, v228, v229
 v_mfma_f32_16x16x32_bf16 v[244:247], a[84:87], a[176:179], v[244:247]
 ds_read_b64_tr_b16 a[20:21], v27 offset:0
 ds_read_b64_tr_b16 a[22:23], v27 offset:4096
 v_mfma_f32_16x16x32_bf16 v[244:247], a[88:91], a[180:183], v[244:247]
 ds_read_b64_tr_b16 a[24:25], v28 offset:0
 ds_read_b64_tr_b16 a[26:27], v28 offset:4096
 v_max3_f32 v5, v5, v230, v231
 v_mfma_f32_16x16x32_bf16 v[244:247], a[92:95], a[184:187], v[244:247]
 buffer_load_dwordx4 v13, s[20:23], s59 offen offset:1024 nt lds
 ds_read_b64_tr_b16 a[28:29], v29 offset:0
 ds_read_b64_tr_b16 a[30:31], v29 offset:4096
 s_waitcnt lgkmcnt(15)
 v_mfma_f32_16x16x32_bf16 v[248:251], a[96:99], a[172:175], 0
 ds_read_b64_tr_b16 a[32:33], v22 offset:8192
 ds_read_b64_tr_b16 a[34:35], v22 offset:12288
 v_max3_f32 v6, v6, v232, v233
 v_mfma_f32_16x16x32_bf16 v[248:251], a[100:103], a[176:179], v[248:251]
 ds_read_b64_tr_b16 a[36:37], v23 offset:8192
 ds_read_b64_tr_b16 a[38:39], v23 offset:12288
 v_mfma_f32_16x16x32_bf16 v[248:251], a[104:107], a[180:183], v[248:251]
 ds_read_b64_tr_b16 a[40:41], v24 offset:8192
 ds_read_b64_tr_b16 a[42:43], v24 offset:12288
 v_max3_f32 v6, v6, v234, v235
 v_mfma_f32_16x16x32_bf16 v[248:251], a[108:111], a[184:187], v[248:251]
 buffer_load_dwordx4 v12, s[20:23], s59 offen offset:2048 nt lds
 ds_read_b64_tr_b16 a[44:45], v25 offset:8192
 ds_read_b64_tr_b16 a[46:47], v25 offset:12288
 v_mfma_f32_16x16x32_bf16 v[252:255], a[112:115], a[172:175], 0
 ds_read_b64_tr_b16 a[48:49], v26 offset:8192
 ds_read_b64_tr_b16 a[50:51], v26 offset:12288
 v_max3_f32 v7, v7, v236, v237
 v_mfma_f32_16x16x32_bf16 v[252:255], a[116:119], a[176:179], v[252:255]
 ds_read_b64_tr_b16 a[52:53], v27 offset:8192
 ds_read_b64_tr_b16 a[54:55], v27 offset:12288
 v_mfma_f32_16x16x32_bf16 v[252:255], a[120:123], a[180:183], v[252:255]
 ds_read_b64_tr_b16 a[56:57], v28 offset:8192
 ds_read_b64_tr_b16 a[58:59], v28 offset:12288
 v_max3_f32 v7, v7, v238, v239
 v_mfma_f32_16x16x32_bf16 v[252:255], a[124:127], a[184:187], v[252:255]
 buffer_load_dwordx4 v13, s[20:23], s59 offen offset:3072 nt lds
 ds_read_b64_tr_b16 a[60:61], v29 offset:8192
 ds_read_b64_tr_b16 a[62:63], v29 offset:12288
 s_nop 7
 v_max3_f32 v4, v4, v240, v241
 v_max3_f32 v4, v4, v242, v243
 v_max3_f32 v5, v5, v244, v245
 v_max3_f32 v5, v5, v246, v247
 v_max3_f32 v6, v6, v248, v249
 v_max3_f32 v6, v6, v250, v251
 v_max3_f32 v7, v7, v252, v253
 v_max3_f32 v7, v7, v254, v255
 v_max3_f32 v4, v4, v5, v6
 v_max_f32 v4, v4, v7
 v_mov_b32 v5, v4
 s_nop 1
 v_permlane16_swap_b32 v4, v5
 v_max_f32 v4, v4, v5
 v_mov_b32 v5, v4
 s_nop 1
 v_permlane32_swap_b32 v4, v5
 v_max_f32 v4, v4, v5
 v_mul_f32 v4, s64, v4
 v_fma_f32 v52, v128, s64, -v4
 v_fma_f32 v53, v129, s64, -v4
 v_fma_f32 v54, v130, s64, -v4
 v_fma_f32 v55, v131, s64, -v4
 v_fma_f32 v56, v132, s64, -v4
 v_fma_f32 v57, v133, s64, -v4
 v_fma_f32 v58, v134, s64, -v4
 v_fma_f32 v59, v135, s64, -v4
 v_exp_f32 v52, v52
 v_exp_f32 v53, v53
 v_exp_f32 v54, v54
 v_exp_f32 v55, v55
 v_exp_f32 v56, v56
 v_exp_f32 v57, v57
 v_exp_f32 v58, v58
 v_exp_f32 v59, v59
 v_cvt_pk_bf16_f32 v128, v52, v53
 v_cvt_pk_bf16_f32 v129, v54, v55
 v_cvt_pk_bf16_f32 v130, v56, v57
 v_cvt_pk_bf16_f32 v131, v58, v59
 v_fma_f32 v52, v136, s64, -v4
 v_fma_f32 v53, v137, s64, -v4
 v_fma_f32 v54, v138, s64, -v4
 v_fma_f32 v55, v139, s64, -v4
 v_fma_f32 v56, v140, s64, -v4
 v_fma_f32 v57, v141, s64, -v4
 v_fma_f32 v58, v142, s64, -v4
 v_fma_f32 v59, v143, s64, -v4
 v_exp_f32 v52, v52
 v_exp_f32 v53, v53
 v_exp_f32 v54, v54
 v_exp_f32 v55, v55
 v_exp_f32 v56, v56
 v_exp_f32 v57, v57
 v_exp_f32 v58, v58
 v_exp_f32 v59, v59
 v_cvt_pk_bf16_f32 v132, v52, v53
 v_cvt_pk_bf16_f32 v133, v54, v55
 v_cvt_pk_bf16_f32 v134, v56, v57
 v_cvt_pk_bf16_f32 v135, v58, v59
 s_waitcnt vmcnt(8)
 s_waitcnt vmcnt(4)
 s_barrier
 s_add_u32 m0, s65, 65536
 s_add_u32 s59, s60, 65536
 s_waitcnt lgkmcnt(15)
 v_mfma_f32_16x16x32_bf16 a[128:131], a[0:3], v[128:131], 0
 ds_read_b64_tr_b16 a[64:65], v22 offset:16384
 ds_read_b64_tr_b16 a[66:67], v22 offset:20480
 v_fma_f32 v52, v144, s64, -v4
 v_mfma_f32_16x16x32_bf16 a[132:135], a[4:7], v[128:131], 0
 ds_read_b64_tr_b16 a[68:69], v23 offset:16384
 ds_read_b64_tr_b16 a[70:71], v23 offset:20480
 v_fma_f32 v53, v145, s64, -v4
 v_mfma_f32_16x16x32_bf16 a[136:139], a[8:11], v[128:131], 0
 ds_read_b64_tr_b16 a[72:73], v24 offset:16384
 ds_read_b64_tr_b16 a[74:75], v24 offset:20480
 v_fma_f32 v54, v146, s64, -v4
 v_mfma_f32_16x16x32_bf16 a[140:143], a[12:15], v[128:131], 0
 buffer_load_dwordx4 v12, s[20:23], s59 offen offset:0 nt lds
 v_fma_f32 v55, v147, s64, -v4
 v_fma_f32 v56, v148, s64, -v4
 v_fma_f32 v57, v149, s64, -v4
 v_fma_f32 v58, v150, s64, -v4
 v_mfma_f32_16x16x32_bf16 a[144:147], a[16:19], v[128:131], 0
 ds_read_b64_tr_b16 a[76:77], v25 offset:16384
 ds_read_b64_tr_b16 a[78:79], v25 offset:20480
 v_fma_f32 v59, v151, s64, -v4
 v_mfma_f32_16x16x32_bf16 a[148:151], a[20:23], v[128:131], 0
 ds_read_b64_tr_b16 a[80:81], v26 offset:16384
 ds_read_b64_tr_b16 a[82:83], v26 offset:20480
 v_exp_f32 v52, v52
 v_mfma_f32_16x16x32_bf16 a[152:155], a[24:27], v[128:131], 0
 ds_read_b64_tr_b16 a[84:85], v27 offset:16384
 ds_read_b64_tr_b16 a[86:87], v27 offset:20480
 v_exp_f32 v53, v53
 v_mfma_f32_16x16x32_bf16 a[156:159], a[28:31], v[128:131], 0
 buffer_load_dwordx4 v13, s[20:23], s59 offen offset:1024 nt lds
 v_exp_f32 v54, v54
 v_exp_f32 v55, v55
 v_exp_f32 v56, v56
 v_exp_f32 v57, v57
 v_mfma_f32_16x16x32_bf16 a[160:163], a[168:171], v[128:131], 0
 ds_read_b64_tr_b16 a[88:89], v28 offset:16384
 ds_read_b64_tr_b16 a[90:91], v28 offset:20480
 v_exp_f32 v58, v58
 s_waitcnt lgkmcnt(15)
 v_mfma_f32_16x16x32_bf16 a[128:131], a[32:35], v[132:135], a[128:131]
 ds_read_b64_tr_b16 a[92:93], v29 offset:16384
 ds_read_b64_tr_b16 a[94:95], v29 offset:20480
 v_exp_f32 v59, v59
 v_mfma_f32_16x16x32_bf16 a[132:135], a[36:39], v[132:135], a[132:135]
 ds_read_b64_tr_b16 a[96:97], v22 offset:24576
 ds_read_b64_tr_b16 a[98:99], v22 offset:28672
 v_cvt_pk_bf16_f32 v136, v52, v53
 v_mfma_f32_16x16x32_bf16 a[136:139], a[40:43], v[132:135], a[136:139]
 buffer_load_dwordx4 v12, s[20:23], s59 offen offset:2048 nt lds
 v_cvt_pk_bf16_f32 v137, v54, v55
 v_cvt_pk_bf16_f32 v138, v56, v57
 v_cvt_pk_bf16_f32 v139, v58, v59
 v_fma_f32 v52, v152, s64, -v4
 v_mfma_f32_16x16x32_bf16 a[140:143], a[44:47], v[132:135], a[140:143]
 ds_read_b64_tr_b16 a[100:101], v23 offset:24576
 ds_read_b64_tr_b16 a[102:103], v23 offset:28672
 v_fma_f32 v53, v153, s64, -v4
 v_mfma_f32_16x16x32_bf16 a[144:147], a[48:51], v[132:135], a[144:147]
 ds_read_b64_tr_b16 a[104:105], v24 offset:24576
 ds_read_b64_tr_b16 a[106:107], v24 offset:28672
 v_fma_f32 v54, v154, s64, -v4
 v_mfma_f32_16x16x32_bf16 a[148:151], a[52:55], v[132:135], a[148:151]
 ds_read_b64_tr_b16 a[108:109], v25 offset:24576
 ds_read_b64_tr_b16 a[110:111], v25 offset:28672
 v_fma_f32 v55, v155, s64, -v4
 v_mfma_f32_16x16x32_bf16 a[152:155], a[56:59], v[132:135], a[152:155]
 buffer_load_dwordx4 v13, s[20:23], s59 offen offset:3072 nt lds
 v_fma_f32 v56, v156, s64, -v4
 v_fma_f32 v57, v157, s64, -v4
 v_fma_f32 v58, v158, s64, -v4
 v_fma_f32 v59, v159, s64, -v4
 s_waitcnt lgkmcnt(15)
 v_mfma_f32_16x16x32_bf16 a[156:159], a[60:63], v[132:135], a[156:159]
 ds_read_b64_tr_b16 a[112:113], v26 offset:24576
 ds_read_b64_tr_b16 a[114:115], v26 offset:28672
 ds_read_b64_tr_b16 a[116:117], v27 offset:24576
 ds_read_b64_tr_b16 a[118:119], v27 offset:28672
 v_exp_f32 v52, v52
 v_exp_f32 v53, v53
 v_mfma_f32_16x16x32_bf16 a[160:163], a[168:171], v[132:135], a[160:163]
 ds_read_b64_tr_b16 a[120:121], v28 offset:24576
 ds_read_b64_tr_b16 a[122:123], v28 offset:28672
 ds_read_b64_tr_b16 a[124:125], v29 offset:24576
 ds_read_b64_tr_b16 a[126:127], v29 offset:28672
 v_exp_f32 v54, v54
 v_exp_f32 v55, v55
 v_exp_f32 v56, v56
 v_exp_f32 v57, v57
 v_exp_f32 v58, v58
 v_exp_f32 v59, v59
 v_cvt_pk_bf16_f32 v140, v52, v53
 v_cvt_pk_bf16_f32 v141, v54, v55
 v_cvt_pk_bf16_f32 v142, v56, v57
 v_cvt_pk_bf16_f32 v143, v58, v59
 s_waitcnt vmcnt(8)
 s_waitcnt vmcnt(4)
 s_barrier
 s_add_u32 m0, s65, 81920
 s_add_u32 s59, s60, 81920
 v_mfma_f32_16x16x32_bf16 a[128:131], a[64:67], v[136:139], a[128:131]
 ds_read_b64_tr_b16 a[0:1], v22 offset:32768
 ds_read_b64_tr_b16 a[2:3], v22 offset:36864
 v_fma_f32 v52, v160, s64, -v4
 v_mfma_f32_16x16x32_bf16 a[132:135], a[68:71], v[136:139], a[132:135]
 ds_read_b64_tr_b16 a[4:5], v23 offset:32768
 ds_read_b64_tr_b16 a[6:7], v23 offset:36864
 v_fma_f32 v53, v161, s64, -v4
 v_mfma_f32_16x16x32_bf16 a[136:139], a[72:75], v[136:139], a[136:139]
 ds_read_b64_tr_b16 a[8:9], v24 offset:32768
 ds_read_b64_tr_b16 a[10:11], v24 offset:36864
 v_fma_f32 v54, v162, s64, -v4
 v_mfma_f32_16x16x32_bf16 a[140:143], a[76:79], v[136:139], a[140:143]
 buffer_load_dwordx4 v12, s[20:23], s59 offen offset:0 nt lds
 v_fma_f32 v55, v163, s64, -v4
 v_fma_f32 v56, v164, s64, -v4
 v_fma_f32 v57, v165, s64, -v4
 v_fma_f32 v58, v166, s64, -v4
 s_waitcnt lgkmcnt(15)
 v_mfma_f32_16x16x32_bf16 a[144:147], a[80:83], v[136:139], a[144:147]
 ds_read_b64_tr_b16 a[12:13], v25 offset:32768
 ds_read_b64_tr_b16 a[14:15], v25 offset:36864
 v_fma_f32 v59, v167, s64, -v4
 v_mfma_f32_16x16x32_bf16 a[148:151], a[84:87], v[136:139], a[148:151]
 ds_read_b64_tr_b16 a[16:17], v26 offset:32768
 ds_read_b64_tr_b16 a[18:19], v26 offset:36864
 v_exp_f32 v52, v52
 v_mfma_f32_16x16x32_bf16 a[152:155], a[88:91], v[136:139], a[152:155]
 ds_read_b64_tr_b16 a[20:21], v27 offset:32768
 ds_read_b64_tr_b16 a[22:23], v27 offset:36864
 v_exp_f32 v53, v53
 v_mfma_f32_16x16x32_bf16 a[156:159], a[92:95], v[136:139], a[156:159]
 buffer_load_dwordx4 v13, s[20:23], s59 offen offset:1024 nt lds
 v_exp_f32 v54, v54
 v_exp_f32 v55, v55
 v_exp_f32 v56, v56
 v_exp_f32 v57, v57
 v_mfma_f32_16x16x32_bf16 a[160:163], a[168:171], v[136:139], a[160:163]
 ds_read_b64_tr_b16 a[24:25], v28 offset:32768
 ds_read_b64_tr_b16 a[26:27], v28 offset:36864
 v_exp_f32 v58, v58
 v_mfma_f32_16x16x32_bf16 a[128:131], a[96:99], v[140:143], a[128:131]
 ds_read_b64_tr_b16 a[28:29], v29 offset:32768
 ds_read_b64_tr_b16 a[30:31], v29 offset:36864
 v_exp_f32 v59, v59
 v_mfma_f32_16x16x32_bf16 a[132:135], a[100:103], v[140:143], a[132:135]
 ds_read_b64_tr_b16 a[32:33], v22 offset:40960
 ds_read_b64_tr_b16 a[34:35], v22 offset:45056
 v_cvt_pk_bf16_f32 v144, v52, v53
 v_mfma_f32_16x16x32_bf16 a[136:139], a[104:107], v[140:143], a[136:139]
 buffer_load_dwordx4 v12, s[20:23], s59 offen offset:2048 nt lds
 v_cvt_pk_bf16_f32 v145, v54, v55
 v_cvt_pk_bf16_f32 v146, v56, v57
 v_cvt_pk_bf16_f32 v147, v58, v59
 v_fma_f32 v52, v168, s64, -v4
 s_waitcnt lgkmcnt(15)
 v_mfma_f32_16x16x32_bf16 a[140:143], a[108:111], v[140:143], a[140:143]
 ds_read_b64_tr_b16 a[36:37], v23 offset:40960
 ds_read_b64_tr_b16 a[38:39], v23 offset:45056
 v_fma_f32 v53, v169, s64, -v4
 v_mfma_f32_16x16x32_bf16 a[144:147], a[112:115], v[140:143], a[144:147]
 ds_read_b64_tr_b16 a[40:41], v24 offset:40960
 ds_read_b64_tr_b16 a[42:43], v24 offset:45056
 v_fma_f32 v54, v170, s64, -v4
 v_mfma_f32_16x16x32_bf16 a[148:151], a[116:119], v[140:143], a[148:151]
 ds_read_b64_tr_b16 a[44:45], v25 offset:40960
 ds_read_b64_tr_b16 a[46:47], v25 offset:45056
 v_fma_f32 v55, v171, s64, -v4
 v_mfma_f32_16x16x32_bf16 a[152:155], a[120:123], v[140:143], a[152:155]
 buffer_load_dwordx4 v13, s[20:23], s59 offen offset:3072 nt lds
 v_fma_f32 v56, v172, s64, -v4
 v_fma_f32 v57, v173, s64, -v4
 v_fma_f32 v58, v174, s64, -v4
 v_fma_f32 v59, v175, s64, -v4
 v_mfma_f32_16x16x32_bf16 a[156:159], a[124:127], v[140:143], a[156:159]
 ds_read_b64_tr_b16 a[48:49], v26 offset:40960
 ds_read_b64_tr_b16 a[50:51], v26 offset:45056
 ds_read_b64_tr_b16 a[52:53], v27 offset:40960
 ds_read_b64_tr_b16 a[54:55], v27 offset:45056
 v_exp_f32 v52, v52
 v_exp_f32 v53, v53
 v_mfma_f32_16x16x32_bf16 a[160:163], a[168:171], v[140:143], a[160:163]
 ds_read_b64_tr_b16 a[56:57], v28 offset:40960
 ds_read_b64_tr_b16 a[58:59], v28 offset:45056
 ds_read_b64_tr_b16 a[60:61], v29 offset:40960
 ds_read_b64_tr_b16 a[62:63], v29 offset:45056
 v_exp_f32 v54, v54
 v_exp_f32 v55, v55
 v_exp_f32 v56, v56
 v_exp_f32 v57, v57
 v_exp_f32 v58, v58
 v_exp_f32 v59, v59
 v_cvt_pk_bf16_f32 v148, v52, v53
 v_cvt_pk_bf16_f32 v149, v54, v55
 v_cvt_pk_bf16_f32 v150, v56, v57
 v_cvt_pk_bf16_f32 v151, v58, v59
 s_waitcnt vmcnt(8)
 s_waitcnt vmcnt(4)
 s_barrier
 s_add_u32 m0, s65, 98304
 s_add_u32 s59, s60, 98304
 v_mfma_f32_16x16x32_bf16 a[128:131], a[0:3], v[144:147], a[128:131]
 ds_read_b64_tr_b16 a[64:65], v22 offset:49152
 ds_read_b64_tr_b16 a[66:67], v22 offset:53248
 v_fma_f32 v52, v176, s64, -v4
 s_waitcnt lgkmcnt(15)
 v_mfma_f32_16x16x32_bf16 a[132:135], a[4:7], v[144:147], a[132:135]
 ds_read_b64_tr_b16 a[68:69], v23 offset:49152
 ds_read_b64_tr_b16 a[70:71], v23 offset:53248
 v_fma_f32 v53, v177, s64, -v4
 v_mfma_f32_16x16x32_bf16 a[136:139], a[8:11], v[144:147], a[136:139]
 ds_read_b64_tr_b16 a[72:73], v24 offset:49152
 ds_read_b64_tr_b16 a[74:75], v24 offset:53248
 v_fma_f32 v54, v178, s64, -v4
 v_mfma_f32_16x16x32_bf16 a[140:143], a[12:15], v[144:147], a[140:143]
 buffer_load_dwordx4 v12, s[20:23], s59 offen offset:0 nt lds
 v_fma_f32 v55, v179, s64, -v4
 v_fma_f32 v56, v180, s64, -v4
 v_fma_f32 v57, v181, s64, -v4
 v_fma_f32 v58, v182, s64, -v4
 v_mfma_f32_16x16x32_bf16 a[144:147], a[16:19], v[144:147], a[144:147]
 ds_read_b64_tr_b16 a[76:77], v25 offset:49152
 ds_read_b64_tr_b16 a[78:79], v25 offset:53248
 v_fma_f32 v59, v183, s64, -v4
 v_mfma_f32_16x16x32_bf16 a[148:151], a[20:23], v[144:147], a[148:151]
 ds_read_b64_tr_b16 a[80:81], v26 offset:49152
 ds_read_b64_tr_b16 a[82:83], v26 offset:53248
 v_exp_f32 v52, v52
 v_mfma_f32_16x16x32_bf16 a[152:155], a[24:27], v[144:147], a[152:155]
 ds_read_b64_tr_b16 a[84:85], v27 offset:49152
 ds_read_b64_tr_b16 a[86:87], v27 offset:53248
 v_exp_f32 v53, v53
 v_mfma_f32_16x16x32_bf16 a[156:159], a[28:31], v[144:147], a[156:159]
 buffer_load_dwordx4 v13, s[20:23], s59 offen offset:1024 nt lds
 v_exp_f32 v54, v54
 v_exp_f32 v55, v55
 v_exp_f32 v56, v56
 v_exp_f32 v57, v57
 v_mfma_f32_16x16x32_bf16 a[160:163], a[168:171], v[144:147], a[160:163]
 ds_read_b64_tr_b16 a[88:89], v28 offset:49152
 ds_read_b64_tr_b16 a[90:91], v28 offset:53248
 v_exp_f32 v58, v58
 v_mfma_f32_16x16x32_bf16 a[128:131], a[32:35], v[148:151], a[128:131]
 ds_read_b64_tr_b16 a[92:93], v29 offset:49152
 ds_read_b64_tr_b16 a[94:95], v29 offset:53248
 v_exp_f32 v59, v59
 s_waitcnt lgkmcnt(15)
 v_mfma_f32_16x16x32_bf16 a[132:135], a[36:39], v[148:151], a[132:135]
 ds_read_b64_tr_b16 a[96:97], v22 offset:57344
 ds_read_b64_tr_b16 a[98:99], v22 offset:61440
 v_cvt_pk_bf16_f32 v152, v52, v53
 v_mfma_f32_16x16x32_bf16 a[136:139], a[40:43], v[148:151], a[136:139]
 buffer_load_dwordx4 v12, s[20:23], s59 offen offset:2048 nt lds
 v_cvt_pk_bf16_f32 v153, v54, v55
 v_cvt_pk_bf16_f32 v154, v56, v57
 v_cvt_pk_bf16_f32 v155, v58, v59
 v_fma_f32 v52, v184, s64, -v4
 v_mfma_f32_16x16x32_bf16 a[140:143], a[44:47], v[148:151], a[140:143]
 ds_read_b64_tr_b16 a[100:101], v23 offset:57344
 ds_read_b64_tr_b16 a[102:103], v23 offset:61440
 v_fma_f32 v53, v185, s64, -v4
 v_mfma_f32_16x16x32_bf16 a[144:147], a[48:51], v[148:151], a[144:147]
 ds_read_b64_tr_b16 a[104:105], v24 offset:57344
 ds_read_b64_tr_b16 a[106:107], v24 offset:61440
 v_fma_f32 v54, v186, s64, -v4
 v_mfma_f32_16x16x32_bf16 a[148:151], a[52:55], v[148:151], a[148:151]
 ds_read_b64_tr_b16 a[108:109], v25 offset:57344
 ds_read_b64_tr_b16 a[110:111], v25 offset:61440
 v_fma_f32 v55, v187, s64, -v4
 v_mfma_f32_16x16x32_bf16 a[152:155], a[56:59], v[148:151], a[152:155]
 buffer_load_dwordx4 v13, s[20:23], s59 offen offset:3072 nt lds
 v_fma_f32 v56, v188, s64, -v4
 v_fma_f32 v57, v189, s64, -v4
 v_fma_f32 v58, v190, s64, -v4
 v_fma_f32 v59, v191, s64, -v4
 v_mfma_f32_16x16x32_bf16 a[156:159], a[60:63], v[148:151], a[156:159]
 ds_read_b64_tr_b16 a[112:113], v26 offset:57344
 ds_read_b64_tr_b16 a[114:115], v26 offset:61440
 ds_read_b64_tr_b16 a[116:117], v27 offset:57344
 ds_read_b64_tr_b16 a[118:119], v27 offset:61440
 v_exp_f32 v52, v52
 v_exp_f32 v53, v53
 v_mfma_f32_16x16x32_bf16 a[160:163], a[168:171], v[148:151], a[160:163]
 ds_read_b64_tr_b16 a[120:121], v28 offset:57344
 ds_read_b64_tr_b16 a[122:123], v28 offset:61440
 ds_read_b64_tr_b16 a[124:125], v29 offset:57344
 ds_read_b64_tr_b16 a[126:127], v29 offset:61440
 v_exp_f32 v54, v54
 v_exp_f32 v55, v55
 v_exp_f32 v56, v56
 v_exp_f32 v57, v57
 v_exp_f32 v58, v58
 v_exp_f32 v59, v59
 v_cvt_pk_bf16_f32 v156, v52, v53
 v_cvt_pk_bf16_f32 v157, v54, v55
 v_cvt_pk_bf16_f32 v158, v56, v57
 v_cvt_pk_bf16_f32 v159, v58, v59
 s_waitcnt vmcnt(8)
 s_waitcnt vmcnt(4)
 s_barrier
 s_add_u32 m0, s65, 114688
 s_add_u32 s59, s60, 114688
 s_waitcnt lgkmcnt(15)
 v_mfma_f32_16x16x32_bf16 a[128:131], a[64:67], v[152:155], a[128:131]
 ds_read_b64_tr_b16 a[0:1], v30 offset:0
 ds_read_b64_tr_b16 a[2:3], v30 offset:4096
 v_fma_f32 v52, v192, s64, -v4
 v_mfma_f32_16x16x32_bf16 a[132:135], a[68:71], v[152:155], a[132:135]
 ds_read_b64_tr_b16 a[4:5], v31 offset:0
 ds_read_b64_tr_b16 a[6:7], v31 offset:4096
 v_fma_f32 v53, v193, s64, -v4
 v_mfma_f32_16x16x32_bf16 a[136:139], a[72:75], v[152:155], a[136:139]
 ds_read_b64_tr_b16 a[8:9], v32 offset:0
 ds_read_b64_tr_b16 a[10:11], v32 offset:4096
 v_fma_f32 v54, v194, s64, -v4
 v_mfma_f32_16x16x32_bf16 a[140:143], a[76:79], v[152:155], a[140:143]
 buffer_load_dwordx4 v12, s[20:23], s59 offen offset:0 nt lds
 v_fma_f32 v55, v195, s64, -v4
 v_fma_f32 v56, v196, s64, -v4
 v_fma_f32 v57, v197, s64, -v4
 v_fma_f32 v58, v198, s64, -v4
 v_mfma_f32_16x16x32_bf16 a[144:147], a[80:83], v[152:155], a[144:147]
 ds_read_b64_tr_b16 a[12:13], v33 offset:0
 ds_read_b64_tr_b16 a[14:15], v33 offset:4096
 v_fma_f32 v59, v199, s64, -v4
 v_mfma_f32_16x16x32_bf16 a[148:151], a[84:87], v[152:155], a[148:151]
 ds_read_b64_tr_b16 a[16:17], v34 offset:0
 ds_read_b64_tr_b16 a[18:19], v34 offset:4096
 v_exp_f32 v52, v52
 v_mfma_f32_16x16x32_bf16 a[152:155], a[88:91], v[152:155], a[152:155]
 ds_read_b64_tr_b16 a[20:21], v35 offset:0
 ds_read_b64_tr_b16 a[22:23], v35 offset:4096
 v_exp_f32 v53, v53
 v_mfma_f32_16x16x32_bf16 a[156:159], a[92:95], v[152:155], a[156:159]
 buffer_load_dwordx4 v13, s[20:23], s59 offen offset:1024 nt lds
 v_exp_f32 v54, v54
 v_exp_f32 v55, v55
 v_exp_f32 v56, v56
 v_exp_f32 v57, v57
 v_mfma_f32_16x16x32_bf16 a[160:163], a[168:171], v[152:155], a[160:163]
 ds_read_b64_tr_b16 a[24:25], v36 offset:0
 ds_read_b64_tr_b16 a[26:27], v36 offset:4096
 v_exp_f32 v58, v58
 s_waitcnt lgkmcnt(15)
 v_mfma_f32_16x16x32_bf16 a[128:131], a[96:99], v[156:159], a[128:131]
 ds_read_b64_tr_b16 a[28:29], v37 offset:0
 ds_read_b64_tr_b16 a[30:31], v37 offset:4096
 v_exp_f32 v59, v59
 v_mfma_f32_16x16x32_bf16 a[132:135], a[100:103], v[156:159], a[132:135]
 ds_read_b64_tr_b16 a[32:33], v30 offset:8192
 ds_read_b64_tr_b16 a[34:35], v30 offset:12288
 v_cvt_pk_bf16_f32 v160, v52, v53
 v_mfma_f32_16x16x32_bf16 a[136:139], a[104:107], v[156:159], a[136:139]
 buffer_load_dwordx4 v12, s[20:23], s59 offen offset:2048 nt lds
 v_cvt_pk_bf16_f32 v161, v54, v55
 v_cvt_pk_bf16_f32 v162, v56, v57
 v_cvt_pk_bf16_f32 v163, v58, v59
 v_fma_f32 v52, v200, s64, -v4
 v_mfma_f32_16x16x32_bf16 a[140:143], a[108:111], v[156:159], a[140:143]
 ds_read_b64_tr_b16 a[36:37], v31 offset:8192
 ds_read_b64_tr_b16 a[38:39], v31 offset:12288
 v_fma_f32 v53, v201, s64, -v4
 v_mfma_f32_16x16x32_bf16 a[144:147], a[112:115], v[156:159], a[144:147]
 ds_read_b64_tr_b16 a[40:41], v32 offset:8192
 ds_read_b64_tr_b16 a[42:43], v32 offset:12288
 v_fma_f32 v54, v202, s64, -v4
 v_mfma_f32_16x16x32_bf16 a[148:151], a[116:119], v[156:159], a[148:151]
 ds_read_b64_tr_b16 a[44:45], v33 offset:8192
 ds_read_b64_tr_b16 a[46:47], v33 offset:12288
 v_fma_f32 v55, v203, s64, -v4
 v_mfma_f32_16x16x32_bf16 a[152:155], a[120:123], v[156:159], a[152:155]
 buffer_load_dwordx4 v13, s[20:23], s59 offen offset:3072 nt lds
 v_fma_f32 v56, v204, s64, -v4
 v_fma_f32 v57, v205, s64, -v4
 v_fma_f32 v58, v206, s64, -v4
 v_fma_f32 v59, v207, s64, -v4
 s_waitcnt lgkmcnt(15)
 v_mfma_f32_16x16x32_bf16 a[156:159], a[124:127], v[156:159], a[156:159]
 ds_read_b64_tr_b16 a[48:49], v34 offset:8192
 ds_read_b64_tr_b16 a[50:51], v34 offset:12288
 ds_read_b64_tr_b16 a[52:53], v35 offset:8192
 ds_read_b64_tr_b16 a[54:55], v35 offset:12288
 v_exp_f32 v52, v52
 v_exp_f32 v53, v53
 v_mfma_f32_16x16x32_bf16 a[160:163], a[168:171], v[156:159], a[160:163]
 ds_read_b64_tr_b16 a[56:57], v36 offset:8192
 ds_read_b64_tr_b16 a[58:59], v36 offset:12288
 ds_read_b64_tr_b16 a[60:61], v37 offset:8192
 ds_read_b64_tr_b16 a[62:63], v37 offset:12288
 v_exp_f32 v54, v54
 v_exp_f32 v55, v55
 v_exp_f32 v56, v56
 v_exp_f32 v57, v57
 v_exp_f32 v58, v58
 v_exp_f32 v59, v59
 v_cvt_pk_bf16_f32 v164, v52, v53
 v_cvt_pk_bf16_f32 v165, v54, v55
 v_cvt_pk_bf16_f32 v166, v56, v57
 v_cvt_pk_bf16_f32 v167, v58, v59
 s_waitcnt vmcnt(8)
 s_waitcnt vmcnt(4)
 s_barrier
 s_cmp_eq_u32 s5, 1
 s_cbranch_scc1 L_HO0
 s_add_u32 m0, s65, 0
 s_add_u32 s59, s61, 0
 buffer_load_dwordx4 v8, s[24:27], s59 offen offset:0 nt lds
 buffer_load_dwordx4 v9, s[24:27], s59 offen offset:1024 nt lds
 buffer_load_dwordx4 v10, s[24:27], s59 offen offset:2048 nt lds
 buffer_load_dwordx4 v11, s[24:27], s59 offen offset:3072 nt lds
 s_branch L_HJ0
L_HO0:
 s_add_u32 s59, s52, 0
 s_and_b32 s59, s59, 7
 s_or_b32 s59, s59, 0
 s_lshl_b32 s59, s59, 17
 s_add_u32 m0, s65, 0
 s_add_u32 s59, s59, s75
 buffer_load_dwordx4 v40, s[32:35], s59 offen offset:0 lds
 buffer_load_dwordx4 v41, s[32:35], s59 offen offset:1024 lds
 buffer_load_dwordx4 v42, s[32:35], s59 offen offset:2048 lds
 buffer_load_dwordx4 v43, s[32:35], s59 offen offset:3072 lds
L_HJ0:
 v_mfma_f32_16x16x32_bf16 a[128:131], a[0:3], v[160:163], a[128:131]
 ds_read_b64_tr_b16 a[64:65], v30 offset:16384
 ds_read_b64_tr_b16 a[66:67], v30 offset:20480
 v_fma_f32 v52, v208, s64, -v4
 v_mfma_f32_16x16x32_bf16 a[132:135], a[4:7], v[160:163], a[132:135]
 ds_read_b64_tr_b16 a[68:69], v31 offset:16384
 ds_read_b64_tr_b16 a[70:71], v31 offset:20480
 v_fma_f32 v53, v209, s64, -v4
 v_mfma_f32_16x16x32_bf16 a[136:139], a[8:11], v[160:163], a[136:139]
 ds_read_b64_tr_b16 a[72:73], v32 offset:16384
 ds_read_b64_tr_b16 a[74:75], v32 offset:20480
 v_fma_f32 v54, v210, s64, -v4
 v_mfma_f32_16x16x32_bf16 a[140:143], a[12:15], v[160:163], a[140:143]
 v_fma_f32 v55, v211, s64, -v4
 v_fma_f32 v56, v212, s64, -v4
 v_fma_f32 v57, v213, s64, -v4
 v_fma_f32 v58, v214, s64, -v4
 s_waitcnt lgkmcnt(15)
 v_mfma_f32_16x16x32_bf16 a[144:147], a[16:19], v[160:163], a[144:147]
 ds_read_b64_tr_b16 a[76:77], v33 offset:16384
 ds_read_b64_tr_b16 a[78:79], v33 offset:20480
 v_fma_f32 v59, v215, s64, -v4
 v_mfma_f32_16x16x32_bf16 a[148:151], a[20:23], v[160:163], a[148:151]
 ds_read_b64_tr_b16 a[80:81], v34 offset:16384
 ds_read_b64_tr_b16 a[82:83], v34 offset:20480
 v_exp_f32 v52, v52
 v_mfma_f32_16x16x32_bf16 a[152:155], a[24:27], v[160:163], a[152:155]
 ds_read_b64_tr_b16 a[84:85], v35 offset:16384
 ds_read_b64_tr_b16 a[86:87], v35 offset:20480
 v_exp_f32 v53, v53
 v_mfma_f32_16x16x32_bf16 a[156:159], a[28:31], v[160:163], a[156:159]
 v_exp_f32 v54, v54
 v_exp_f32 v55, v55
 v_exp_f32 v56, v56
 v_exp_f32 v57, v57
 v_mfma_f32_16x16x32_bf16 a[160:163], a[168:171], v[160:163], a[160:163]
 ds_read_b64_tr_b16 a[88:89], v36 offset:16384
 ds_read_b64_tr_b16 a[90:91], v36 offset:20480
 v_exp_f32 v58, v58
 v_mfma_f32_16x16x32_bf16 a[128:131], a[32:35], v[164:167], a[128:131]
 ds_read_b64_tr_b16 a[92:93], v37 offset:16384
 ds_read_b64_tr_b16 a[94:95], v37 offset:20480
 v_exp_f32 v59, v59
 v_mfma_f32_16x16x32_bf16 a[132:135], a[36:39], v[164:167], a[132:135]
 ds_read_b64_tr_b16 a[96:97], v30 offset:24576
 ds_read_b64_tr_b16 a[98:99], v30 offset:28672
 v_cvt_pk_bf16_f32 v168, v52, v53
 v_mfma_f32_16x16x32_bf16 a[136:139], a[40:43], v[164:167], a[136:139]
 v_cvt_pk_bf16_f32 v169, v54, v55
 v_cvt_pk_bf16_f32 v170, v56, v57
 v_cvt_pk_bf16_f32 v171, v58, v59
 v_fma_f32 v52, v216, s64, -v4
 s_waitcnt lgkmcnt(15)
 v_mfma_f32_16x16x32_bf16 a[140:143], a[44:47], v[164:167], a[140:143]
 ds_read_b64_tr_b16 a[100:101], v31 offset:24576
 ds_read_b64_tr_b16 a[102:103], v31 offset:28672
 v_fma_f32 v53, v217, s64, -v4
 v_mfma_f32_16x16x32_bf16 a[144:147], a[48:51], v[164:167], a[144:147]
 ds_read_b64_tr_b16 a[104:105], v32 offset:24576
 ds_read_b64_tr_b16 a[106:107], v32 offset:28672
 v_fma_f32 v54, v218, s64, -v4
 v_mfma_f32_16x16x32_bf16 a[148:151], a[52:55], v[164:167], a[148:151]
 ds_read_b64_tr_b16 a[108:109], v33 offset:24576
 ds_read_b64_tr_b16 a[110:111], v33 offset:28672
 v_fma_f32 v55, v219, s64, -v4
 v_mfma_f32_16x16x32_bf16 a[152:155], a[56:59], v[164:167], a[152:155]
 v_fma_f32 v56, v220, s64, -v4
 v_fma_f32 v57, v221, s64, -v4
 v_fma_f32 v58, v222, s64, -v4
 v_fma_f32 v59, v223, s64, -v4
 v_mfma_f32_16x16x32_bf16 a[156:159], a[60:63], v[164:167], a[156:159]
 ds_read_b64_tr_b16 a[112:113], v34 offset:24576
 ds_read_b64_tr_b16 a[114:115], v34 offset:28672
 ds_read_b64_tr_b16 a[116:117], v35 offset:24576
 ds_read_b64_tr_b16 a[118:119], v35 offset:28672
 v_exp_f32 v52, v52
 v_exp_f32 v53, v53
 v_mfma_f32_16x16x32_bf16 a[160:163], a[168:171], v[164:167], a[160:163]
 ds_read_b64_tr_b16 a[120:121], v36 offset:24576
 ds_read_b64_tr_b16 a[122:123], v36 offset:28672
 ds_read_b64_tr_b16 a[124:125], v37 offset:24576
 ds_read_b64_tr_b16 a[126:127], v37 offset:28672
 v_exp_f32 v54, v54
 v_exp_f32 v55, v55
 v_exp_f32 v56, v56
 v_exp_f32 v57, v57
 v_exp_f32 v58, v58
 v_exp_f32 v59, v59
 v_cvt_pk_bf16_f32 v172, v52, v53
 v_cvt_pk_bf16_f32 v173, v54, v55
 v_cvt_pk_bf16_f32 v174, v56, v57
 v_cvt_pk_bf16_f32 v175, v58, v59
 s_waitcnt vmcnt(8)
 s_waitcnt vmcnt(4)
 s_barrier
 s_cmp_eq_u32 s5, 1
 s_cbranch_scc1 L_HO1
 s_add_u32 m0, s65, 16384
 s_add_u32 s59, s61, 16384
 buffer_load_dwordx4 v8, s[24:27], s59 offen offset:0 nt lds
 buffer_load_dwordx4 v9, s[24:27], s59 offen offset:1024 nt lds
 buffer_load_dwordx4 v10, s[24:27], s59 offen offset:2048 nt lds
 buffer_load_dwordx4 v11, s[24:27], s59 offen offset:3072 nt lds
 s_branch L_HJ1
L_HO1:
 s_add_u32 s59, s52, 1
 s_and_b32 s59, s59, 7
 s_or_b32 s59, s59, 0
 s_lshl_b32 s59, s59, 17
 s_add_u32 m0, s65, 16384
 s_add_u32 s59, s59, s75
 buffer_load_dwordx4 v40, s[32:35], s59 offen offset:0 lds
 buffer_load_dwordx4 v41, s[32:35], s59 offen offset:1024 lds
 buffer_load_dwordx4 v42, s[32:35], s59 offen offset:2048 lds
 buffer_load_dwordx4 v43, s[32:35], s59 offen offset:3072 lds
L_HJ1:
 v_mfma_f32_16x16x32_bf16 a[128:131], a[64:67], v[168:171], a[128:131]
 ds_read_b64_tr_b16 a[0:1], v30 offset:32768
 ds_read_b64_tr_b16 a[2:3], v30 offset:36864
 v_fma_f32 v52, v224, s64, -v4
 s_waitcnt lgkmcnt(15)
 v_mfma_f32_16x16x32_bf16 a[132:135], a[68:71], v[168:171], a[132:135]
 ds_read_b64_tr_b16 a[4:5], v31 offset:32768
 ds_read_b64_tr_b16 a[6:7], v31 offset:36864
 v_fma_f32 v53, v225, s64, -v4
 v_mfma_f32_16x16x32_bf16 a[136:139], a[72:75], v[168:171], a[136:139]
 ds_read_b64_tr_b16 a[8:9], v32 offset:32768
 ds_read_b64_tr_b16 a[10:11], v32 offset:36864
 v_fma_f32 v54, v226, s64, -v4
 v_mfma_f32_16x16x32_bf16 a[140:143], a[76:79], v[168:171], a[140:143]
 v_fma_f32 v55, v227, s64, -v4
 v_fma_f32 v56, v228, s64, -v4
 v_fma_f32 v57, v229, s64, -v4
 v_fma_f32 v58, v230, s64, -v4
 v_mfma_f32_16x16x32_bf16 a[144:147], a[80:83], v[168:171], a[144:147]
 ds_read_b64_tr_b16 a[12:13], v33 offset:32768
 ds_read_b64_tr_b16 a[14:15], v33 offset:36864
 v_fma_f32 v59, v231, s64, -v4
 v_mfma_f32_16x16x32_bf16 a[148:151], a[84:87], v[168:171], a[148:151]
 ds_read_b64_tr_b16 a[16:17], v34 offset:32768
 ds_read_b64_tr_b16 a[18:19], v34 offset:36864
 v_exp_f32 v52, v52
 v_mfma_f32_16x16x32_bf16 a[152:155], a[88:91], v[168:171], a[152:155]
 ds_read_b64_tr_b16 a[20:21], v35 offset:32768
 ds_read_b64_tr_b16 a[22:23], v35 offset:36864
 v_exp_f32 v53, v53
 v_mfma_f32_16x16x32_bf16 a[156:159], a[92:95], v[168:171], a[156:159]
 v_exp_f32 v54, v54
 v_exp_f32 v55, v55
 v_exp_f32 v56, v56
 v_exp_f32 v57, v57
 v_mfma_f32_16x16x32_bf16 a[160:163], a[168:171], v[168:171], a[160:163]
 ds_read_b64_tr_b16 a[24:25], v36 offset:32768
 ds_read_b64_tr_b16 a[26:27], v36 offset:36864
 v_exp_f32 v58, v58
 v_mfma_f32_16x16x32_bf16 a[128:131], a[96:99], v[172:175], a[128:131]
 ds_read_b64_tr_b16 a[28:29], v37 offset:32768
 ds_read_b64_tr_b16 a[30:31], v37 offset:36864
 v_exp_f32 v59, v59
 s_waitcnt lgkmcnt(15)
 v_mfma_f32_16x16x32_bf16 a[132:135], a[100:103], v[172:175], a[132:135]
 ds_read_b64_tr_b16 a[32:33], v30 offset:40960
 ds_read_b64_tr_b16 a[34:35], v30 offset:45056
 v_cvt_pk_bf16_f32 v176, v52, v53
 v_mfma_f32_16x16x32_bf16 a[136:139], a[104:107], v[172:175], a[136:139]
 v_cvt_pk_bf16_f32 v177, v54, v55
 v_cvt_pk_bf16_f32 v178, v56, v57
 v_cvt_pk_bf16_f32 v179, v58, v59
 v_fma_f32 v52, v232, s64, -v4
 v_mfma_f32_16x16x32_bf16 a[140:143], a[108:111], v[172:175], a[140:143]
 ds_read_b64_tr_b16 a[36:37], v31 offset:40960
 ds_read_b64_tr_b16 a[38:39], v31 offset:45056
 v_fma_f32 v53, v233, s64, -v4
 v_mfma_f32_16x16x32_bf16 a[144:147], a[112:115], v[172:175], a[144:147]
 ds_read_b64_tr_b16 a[40:41], v32 offset:40960
 ds_read_b64_tr_b16 a[42:43], v32 offset:45056
 v_fma_f32 v54, v234, s64, -v4
 v_mfma_f32_16x16x32_bf16 a[148:151], a[116:119], v[172:175], a[148:151]
 ds_read_b64_tr_b16 a[44:45], v33 offset:40960
 ds_read_b64_tr_b16 a[46:47], v33 offset:45056
 v_fma_f32 v55, v235, s64, -v4
 v_mfma_f32_16x16x32_bf16 a[152:155], a[120:123], v[172:175], a[152:155]
 v_fma_f32 v56, v236, s64, -v4
 v_fma_f32 v57, v237, s64, -v4
 v_fma_f32 v58, v238, s64, -v4
 v_fma_f32 v59, v239, s64, -v4
 v_mfma_f32_16x16x32_bf16 a[156:159], a[124:127], v[172:175], a[156:159]
 ds_read_b64_tr_b16 a[48:49], v34 offset:40960
 ds_read_b64_tr_b16 a[50:51], v34 offset:45056
 ds_read_b64_tr_b16 a[52:53], v35 offset:40960
 ds_read_b64_tr_b16 a[54:55], v35 offset:45056
 v_exp_f32 v52, v52
 v_exp_f32 v53, v53
 v_mfma_f32_16x16x32_bf16 a[160:163], a[168:171], v[172:175], a[160:163]
 ds_read_b64_tr_b16 a[56:57], v36 offset:40960
 ds_read_b64_tr_b16 a[58:59], v36 offset:45056
 ds_read_b64_tr_b16 a[60:61], v37 offset:40960
 ds_read_b64_tr_b16 a[62:63], v37 offset:45056
 v_exp_f32 v54, v54
 v_exp_f32 v55, v55
 v_exp_f32 v56, v56
 v_exp_f32 v57, v57
 v_exp_f32 v58, v58
 v_exp_f32 v59, v59
 v_cvt_pk_bf16_f32 v180, v52, v53
 v_cvt_pk_bf16_f32 v181, v54, v55
 v_cvt_pk_bf16_f32 v182, v56, v57
 v_cvt_pk_bf16_f32 v183, v58, v59
 s_waitcnt vmcnt(8)
 s_waitcnt vmcnt(4)
 s_barrier
 s_cmp_eq_u32 s5, 1
 s_cbranch_scc1 L_HO2
 s_add_u32 m0, s65, 32768
 s_add_u32 s59, s61, 32768
 buffer_load_dwordx4 v8, s[24:27], s59 offen offset:0 nt lds
 buffer_load_dwordx4 v9, s[24:27], s59 offen offset:1024 nt lds
 buffer_load_dwordx4 v10, s[24:27], s59 offen offset:2048 nt lds
 buffer_load_dwordx4 v11, s[24:27], s59 offen offset:3072 nt lds
 s_branch L_HJ2
L_HO2:
 s_add_u32 s59, s52, 2
 s_and_b32 s59, s59, 7
 s_or_b32 s59, s59, 0
 s_lshl_b32 s59, s59, 17
 s_add_u32 m0, s65, 32768
 s_add_u32 s59, s59, s75
 buffer_load_dwordx4 v40, s[32:35], s59 offen offset:0 lds
 buffer_load_dwordx4 v41, s[32:35], s59 offen offset:1024 lds
 buffer_load_dwordx4 v42, s[32:35], s59 offen offset:2048 lds
 buffer_load_dwordx4 v43, s[32:35], s59 offen offset:3072 lds
L_HJ2:
 s_cmp_eq_u32 s5, 1
 s_cbranch_scc0 L_OL14
 s_sub_u32 s58, s63, 1572864
 buffer_store_dwordx4 v[64:67], v38, s[28:31], s58 offen offset:0 sc1
 buffer_store_dwordx4 v[68:71], v38, s[28:31], s58 offen offset:1024 sc1
 buffer_store_dwordx4 v[72:75], v38, s[28:31], s58 offen offset:2048 sc1
 buffer_store_dwordx4 v[76:79], v38, s[28:31], s58 offen offset:3072 sc1
 s_sub_u32 s58, s63, 1048576
 buffer_store_dwordx4 v[80:83], v38, s[28:31], s58 offen offset:0 sc1
 buffer_store_dwordx4 v[84:87], v38, s[28:31], s58 offen offset:1024 sc1
L_OL14:
 s_waitcnt lgkmcnt(15)
 v_mfma_f32_16x16x32_bf16 a[128:131], a[0:3], v[176:179], a[128:131]
 ds_read_b64_tr_b16 a[64:65], v30 offset:49152
 ds_read_b64_tr_b16 a[66:67], v30 offset:53248
 v_fma_f32 v52, v240, s64, -v4
 v_mfma_f32_16x16x32_bf16 a[132:135], a[4:7], v[176:179], a[132:135]
 ds_read_b64_tr_b16 a[68:69], v31 offset:49152
 ds_read_b64_tr_b16 a[70:71], v31 offset:53248
 v_fma_f32 v53, v241, s64, -v4
 v_mfma_f32_16x16x32_bf16 a[136:139], a[8:11], v[176:179], a[136:139]
 ds_read_b64_tr_b16 a[72:73], v32 offset:49152
 ds_read_b64_tr_b16 a[74:75], v32 offset:53248
 v_fma_f32 v54, v242, s64, -v4
 v_mfma_f32_16x16x32_bf16 a[140:143], a[12:15], v[176:179], a[140:143]
 v_fma_f32 v55, v243, s64, -v4
 v_fma_f32 v56, v244, s64, -v4
 v_fma_f32 v57, v245, s64, -v4
 v_fma_f32 v58, v246, s64, -v4
 v_mfma_f32_16x16x32_bf16 a[144:147], a[16:19], v[176:179], a[144:147]
 ds_read_b64_tr_b16 a[76:77], v33 offset:49152
 ds_read_b64_tr_b16 a[78:79], v33 offset:53248
 v_fma_f32 v59, v247, s64, -v4
 v_mfma_f32_16x16x32_bf16 a[148:151], a[20:23], v[176:179], a[148:151]
 ds_read_b64_tr_b16 a[80:81], v34 offset:49152
 ds_read_b64_tr_b16 a[82:83], v34 offset:53248
 v_exp_f32 v52, v52
 v_mfma_f32_16x16x32_bf16 a[152:155], a[24:27], v[176:179], a[152:155]
 ds_read_b64_tr_b16 a[84:85], v35 offset:49152
 ds_read_b64_tr_b16 a[86:87], v35 offset:53248
 v_exp_f32 v53, v53
 v_mfma_f32_16x16x32_bf16 a[156:159], a[28:31], v[176:179], a[156:159]
 v_exp_f32 v54, v54
 v_exp_f32 v55, v55
 v_exp_f32 v56, v56
 v_exp_f32 v57, v57
 v_mfma_f32_16x16x32_bf16 a[160:163], a[168:171], v[176:179], a[160:163]
 ds_read_b64_tr_b16 a[88:89], v36 offset:49152
 ds_read_b64_tr_b16 a[90:91], v36 offset:53248
 v_exp_f32 v58, v58
 s_waitcnt lgkmcnt(15)
 v_mfma_f32_16x16x32_bf16 a[128:131], a[32:35], v[180:183], a[128:131]
 ds_read_b64_tr_b16 a[92:93], v37 offset:49152
 ds_read_b64_tr_b16 a[94:95], v37 offset:53248
 v_exp_f32 v59, v59
 v_mfma_f32_16x16x32_bf16 a[132:135], a[36:39], v[180:183], a[132:135]
 ds_read_b64_tr_b16 a[96:97], v30 offset:57344
 ds_read_b64_tr_b16 a[98:99], v30 offset:61440
 v_cvt_pk_bf16_f32 v184, v52, v53
 v_mfma_f32_16x16x32_bf16 a[136:139], a[40:43], v[180:183], a[136:139]
 v_cvt_pk_bf16_f32 v185, v54, v55
 v_cvt_pk_bf16_f32 v186, v56, v57
 v_cvt_pk_bf16_f32 v187, v58, v59
 v_fma_f32 v52, v248, s64, -v4
 v_mfma_f32_16x16x32_bf16 a[140:143], a[44:47], v[180:183], a[140:143]
 ds_read_b64_tr_b16 a[100:101], v31 offset:57344
 ds_read_b64_tr_b16 a[102:103], v31 offset:61440
 v_fma_f32 v53, v249, s64, -v4
 v_mfma_f32_16x16x32_bf16 a[144:147], a[48:51], v[180:183], a[144:147]
 ds_read_b64_tr_b16 a[104:105], v32 offset:57344
 ds_read_b64_tr_b16 a[106:107], v32 offset:61440
 v_fma_f32 v54, v250, s64, -v4
 v_mfma_f32_16x16x32_bf16 a[148:151], a[52:55], v[180:183], a[148:151]
 ds_read_b64_tr_b16 a[108:109], v33 offset:57344
 ds_read_b64_tr_b16 a[110:111], v33 offset:61440
 v_fma_f32 v55, v251, s64, -v4
 v_mfma_f32_16x16x32_bf16 a[152:155], a[56:59], v[180:183], a[152:155]
 v_fma_f32 v56, v252, s64, -v4
 v_fma_f32 v57, v253, s64, -v4
 v_fma_f32 v58, v254, s64, -v4
 v_fma_f32 v59, v255, s64, -v4
 s_waitcnt lgkmcnt(15)
 v_mfma_f32_16x16x32_bf16 a[156:159], a[60:63], v[180:183], a[156:159]
 ds_read_b64_tr_b16 a[112:113], v34 offset:57344
 ds_read_b64_tr_b16 a[114:115], v34 offset:61440
 ds_read_b64_tr_b16 a[116:117], v35 offset:57344
 ds_read_b64_tr_b16 a[118:119], v35 offset:61440
 v_exp_f32 v52, v52
 v_exp_f32 v53, v53
 v_mfma_f32_16x16x32_bf16 a[160:163], a[168:171], v[180:183], a[160:163]
 ds_read_b64_tr_b16 a[120:121], v36 offset:57344
 ds_read_b64_tr_b16 a[122:123], v36 offset:61440
 ds_read_b64_tr_b16 a[124:125], v37 offset:57344
 ds_read_b64_tr_b16 a[126:127], v37 offset:61440
 v_exp_f32 v54, v54
 v_exp_f32 v55, v55
 v_exp_f32 v56, v56
 v_exp_f32 v57, v57
 v_exp_f32 v58, v58
 v_exp_f32 v59, v59
 v_cvt_pk_bf16_f32 v188, v52, v53
 v_cvt_pk_bf16_f32 v189, v54, v55
 v_cvt_pk_bf16_f32 v190, v56, v57
 v_cvt_pk_bf16_f32 v191, v58, v59
 s_barrier
 s_cmp_eq_u32 s5, 1
 s_cbranch_scc1 L_HO3
 s_add_u32 m0, s65, 49152
 s_add_u32 s59, s61, 49152
 buffer_load_dwordx4 v8, s[24:27], s59 offen offset:0 nt lds
 buffer_load_dwordx4 v9, s[24:27], s59 offen offset:1024 nt lds
 buffer_load_dwordx4 v10, s[24:27], s59 offen offset:2048 nt lds
 buffer_load_dwordx4 v11, s[24:27], s59 offen offset:3072 nt lds
 s_branch L_HJ3
L_HO3:
 s_add_u32 s59, s52, 3
 s_and_b32 s59, s59, 7
 s_or_b32 s59, s59, 0
 s_lshl_b32 s59, s59, 17
 s_add_u32 m0, s65, 49152
 s_add_u32 s59, s59, s75
 buffer_load_dwordx4 v40, s[32:35], s59 offen offset:0 lds
 buffer_load_dwordx4 v41, s[32:35], s59 offen offset:1024 lds
 buffer_load_dwordx4 v42, s[32:35], s59 offen offset:2048 lds
 buffer_load_dwordx4 v43, s[32:35], s59 offen offset:3072 lds
L_HJ3:
 s_cmp_eq_u32 s5, 1
 s_cbranch_scc0 L_OL15
 s_sub_u32 s58, s63, 1048576
 buffer_store_dwordx4 v[88:91], v38, s[28:31], s58 offen offset:2048 sc1
 buffer_store_dwordx4 v[92:95], v38, s[28:31], s58 offen offset:3072 sc1
 s_sub_u32 s58, s63, 524288
 buffer_store_dwordx4 v[96:99], v38, s[28:31], s58 offen offset:0 sc1
 buffer_store_dwordx4 v[100:103], v38, s[28:31], s58 offen offset:1024 sc1
 buffer_store_dwordx4 v[104:107], v38, s[28:31], s58 offen offset:2048 sc1
 buffer_store_dwordx4 v[108:111], v38, s[28:31], s58 offen offset:3072 sc1
L_OL15:
 v_mfma_f32_16x16x32_bf16 a[128:131], a[64:67], v[184:187], a[128:131]
 v_mfma_f32_16x16x32_bf16 a[132:135], a[68:71], v[184:187], a[132:135]
 v_mfma_f32_16x16x32_bf16 a[136:139], a[72:75], v[184:187], a[136:139]
 v_mfma_f32_16x16x32_bf16 a[140:143], a[76:79], v[184:187], a[140:143]
 s_waitcnt lgkmcnt(15)
 v_mfma_f32_16x16x32_bf16 a[144:147], a[80:83], v[184:187], a[144:147]
 v_mfma_f32_16x16x32_bf16 a[148:151], a[84:87], v[184:187], a[148:151]
 v_mfma_f32_16x16x32_bf16 a[152:155], a[88:91], v[184:187], a[152:155]
 v_mfma_f32_16x16x32_bf16 a[156:159], a[92:95], v[184:187], a[156:159]
 v_mfma_f32_16x16x32_bf16 a[160:163], a[168:171], v[184:187], a[160:163]
 s_waitcnt lgkmcnt(14)
 v_mfma_f32_16x16x32_bf16 a[128:131], a[96:99], v[188:191], a[128:131]
 s_waitcnt lgkmcnt(12)
 v_mfma_f32_16x16x32_bf16 a[132:135], a[100:103], v[188:191], a[132:135]
 s_waitcnt lgkmcnt(10)
 v_mfma_f32_16x16x32_bf16 a[136:139], a[104:107], v[188:191], a[136:139]
 s_waitcnt lgkmcnt(8)
 v_mfma_f32_16x16x32_bf16 a[140:143], a[108:111], v[188:191], a[140:143]
 s_waitcnt lgkmcnt(6)
 v_mfma_f32_16x16x32_bf16 a[144:147], a[112:115], v[188:191], a[144:147]
 s_waitcnt lgkmcnt(4)
 v_mfma_f32_16x16x32_bf16 a[148:151], a[116:119], v[188:191], a[148:151]
 s_waitcnt lgkmcnt(2)
 v_mfma_f32_16x16x32_bf16 a[152:155], a[120:123], v[188:191], a[152:155]
 s_waitcnt lgkmcnt(0)
 v_mfma_f32_16x16x32_bf16 a[156:159], a[124:127], v[188:191], a[156:159]
 v_mfma_f32_16x16x32_bf16 a[160:163], a[168:171], v[188:191], a[160:163]
 s_nop 7
 v_accvgpr_read_b32 v4, a160
 s_nop 0
 v_rcp_f32 v4, v4
 v_accvgpr_read_b32 v128, a128
 v_accvgpr_read_b32 v129, a129
 v_accvgpr_read_b32 v130, a130
 v_accvgpr_read_b32 v131, a131
 v_accvgpr_read_b32 v132, a132
 v_accvgpr_read_b32 v133, a133
 v_accvgpr_read_b32 v134, a134
 v_accvgpr_read_b32 v135, a135
 v_accvgpr_read_b32 v136, a136
 v_accvgpr_read_b32 v137, a137
 v_accvgpr_read_b32 v138, a138
 v_accvgpr_read_b32 v139, a139
 v_accvgpr_read_b32 v140, a140
 v_accvgpr_read_b32 v141, a141
 v_accvgpr_read_b32 v142, a142
 v_accvgpr_read_b32 v143, a143
 v_accvgpr_read_b32 v144, a144
 v_accvgpr_read_b32 v145, a145
 v_accvgpr_read_b32 v146, a146
 v_accvgpr_read_b32 v147, a147
 v_accvgpr_read_b32 v148, a148
 v_accvgpr_read_b32 v149, a149
 v_accvgpr_read_b32 v150, a150
 v_accvgpr_read_b32 v151, a151
 v_accvgpr_read_b32 v152, a152
 v_accvgpr_read_b32 v153, a153
 v_accvgpr_read_b32 v154, a154
 v_accvgpr_read_b32 v155, a155
 v_accvgpr_read_b32 v156, a156
 v_accvgpr_read_b32 v157, a157
 v_accvgpr_read_b32 v158, a158
 v_accvgpr_read_b32 v159, a159
 v_mul_f32 v128, v128, v4
 v_mul_f32 v129, v129, v4
 v_mul_f32 v130, v130, v4
 v_mul_f32 v131, v131, v4
 v_mul_f32 v132, v132, v4
 v_mul_f32 v133, v133, v4
 v_mul_f32 v134, v134, v4
 v_mul_f32 v135, v135, v4
 v_mul_f32 v136, v136, v4
 v_mul_f32 v137, v137, v4
 v_mul_f32 v138, v138, v4
 v_mul_f32 v139, v139, v4
 v_mul_f32 v140, v140, v4
 v_mul_f32 v141, v141, v4
 v_mul_f32 v142, v142, v4
 v_mul_f32 v143, v143, v4
 v_mul_f32 v144, v144, v4
 v_mul_f32 v145, v145, v4
 v_mul_f32 v146, v146, v4
 v_mul_f32 v147, v147, v4
 v_mul_f32 v148, v148, v4
 v_mul_f32 v149, v149, v4
 v_mul_f32 v150, v150, v4
 v_mul_f32 v151, v151, v4
 v_mul_f32 v152, v152, v4
 v_mul_f32 v153, v153, v4
 v_mul_f32 v154, v154, v4
 v_mul_f32 v155, v155, v4
 v_mul_f32 v156, v156, v4
 v_mul_f32 v157, v157, v4
 v_mul_f32 v158, v158, v4
 v_mul_f32 v159, v159, v4
 s_cmp_eq_u32 s62, 0
 s_cbranch_scc0 L_OP0
 v_cvt_pk_bf16_f32 v64, v128, v129
 v_cvt_pk_bf16_f32 v65, v130, v131
 v_cvt_pk_bf16_f32 v66, v132, v133
 v_cvt_pk_bf16_f32 v67, v134, v135
 v_cvt_pk_bf16_f32 v68, v136, v137
 v_cvt_pk_bf16_f32 v69, v138, v139
 v_cvt_pk_bf16_f32 v70, v140, v141
 v_cvt_pk_bf16_f32 v71, v142, v143
 v_cvt_pk_bf16_f32 v72, v144, v145
 v_cvt_pk_bf16_f32 v73, v146, v147
 v_cvt_pk_bf16_f32 v74, v148, v149
 v_cvt_pk_bf16_f32 v75, v150, v151
 v_cvt_pk_bf16_f32 v76, v152, v153
 v_cvt_pk_bf16_f32 v77, v154, v155
 v_cvt_pk_bf16_f32 v78, v156, v157
 v_cvt_pk_bf16_f32 v79, v158, v159
L_OP0:
 s_cmp_eq_u32 s62, 1
 s_cbranch_scc0 L_OP1
 v_cvt_pk_bf16_f32 v80, v128, v129
 v_cvt_pk_bf16_f32 v81, v130, v131
 v_cvt_pk_bf16_f32 v82, v132, v133
 v_cvt_pk_bf16_f32 v83, v134, v135
 v_cvt_pk_bf16_f32 v84, v136, v137
 v_cvt_pk_bf16_f32 v85, v138, v139
 v_cvt_pk_bf16_f32 v86, v140, v141
 v_cvt_pk_bf16_f32 v87, v142, v143
 v_cvt_pk_bf16_f32 v88, v144, v145
 v_cvt_pk_bf16_f32 v89, v146, v147
 v_cvt_pk_bf16_f32 v90, v148, v149
 v_cvt_pk_bf16_f32 v91, v150, v151
 v_cvt_pk_bf16_f32 v92, v152, v153
 v_cvt_pk_bf16_f32 v93, v154, v155
 v_cvt_pk_bf16_f32 v94, v156, v157
 v_cvt_pk_bf16_f32 v95, v158, v159
L_OP1:
 s_cmp_eq_u32 s62, 2
 s_cbranch_scc0 L_OP2
 v_cvt_pk_bf16_f32 v96, v128, v129
 v_cvt_pk_bf16_f32 v97, v130, v131
 v_cvt_pk_bf16_f32 v98, v132, v133
 v_cvt_pk_bf16_f32 v99, v134, v135
 v_cvt_pk_bf16_f32 v100, v136, v137
 v_cvt_pk_bf16_f32 v101, v138, v139
 v_cvt_pk_bf16_f32 v102, v140, v141
 v_cvt_pk_bf16_f32 v103, v142, v143
 v_cvt_pk_bf16_f32 v104, v144, v145
 v_cvt_pk_bf16_f32 v105, v146, v147
 v_cvt_pk_bf16_f32 v106, v148, v149
 v_cvt_pk_bf16_f32 v107, v150, v151
 v_cvt_pk_bf16_f32 v108, v152, v153
 v_cvt_pk_bf16_f32 v109, v154, v155
 v_cvt_pk_bf16_f32 v110, v156, v157
 v_cvt_pk_bf16_f32 v111, v158, v159
L_OP2:
 s_cmp_eq_u32 s62, 3
 s_cbranch_scc0 L_OP3
 v_cvt_pk_bf16_f32 v112, v128, v129
 v_cvt_pk_bf16_f32 v113, v130, v131
 v_cvt_pk_bf16_f32 v114, v132, v133
 v_cvt_pk_bf16_f32 v115, v134, v135
 v_cvt_pk_bf16_f32 v116, v136, v137
 v_cvt_pk_bf16_f32 v117, v138, v139
 v_cvt_pk_bf16_f32 v118, v140, v141
 v_cvt_pk_bf16_f32 v119, v142, v143
 v_cvt_pk_bf16_f32 v120, v144, v145
 v_cvt_pk_bf16_f32 v121, v146, v147
 v_cvt_pk_bf16_f32 v122, v148, v149
 v_cvt_pk_bf16_f32 v123, v150, v151
 v_cvt_pk_bf16_f32 v124, v152, v153
 v_cvt_pk_bf16_f32 v125, v154, v155
 v_cvt_pk_bf16_f32 v126, v156, v157
 v_cvt_pk_bf16_f32 v127, v158, v159
L_OP3:
 s_cmp_eq_u32 s5, 1
 s_cbranch_scc0 L_OSKIP
 s_sub_u32 s59, s63, 0
 buffer_store_dwordx4 v[112:115], v38, s[28:31], s59 offen offset:0 sc1
 buffer_store_dwordx4 v[116:119], v38, s[28:31], s59 offen offset:1024 sc1
 buffer_store_dwordx4 v[120:123], v38, s[28:31], s59 offen offset:2048 sc1
 buffer_store_dwordx4 v[124:127], v38, s[28:31], s59 offen offset:3072 sc1
L_OSKIP:
 s_add_u32 s60, s60, 0x400000
 s_add_u32 s61, s61, 0x400000
 s_add_u32 s63, s63, 524288
 s_cmp_eq_u32 s5, 1
 s_cbranch_scc0 L_A_DONE
 s_waitcnt vmcnt(0)
 s_barrier
 s_cmp_lg_u32 s44, 0
 s_cbranch_scc1 L_A_DONE
 v_accvgpr_read_b32 v1, a166
 v_accvgpr_read_b32 v3, a164
 s_nop 0
 v_readfirstlane_b32 s58, v1
 v_readfirstlane_b32 s59, v3
 s_nop 3
 s_cmp_eq_u32 s58, 0
 s_cselect_b32 s74, s59, s58
 s_lshl_b32 s58, s2, 7
 s_add_u32 s58, s58, 46137344
 s_add_u32 s58, s58, 0
 v_mov_b32 v1, s58
 v_mov_b32 v3, s74
 s_mov_b64 exec, 1
 global_store_dword v1, v3, s[90:91] sc1
 s_mov_b64 exec, -1
L_A_DONE:
 s_add_u32 s62, s62, 1
 s_cmp_lt_u32 s62, 4
 s_cbranch_scc1 L_ITEM
 s_lshl_b32 s58, s50, 7
 v_xor_b32 v46, s58, v22
 v_xor_b32 v47, s58, v23
 v_xor_b32 v48, s58, v24
 v_xor_b32 v49, s58, v25
 v_xor_b32 v50, s58, v26
 v_xor_b32 v51, s58, v27
 v_xor_b32 v52, s58, v28
 v_xor_b32 v53, s58, v29
 v_xor_b32 v54, s58, v30
 v_xor_b32 v55, s58, v31
 v_xor_b32 v56, s58, v32
 v_xor_b32 v57, s58, v33
 v_xor_b32 v58, s58, v34
 v_xor_b32 v59, s58, v35
 v_xor_b32 v60, s58, v36
 v_xor_b32 v61, s58, v37
 v_mov_b32 v1, 0
 v_accvgpr_write_b32 a192, v1
 v_accvgpr_write_b32 a193, v1
 v_accvgpr_write_b32 a194, v1
 v_accvgpr_write_b32 a195, v1
 v_accvgpr_write_b32 a196, v1
 v_accvgpr_write_b32 a197, v1
 v_accvgpr_write_b32 a198, v1
 v_accvgpr_write_b32 a199, v1
 v_accvgpr_write_b32 a200, v1
 v_accvgpr_write_b32 a201, v1
 v_accvgpr_write_b32 a202, v1
 v_accvgpr_write_b32 a203, v1
 v_accvgpr_write_b32 a204, v1
 v_accvgpr_write_b32 a205, v1
 v_accvgpr_write_b32 a206, v1
 v_accvgpr_write_b32 a207, v1
 v_accvgpr_write_b32 a208, v1
 v_accvgpr_write_b32 a209, v1
 v_accvgpr_write_b32 a210, v1
 v_accvgpr_write_b32 a211, v1
 v_accvgpr_write_b32 a212, v1
 v_accvgpr_write_b32 a213, v1
 v_accvgpr_write_b32 a214, v1
 v_accvgpr_write_b32 a215, v1
 v_accvgpr_write_b32 a216, v1
 v_accvgpr_write_b32 a217, v1
 v_accvgpr_write_b32 a218, v1
 v_accvgpr_write_b32 a219, v1
 v_accvgpr_write_b32 a220, v1
 v_accvgpr_write_b32 a221, v1
 v_accvgpr_write_b32 a222, v1
 v_accvgpr_write_b32 a223, v1
 v_accvgpr_write_b32 a224, v1
 v_accvgpr_write_b32 a225, v1
 v_accvgpr_write_b32 a226, v1
 v_accvgpr_write_b32 a227, v1
 v_accvgpr_write_b32 a228, v1
 v_accvgpr_write_b32 a229, v1
 v_accvgpr_write_b32 a230, v1
 v_accvgpr_write_b32 a231, v1
 v_accvgpr_write_b32 a232, v1
 v_accvgpr_write_b32 a233, v1
 v_accvgpr_write_b32 a234, v1
 v_accvgpr_write_b32 a235, v1
 v_accvgpr_write_b32 a236, v1
 v_accvgpr_write_b32 a237, v1
 v_accvgpr_write_b32 a238, v1
 v_accvgpr_write_b32 a239, v1
 v_accvgpr_write_b32 a240, v1
 v_accvgpr_write_b32 a241, v1
 v_accvgpr_write_b32 a242, v1
 v_accvgpr_write_b32 a243, v1
 v_accvgpr_write_b32 a244, v1
 v_accvgpr_write_b32 a245, v1
 v_accvgpr_write_b32 a246, v1
 v_accvgpr_write_b32 a247, v1
 v_accvgpr_write_b32 a248, v1
 v_accvgpr_write_b32 a249, v1
 v_accvgpr_write_b32 a250, v1
 v_accvgpr_write_b32 a251, v1
 v_accvgpr_write_b32 a252, v1
 v_accvgpr_write_b32 a253, v1
 v_accvgpr_write_b32 a254, v1
 v_accvgpr_write_b32 a255, v1
 s_cmp_lg_u32 s44, 0
 s_cbranch_scc1 L_O_WAITB
 v_mov_b32 v1, 131072
 v_mov_b32 v3, s74
 ds_write_b32 v1, v3
 s_mov_b32 s6, 0
 s_mov_b64 exec, 0xffff
L_O_POLL:
 global_load_dword v3, v44, s[90:91] sc1
 s_add_u32 s6, s6, 1
 s_waitcnt vmcnt(0)
 v_cmp_eq_u32 vcc, s74, v3
 s_cmp_gt_u32 s6, 0x40000
 s_cbranch_scc1 L_O_POLLX
 s_nop 1
 s_cmp_lg_u32 vcc_lo, 0xffff
 s_cbranch_scc1 L_O_POLL
L_O_POLLX:
 s_mov_b64 exec, -1
 s_waitcnt lgkmcnt(0)
L_O_WAITB:
 s_barrier
 v_mov_b32 v1, 131072
 ds_read_b32 v3, v1
 s_waitcnt lgkmcnt(0)
 v_readfirstlane_b32 s74, v3
 s_add_u32 s58, s52, 0
 s_and_b32 s58, s58, 7
 s_lshl_b32 s58, s58, 11
 s_add_u32 s78, s58, s76
 buffer_load_dwordx4 v[128:131], v38, s[28:31], s78 offen offset:0 sc1
 buffer_load_dwordx4 v[132:135], v38, s[28:31], s78 offen offset:1024 sc1
 buffer_load_dwordx4 v[136:139], v39, s[28:31], s78 offen offset:0 sc1
 buffer_load_dwordx4 v[140:143], v39, s[28:31], s78 offen offset:1024 sc1
 s_add_u32 s58, s52, 1
 s_and_b32 s58, s58, 7
 s_lshl_b32 s58, s58, 11
 s_add_u32 s78, s58, s76
 buffer_load_dwordx4 v[144:147], v38, s[28:31], s78 offen offset:0 sc1
 buffer_load_dwordx4 v[148:151], v38, s[28:31], s78 offen offset:1024 sc1
 buffer_load_dwordx4 v[152:155], v39, s[28:31], s78 offen offset:0 sc1
 buffer_load_dwordx4 v[156:159], v39, s[28:31], s78 offen offset:1024 sc1
 s_add_u32 s58, s52, 2
 s_and_b32 s58, s58, 7
 s_lshl_b32 s58, s58, 11
 s_add_u32 s78, s58, s76
 buffer_load_dwordx4 v[160:163], v38, s[28:31], s78 offen offset:0 sc1
 buffer_load_dwordx4 v[164:167], v38, s[28:31], s78 offen offset:1024 sc1
 buffer_load_dwordx4 v[168:171], v39, s[28:31], s78 offen offset:0 sc1
 buffer_load_dwordx4 v[172:175], v39, s[28:31], s78 offen offset:1024 sc1
 ds_read_b64_tr_b16 a[0:1], v46 offset:0
 ds_read_b64_tr_b16 a[2:3], v46 offset:4096
 ds_read_b64_tr_b16 a[4:5], v47 offset:0
 ds_read_b64_tr_b16 a[6:7], v47 offset:4096
 ds_read_b64_tr_b16 a[8:9], v48 offset:0
 ds_read_b64_tr_b16 a[10:11], v48 offset:4096
 ds_read_b64_tr_b16 a[12:13], v49 offset:0
 ds_read_b64_tr_b16 a[14:15], v49 offset:4096
 ds_read_b64_tr_b16 a[16:17], v50 offset:0
 ds_read_b64_tr_b16 a[18:19], v50 offset:4096
 ds_read_b64_tr_b16 a[20:21], v51 offset:0
 ds_read_b64_tr_b16 a[22:23], v51 offset:4096
 ds_read_b64_tr_b16 a[24:25], v52 offset:0
 ds_read_b64_tr_b16 a[26:27], v52 offset:4096
 ds_read_b64_tr_b16 a[28:29], v53 offset:0
 ds_read_b64_tr_b16 a[30:31], v53 offset:4096
 ds_read_b64_tr_b16 a[32:33], v46 offset:8192
 ds_read_b64_tr_b16 a[34:35], v46 offset:12288
 ds_read_b64_tr_b16 a[36:37], v47 offset:8192
 ds_read_b64_tr_b16 a[38:39], v47 offset:12288
 ds_read_b64_tr_b16 a[40:41], v48 offset:8192
 ds_read_b64_tr_b16 a[42:43], v48 offset:12288
 ds_read_b64_tr_b16 a[44:45], v49 offset:8192
 ds_read_b64_tr_b16 a[46:47], v49 offset:12288
 ds_read_b64_tr_b16 a[48:49], v50 offset:8192
 ds_read_b64_tr_b16 a[50:51], v50 offset:12288
 ds_read_b64_tr_b16 a[52:53], v51 offset:8192
 ds_read_b64_tr_b16 a[54:55], v51 offset:12288
 ds_read_b64_tr_b16 a[56:57], v52 offset:8192
 ds_read_b64_tr_b16 a[58:59], v52 offset:12288
 ds_read_b64_tr_b16 a[60:61], v53 offset:8192
 ds_read_b64_tr_b16 a[62:63], v53 offset:12288
 s_add_u32 s58, s52, 4
 s_and_b32 s58, s58, 7
 s_lshl_b32 s79, s58, 17
 s_add_u32 s58, s52, 3
 s_and_b32 s58, s58, 7
 s_lshl_b32 s80, s58, 11
 s_add_u32 s75, s75, 0
 s_add_u32 s76, s76, 0
 s_mov_b32 s4, 0
 s_waitcnt lgkmcnt(0)
L_O_LOOP:
 s_waitcnt vmcnt(8)
 s_barrier
 v_mfma_f32_16x16x32_bf16 a[192:195], a[0:3], v[128:131], a[192:195]
 ds_read_b64_tr_b16 a[64:65], v46 offset:16384
 v_mfma_f32_16x16x32_bf16 a[224:227], a[0:3], v[136:139], a[224:227]
 ds_read_b64_tr_b16 a[66:67], v46 offset:20480
 s_add_u32 s77, s79, s75
 s_waitcnt lgkmcnt(15)
 v_mfma_f32_16x16x32_bf16 a[196:199], a[4:7], v[128:131], a[196:199]
 ds_read_b64_tr_b16 a[68:69], v47 offset:16384
 s_add_u32 m0, s65, 65536
 v_mfma_f32_16x16x32_bf16 a[228:231], a[4:7], v[136:139], a[228:231]
 buffer_load_dwordx4 v40, s[40:43], s77 offen offset:0 lds
 v_mfma_f32_16x16x32_bf16 a[200:203], a[8:11], v[128:131], a[200:203]
 ds_read_b64_tr_b16 a[70:71], v47 offset:20480
 v_mfma_f32_16x16x32_bf16 a[232:235], a[8:11], v[136:139], a[232:235]
 ds_read_b64_tr_b16 a[72:73], v48 offset:16384
 s_add_u32 s78, s80, s76
 v_mfma_f32_16x16x32_bf16 a[204:207], a[12:15], v[128:131], a[204:207]
 ds_read_b64_tr_b16 a[74:75], v48 offset:20480
 v_mfma_f32_16x16x32_bf16 a[236:239], a[12:15], v[136:139], a[236:239]
 buffer_load_dwordx4 v[176:179], v38, s[84:87], s78 offen offset:0 sc1
 v_mfma_f32_16x16x32_bf16 a[208:211], a[16:19], v[128:131], a[208:211]
 ds_read_b64_tr_b16 a[76:77], v49 offset:16384
 s_add_u32 s79, s79, 131072
 v_mfma_f32_16x16x32_bf16 a[240:243], a[16:19], v[136:139], a[240:243]
 ds_read_b64_tr_b16 a[78:79], v49 offset:20480
 s_and_b32 s79, s79, 917504
 v_mfma_f32_16x16x32_bf16 a[212:215], a[20:23], v[128:131], a[212:215]
 ds_read_b64_tr_b16 a[80:81], v50 offset:16384
 v_mfma_f32_16x16x32_bf16 a[244:247], a[20:23], v[136:139], a[244:247]
 buffer_load_dwordx4 v41, s[40:43], s77 offen offset:1024 lds
 v_mfma_f32_16x16x32_bf16 a[216:219], a[24:27], v[128:131], a[216:219]
 ds_read_b64_tr_b16 a[82:83], v50 offset:20480
 s_add_u32 s80, s80, 2048
 v_mfma_f32_16x16x32_bf16 a[248:251], a[24:27], v[136:139], a[248:251]
 ds_read_b64_tr_b16 a[84:85], v51 offset:16384
 s_and_b32 s80, s80, 14336
 v_mfma_f32_16x16x32_bf16 a[220:223], a[28:31], v[128:131], a[220:223]
 ds_read_b64_tr_b16 a[86:87], v51 offset:20480
 v_mfma_f32_16x16x32_bf16 a[252:255], a[28:31], v[136:139], a[252:255]
 buffer_load_dwordx4 v[180:183], v38, s[84:87], s78 offen offset:1024 sc1
 v_mfma_f32_16x16x32_bf16 a[192:195], a[32:35], v[132:135], a[192:195]
 ds_read_b64_tr_b16 a[88:89], v52 offset:16384
 v_mfma_f32_16x16x32_bf16 a[224:227], a[32:35], v[140:143], a[224:227]
 ds_read_b64_tr_b16 a[90:91], v52 offset:20480
 s_waitcnt lgkmcnt(15)
 v_mfma_f32_16x16x32_bf16 a[196:199], a[36:39], v[132:135], a[196:199]
 ds_read_b64_tr_b16 a[92:93], v53 offset:16384
 v_mfma_f32_16x16x32_bf16 a[228:231], a[36:39], v[140:143], a[228:231]
 buffer_load_dwordx4 v42, s[40:43], s77 offen offset:2048 lds
 v_mfma_f32_16x16x32_bf16 a[200:203], a[40:43], v[132:135], a[200:203]
 ds_read_b64_tr_b16 a[94:95], v53 offset:20480
 v_mfma_f32_16x16x32_bf16 a[232:235], a[40:43], v[140:143], a[232:235]
 ds_read_b64_tr_b16 a[96:97], v46 offset:24576
 s_waitcnt lgkmcnt(15)
 v_mfma_f32_16x16x32_bf16 a[204:207], a[44:47], v[132:135], a[204:207]
 ds_read_b64_tr_b16 a[98:99], v46 offset:28672
 ds_read_b64_tr_b16 a[112:113], v50 offset:24576
 v_mfma_f32_16x16x32_bf16 a[236:239], a[44:47], v[140:143], a[236:239]
 buffer_load_dwordx4 v[184:187], v39, s[84:87], s78 offen offset:0 sc1
 ds_read_b64_tr_b16 a[114:115], v50 offset:28672
 v_mfma_f32_16x16x32_bf16 a[208:211], a[48:51], v[132:135], a[208:211]
 ds_read_b64_tr_b16 a[100:101], v47 offset:24576
 ds_read_b64_tr_b16 a[116:117], v51 offset:24576
 v_mfma_f32_16x16x32_bf16 a[240:243], a[48:51], v[140:143], a[240:243]
 ds_read_b64_tr_b16 a[102:103], v47 offset:28672
 ds_read_b64_tr_b16 a[118:119], v51 offset:28672
 v_mfma_f32_16x16x32_bf16 a[212:215], a[52:55], v[132:135], a[212:215]
 ds_read_b64_tr_b16 a[104:105], v48 offset:24576
 ds_read_b64_tr_b16 a[120:121], v52 offset:24576
 v_mfma_f32_16x16x32_bf16 a[244:247], a[52:55], v[140:143], a[244:247]
 buffer_load_dwordx4 v43, s[40:43], s77 offen offset:3072 lds
 ds_read_b64_tr_b16 a[122:123], v52 offset:28672
 v_mfma_f32_16x16x32_bf16 a[216:219], a[56:59], v[132:135], a[216:219]
 ds_read_b64_tr_b16 a[106:107], v48 offset:28672
 ds_read_b64_tr_b16 a[124:125], v53 offset:24576
 v_mfma_f32_16x16x32_bf16 a[248:251], a[56:59], v[140:143], a[248:251]
 ds_read_b64_tr_b16 a[108:109], v49 offset:24576
 ds_read_b64_tr_b16 a[126:127], v53 offset:28672
 v_mfma_f32_16x16x32_bf16 a[220:223], a[60:63], v[132:135], a[220:223]
 ds_read_b64_tr_b16 a[110:111], v49 offset:28672
 v_mfma_f32_16x16x32_bf16 a[252:255], a[60:63], v[140:143], a[252:255]
 buffer_load_dwordx4 v[188:191], v39, s[84:87], s78 offen offset:1024 sc1
 s_waitcnt vmcnt(8)
 s_barrier
 v_mfma_f32_16x16x32_bf16 a[192:195], a[64:67], v[144:147], a[192:195]
 ds_read_b64_tr_b16 a[0:1], v46 offset:32768
 v_mfma_f32_16x16x32_bf16 a[224:227], a[64:67], v[152:155], a[224:227]
 ds_read_b64_tr_b16 a[2:3], v46 offset:36864
 s_add_u32 s77, s79, s75
 s_waitcnt lgkmcnt(15)
 v_mfma_f32_16x16x32_bf16 a[196:199], a[68:71], v[144:147], a[196:199]
 ds_read_b64_tr_b16 a[4:5], v47 offset:32768
 s_add_u32 m0, s65, 81920
 v_mfma_f32_16x16x32_bf16 a[228:231], a[68:71], v[152:155], a[228:231]
 buffer_load_dwordx4 v40, s[40:43], s77 offen offset:0 lds
 v_mfma_f32_16x16x32_bf16 a[200:203], a[72:75], v[144:147], a[200:203]
 ds_read_b64_tr_b16 a[6:7], v47 offset:36864
 v_mfma_f32_16x16x32_bf16 a[232:235], a[72:75], v[152:155], a[232:235]
 ds_read_b64_tr_b16 a[8:9], v48 offset:32768
 s_add_u32 s78, s80, s76
 v_mfma_f32_16x16x32_bf16 a[204:207], a[76:79], v[144:147], a[204:207]
 ds_read_b64_tr_b16 a[10:11], v48 offset:36864
 v_mfma_f32_16x16x32_bf16 a[236:239], a[76:79], v[152:155], a[236:239]
 buffer_load_dwordx4 v[128:131], v38, s[84:87], s78 offen offset:0 sc1
 v_mfma_f32_16x16x32_bf16 a[208:211], a[80:83], v[144:147], a[208:211]
 ds_read_b64_tr_b16 a[12:13], v49 offset:32768
 s_add_u32 s79, s79, 131072
 v_mfma_f32_16x16x32_bf16 a[240:243], a[80:83], v[152:155], a[240:243]
 ds_read_b64_tr_b16 a[14:15], v49 offset:36864
 s_and_b32 s79, s79, 917504
 v_mfma_f32_16x16x32_bf16 a[212:215], a[84:87], v[144:147], a[212:215]
 ds_read_b64_tr_b16 a[16:17], v50 offset:32768
 v_mfma_f32_16x16x32_bf16 a[244:247], a[84:87], v[152:155], a[244:247]
 buffer_load_dwordx4 v41, s[40:43], s77 offen offset:1024 lds
 v_mfma_f32_16x16x32_bf16 a[216:219], a[88:91], v[144:147], a[216:219]
 ds_read_b64_tr_b16 a[18:19], v50 offset:36864
 s_add_u32 s80, s80, 2048
 v_mfma_f32_16x16x32_bf16 a[248:251], a[88:91], v[152:155], a[248:251]
 ds_read_b64_tr_b16 a[20:21], v51 offset:32768
 s_and_b32 s80, s80, 14336
 v_mfma_f32_16x16x32_bf16 a[220:223], a[92:95], v[144:147], a[220:223]
 ds_read_b64_tr_b16 a[22:23], v51 offset:36864
 v_mfma_f32_16x16x32_bf16 a[252:255], a[92:95], v[152:155], a[252:255]
 buffer_load_dwordx4 v[132:135], v38, s[84:87], s78 offen offset:1024 sc1
 v_mfma_f32_16x16x32_bf16 a[192:195], a[96:99], v[148:151], a[192:195]
 ds_read_b64_tr_b16 a[24:25], v52 offset:32768
 v_mfma_f32_16x16x32_bf16 a[224:227], a[96:99], v[156:159], a[224:227]
 ds_read_b64_tr_b16 a[26:27], v52 offset:36864
 s_waitcnt lgkmcnt(15)
 v_mfma_f32_16x16x32_bf16 a[196:199], a[100:103], v[148:151], a[196:199]
 ds_read_b64_tr_b16 a[28:29], v53 offset:32768
 v_mfma_f32_16x16x32_bf16 a[228:231], a[100:103], v[156:159], a[228:231]
 buffer_load_dwordx4 v42, s[40:43], s77 offen offset:2048 lds
 v_mfma_f32_16x16x32_bf16 a[200:203], a[104:107], v[148:151], a[200:203]
 ds_read_b64_tr_b16 a[30:31], v53 offset:36864
 v_mfma_f32_16x16x32_bf16 a[232:235], a[104:107], v[156:159], a[232:235]
 ds_read_b64_tr_b16 a[32:33], v46 offset:40960
 s_waitcnt lgkmcnt(15)
 v_mfma_f32_16x16x32_bf16 a[204:207], a[108:111], v[148:151], a[204:207]
 ds_read_b64_tr_b16 a[34:35], v46 offset:45056
 ds_read_b64_tr_b16 a[48:49], v50 offset:40960
 v_mfma_f32_16x16x32_bf16 a[236:239], a[108:111], v[156:159], a[236:239]
 buffer_load_dwordx4 v[136:139], v39, s[84:87], s78 offen offset:0 sc1
 ds_read_b64_tr_b16 a[50:51], v50 offset:45056
 v_mfma_f32_16x16x32_bf16 a[208:211], a[112:115], v[148:151], a[208:211]
 ds_read_b64_tr_b16 a[36:37], v47 offset:40960
 ds_read_b64_tr_b16 a[52:53], v51 offset:40960
 v_mfma_f32_16x16x32_bf16 a[240:243], a[112:115], v[156:159], a[240:243]
 ds_read_b64_tr_b16 a[38:39], v47 offset:45056
 ds_read_b64_tr_b16 a[54:55], v51 offset:45056
 v_mfma_f32_16x16x32_bf16 a[212:215], a[116:119], v[148:151], a[212:215]
 ds_read_b64_tr_b16 a[40:41], v48 offset:40960
 ds_read_b64_tr_b16 a[56:57], v52 offset:40960
 v_mfma_f32_16x16x32_bf16 a[244:247], a[116:119], v[156:159], a[244:247]
 buffer_load_dwordx4 v43, s[40:43], s77 offen offset:3072 lds
 ds_read_b64_tr_b16 a[58:59], v52 offset:45056
 v_mfma_f32_16x16x32_bf16 a[216:219], a[120:123], v[148:151], a[216:219]
 ds_read_b64_tr_b16 a[42:43], v48 offset:45056
 ds_read_b64_tr_b16 a[60:61], v53 offset:40960
 v_mfma_f32_16x16x32_bf16 a[248:251], a[120:123], v[156:159], a[248:251]
 ds_read_b64_tr_b16 a[44:45], v49 offset:40960
 ds_read_b64_tr_b16 a[62:63], v53 offset:45056
 v_mfma_f32_16x16x32_bf16 a[220:223], a[124:127], v[148:151], a[220:223]
 ds_read_b64_tr_b16 a[46:47], v49 offset:45056
 v_mfma_f32_16x16x32_bf16 a[252:255], a[124:127], v[156:159], a[252:255]
 buffer_load_dwordx4 v[140:143], v39, s[84:87], s78 offen offset:1024 sc1
 s_waitcnt vmcnt(8)
 s_barrier
 v_mfma_f32_16x16x32_bf16 a[192:195], a[0:3], v[160:163], a[192:195]
 ds_read_b64_tr_b16 a[64:65], v46 offset:49152
 v_mfma_f32_16x16x32_bf16 a[224:227], a[0:3], v[168:171], a[224:227]
 ds_read_b64_tr_b16 a[66:67], v46 offset:53248
 s_add_u32 s77, s79, s75
 s_waitcnt lgkmcnt(15)
 v_mfma_f32_16x16x32_bf16 a[196:199], a[4:7], v[160:163], a[196:199]
 ds_read_b64_tr_b16 a[68:69], v47 offset:49152
 s_add_u32 m0, s65, 98304
 v_mfma_f32_16x16x32_bf16 a[228:231], a[4:7], v[168:171], a[228:231]
 buffer_load_dwordx4 v40, s[40:43], s77 offen offset:0 lds
 v_mfma_f32_16x16x32_bf16 a[200:203], a[8:11], v[160:163], a[200:203]
 ds_read_b64_tr_b16 a[70:71], v47 offset:53248
 v_mfma_f32_16x16x32_bf16 a[232:235], a[8:11], v[168:171], a[232:235]
 ds_read_b64_tr_b16 a[72:73], v48 offset:49152
 s_add_u32 s78, s80, s76
 v_mfma_f32_16x16x32_bf16 a[204:207], a[12:15], v[160:163], a[204:207]
 ds_read_b64_tr_b16 a[74:75], v48 offset:53248
 v_mfma_f32_16x16x32_bf16 a[236:239], a[12:15], v[168:171], a[236:239]
 buffer_load_dwordx4 v[144:147], v38, s[84:87], s78 offen offset:0 sc1
 v_mfma_f32_16x16x32_bf16 a[208:211], a[16:19], v[160:163], a[208:211]
 ds_read_b64_tr_b16 a[76:77], v49 offset:49152
 s_add_u32 s79, s79, 131072
 v_mfma_f32_16x16x32_bf16 a[240:243], a[16:19], v[168:171], a[240:243]
 ds_read_b64_tr_b16 a[78:79], v49 offset:53248
 s_and_b32 s79, s79, 917504
 v_mfma_f32_16x16x32_bf16 a[212:215], a[20:23], v[160:163], a[212:215]
 ds_read_b64_tr_b16 a[80:81], v50 offset:49152
 v_mfma_f32_16x16x32_bf16 a[244:247], a[20:23], v[168:171], a[244:247]
 buffer_load_dwordx4 v41, s[40:43], s77 offen offset:1024 lds
 v_mfma_f32_16x16x32_bf16 a[216:219], a[24:27], v[160:163], a[216:219]
 ds_read_b64_tr_b16 a[82:83], v50 offset:53248
 s_add_u32 s80, s80, 2048
 v_mfma_f32_16x16x32_bf16 a[248:251], a[24:27], v[168:171], a[248:251]
 ds_read_b64_tr_b16 a[84:85], v51 offset:49152
 s_and_b32 s80, s80, 14336
 v_mfma_f32_16x16x32_bf16 a[220:223], a[28:31], v[160:163], a[220:223]
 ds_read_b64_tr_b16 a[86:87], v51 offset:53248
 v_mfma_f32_16x16x32_bf16 a[252:255], a[28:31], v[168:171], a[252:255]
 buffer_load_dwordx4 v[148:151], v38, s[84:87], s78 offen offset:1024 sc1
 v_mfma_f32_16x16x32_bf16 a[192:195], a[32:35], v[164:167], a[192:195]
 ds_read_b64_tr_b16 a[88:89], v52 offset:49152
 v_mfma_f32_16x16x32_bf16 a[224:227], a[32:35], v[172:175], a[224:227]
 ds_read_b64_tr_b16 a[90:91], v52 offset:53248
 s_waitcnt lgkmcnt(15)
 v_mfma_f32_16x16x32_bf16 a[196:199], a[36:39], v[164:167], a[196:199]
 ds_read_b64_tr_b16 a[92:93], v53 offset:49152
 v_mfma_f32_16x16x32_bf16 a[228:231], a[36:39], v[172:175], a[228:231]
 buffer_load_dwordx4 v42, s[40:43], s77 offen offset:2048 lds
 v_mfma_f32_16x16x32_bf16 a[200:203], a[40:43], v[164:167], a[200:203]
 ds_read_b64_tr_b16 a[94:95], v53 offset:53248
 v_mfma_f32_16x16x32_bf16 a[232:235], a[40:43], v[172:175], a[232:235]
 ds_read_b64_tr_b16 a[96:97], v46 offset:57344
 s_waitcnt lgkmcnt(15)
 v_mfma_f32_16x16x32_bf16 a[204:207], a[44:47], v[164:167], a[204:207]
 ds_read_b64_tr_b16 a[98:99], v46 offset:61440
 ds_read_b64_tr_b16 a[112:113], v50 offset:57344
 v_mfma_f32_16x16x32_bf16 a[236:239], a[44:47], v[172:175], a[236:239]
 buffer_load_dwordx4 v[152:155], v39, s[84:87], s78 offen offset:0 sc1
 ds_read_b64_tr_b16 a[114:115], v50 offset:61440
 v_mfma_f32_16x16x32_bf16 a[208:211], a[48:51], v[164:167], a[208:211]
 ds_read_b64_tr_b16 a[100:101], v47 offset:57344
 ds_read_b64_tr_b16 a[116:117], v51 offset:57344
 v_mfma_f32_16x16x32_bf16 a[240:243], a[48:51], v[172:175], a[240:243]
 ds_read_b64_tr_b16 a[102:103], v47 offset:61440
 ds_read_b64_tr_b16 a[118:119], v51 offset:61440
 v_mfma_f32_16x16x32_bf16 a[212:215], a[52:55], v[164:167], a[212:215]
 ds_read_b64_tr_b16 a[104:105], v48 offset:57344
 ds_read_b64_tr_b16 a[120:121], v52 offset:57344
 v_mfma_f32_16x16x32_bf16 a[244:247], a[52:55], v[172:175], a[244:247]
 buffer_load_dwordx4 v43, s[40:43], s77 offen offset:3072 lds
 ds_read_b64_tr_b16 a[122:123], v52 offset:61440
 v_mfma_f32_16x16x32_bf16 a[216:219], a[56:59], v[164:167], a[216:219]
 ds_read_b64_tr_b16 a[106:107], v48 offset:61440
 ds_read_b64_tr_b16 a[124:125], v53 offset:57344
 v_mfma_f32_16x16x32_bf16 a[248:251], a[56:59], v[172:175], a[248:251]
 ds_read_b64_tr_b16 a[108:109], v49 offset:57344
 ds_read_b64_tr_b16 a[126:127], v53 offset:61440
 v_mfma_f32_16x16x32_bf16 a[220:223], a[60:63], v[164:167], a[220:223]
 ds_read_b64_tr_b16 a[110:111], v49 offset:61440
 v_mfma_f32_16x16x32_bf16 a[252:255], a[60:63], v[172:175], a[252:255]
 buffer_load_dwordx4 v[156:159], v39, s[84:87], s78 offen offset:1024 sc1
 s_waitcnt vmcnt(8)
 s_barrier
 v_mfma_f32_16x16x32_bf16 a[192:195], a[64:67], v[176:179], a[192:195]
 ds_read_b64_tr_b16 a[0:1], v54 offset:0
 v_mfma_f32_16x16x32_bf16 a[224:227], a[64:67], v[184:187], a[224:227]
 ds_read_b64_tr_b16 a[2:3], v54 offset:4096
 s_add_u32 s77, s79, s75
 s_waitcnt lgkmcnt(15)
 v_mfma_f32_16x16x32_bf16 a[196:199], a[68:71], v[176:179], a[196:199]
 ds_read_b64_tr_b16 a[4:5], v55 offset:0
 s_add_u32 m0, s65, 114688
 v_mfma_f32_16x16x32_bf16 a[228:231], a[68:71], v[184:187], a[228:231]
 buffer_load_dwordx4 v40, s[40:43], s77 offen offset:0 lds
 v_mfma_f32_16x16x32_bf16 a[200:203], a[72:75], v[176:179], a[200:203]
 ds_read_b64_tr_b16 a[6:7], v55 offset:4096
 v_mfma_f32_16x16x32_bf16 a[232:235], a[72:75], v[184:187], a[232:235]
 ds_read_b64_tr_b16 a[8:9], v56 offset:0
 s_add_u32 s78, s80, s76
 v_mfma_f32_16x16x32_bf16 a[204:207], a[76:79], v[176:179], a[204:207]
 ds_read_b64_tr_b16 a[10:11], v56 offset:4096
 v_mfma_f32_16x16x32_bf16 a[236:239], a[76:79], v[184:187], a[236:239]
 buffer_load_dwordx4 v[160:163], v38, s[84:87], s78 offen offset:0 sc1
 v_mfma_f32_16x16x32_bf16 a[208:211], a[80:83], v[176:179], a[208:211]
 ds_read_b64_tr_b16 a[12:13], v57 offset:0
 s_add_u32 s79, s79, 131072
 v_mfma_f32_16x16x32_bf16 a[240:243], a[80:83], v[184:187], a[240:243]
 ds_read_b64_tr_b16 a[14:15], v57 offset:4096
 s_and_b32 s79, s79, 917504
 v_mfma_f32_16x16x32_bf16 a[212:215], a[84:87], v[176:179], a[212:215]
 ds_read_b64_tr_b16 a[16:17], v58 offset:0
 v_mfma_f32_16x16x32_bf16 a[244:247], a[84:87], v[184:187], a[244:247]
 buffer_load_dwordx4 v41, s[40:43], s77 offen offset:1024 lds
 v_mfma_f32_16x16x32_bf16 a[216:219], a[88:91], v[176:179], a[216:219]
 ds_read_b64_tr_b16 a[18:19], v58 offset:4096
 s_add_u32 s80, s80, 2048
 v_mfma_f32_16x16x32_bf16 a[248:251], a[88:91], v[184:187], a[248:251]
 ds_read_b64_tr_b16 a[20:21], v59 offset:0
 s_and_b32 s80, s80, 14336
 v_mfma_f32_16x16x32_bf16 a[220:223], a[92:95], v[176:179], a[220:223]
 ds_read_b64_tr_b16 a[22:23], v59 offset:4096
 v_mfma_f32_16x16x32_bf16 a[252:255], a[92:95], v[184:187], a[252:255]
 buffer_load_dwordx4 v[164:167], v38, s[84:87], s78 offen offset:1024 sc1
 v_mfma_f32_16x16x32_bf16 a[192:195], a[96:99], v[180:183], a[192:195]
 ds_read_b64_tr_b16 a[24:25], v60 offset:0
 v_mfma_f32_16x16x32_bf16 a[224:227], a[96:99], v[188:191], a[224:227]
 ds_read_b64_tr_b16 a[26:27], v60 offset:4096
 s_waitcnt lgkmcnt(15)
 v_mfma_f32_16x16x32_bf16 a[196:199], a[100:103], v[180:183], a[196:199]
 ds_read_b64_tr_b16 a[28:29], v61 offset:0
 v_mfma_f32_16x16x32_bf16 a[228:231], a[100:103], v[188:191], a[228:231]
 buffer_load_dwordx4 v42, s[40:43], s77 offen offset:2048 lds
 v_mfma_f32_16x16x32_bf16 a[200:203], a[104:107], v[180:183], a[200:203]
 ds_read_b64_tr_b16 a[30:31], v61 offset:4096
 v_mfma_f32_16x16x32_bf16 a[232:235], a[104:107], v[188:191], a[232:235]
 ds_read_b64_tr_b16 a[32:33], v54 offset:8192
 s_waitcnt lgkmcnt(15)
 v_mfma_f32_16x16x32_bf16 a[204:207], a[108:111], v[180:183], a[204:207]
 ds_read_b64_tr_b16 a[34:35], v54 offset:12288
 ds_read_b64_tr_b16 a[48:49], v58 offset:8192
 v_mfma_f32_16x16x32_bf16 a[236:239], a[108:111], v[188:191], a[236:239]
 buffer_load_dwordx4 v[168:171], v39, s[84:87], s78 offen offset:0 sc1
 ds_read_b64_tr_b16 a[50:51], v58 offset:12288
 v_mfma_f32_16x16x32_bf16 a[208:211], a[112:115], v[180:183], a[208:211]
 ds_read_b64_tr_b16 a[36:37], v55 offset:8192
 ds_read_b64_tr_b16 a[52:53], v59 offset:8192
 v_mfma_f32_16x16x32_bf16 a[240:243], a[112:115], v[188:191], a[240:243]
 ds_read_b64_tr_b16 a[38:39], v55 offset:12288
 ds_read_b64_tr_b16 a[54:55], v59 offset:12288
 v_mfma_f32_16x16x32_bf16 a[212:215], a[116:119], v[180:183], a[212:215]
 ds_read_b64_tr_b16 a[40:41], v56 offset:8192
 ds_read_b64_tr_b16 a[56:57], v60 offset:8192
 v_mfma_f32_16x16x32_bf16 a[244:247], a[116:119], v[188:191], a[244:247]
 buffer_load_dwordx4 v43, s[40:43], s77 offen offset:3072 lds
 ds_read_b64_tr_b16 a[58:59], v60 offset:12288
 v_mfma_f32_16x16x32_bf16 a[216:219], a[120:123], v[180:183], a[216:219]
 ds_read_b64_tr_b16 a[42:43], v56 offset:12288
 ds_read_b64_tr_b16 a[60:61], v61 offset:8192
 v_mfma_f32_16x16x32_bf16 a[248:251], a[120:123], v[188:191], a[248:251]
 ds_read_b64_tr_b16 a[44:45], v57 offset:8192
 ds_read_b64_tr_b16 a[62:63], v61 offset:12288
 v_mfma_f32_16x16x32_bf16 a[220:223], a[124:127], v[180:183], a[220:223]
 ds_read_b64_tr_b16 a[46:47], v57 offset:12288
 v_mfma_f32_16x16x32_bf16 a[252:255], a[124:127], v[188:191], a[252:255]
 buffer_load_dwordx4 v[172:175], v39, s[84:87], s78 offen offset:1024 sc1
 s_waitcnt vmcnt(8)
 s_barrier
 v_mfma_f32_16x16x32_bf16 a[192:195], a[0:3], v[128:131], a[192:195]
 ds_read_b64_tr_b16 a[64:65], v54 offset:16384
 s_add_u32 s75, s75, 1048576
 s_cmp_lt_u32 s4, 24
 s_cselect_b32 s42, 8388608, 0
 v_mfma_f32_16x16x32_bf16 a[224:227], a[0:3], v[136:139], a[224:227]
 ds_read_b64_tr_b16 a[66:67], v54 offset:20480
 s_add_u32 s77, s79, s75
 s_waitcnt lgkmcnt(15)
 v_mfma_f32_16x16x32_bf16 a[196:199], a[4:7], v[128:131], a[196:199]
 ds_read_b64_tr_b16 a[68:69], v55 offset:16384
 s_add_u32 m0, s65, 0
 v_mfma_f32_16x16x32_bf16 a[228:231], a[4:7], v[136:139], a[228:231]
 buffer_load_dwordx4 v40, s[40:43], s77 offen offset:0 lds
 v_mfma_f32_16x16x32_bf16 a[200:203], a[8:11], v[128:131], a[200:203]
 ds_read_b64_tr_b16 a[70:71], v55 offset:20480
 v_mfma_f32_16x16x32_bf16 a[232:235], a[8:11], v[136:139], a[232:235]
 ds_read_b64_tr_b16 a[72:73], v56 offset:16384
 s_add_u32 s78, s80, s76
 v_mfma_f32_16x16x32_bf16 a[204:207], a[12:15], v[128:131], a[204:207]
 ds_read_b64_tr_b16 a[74:75], v56 offset:20480
 v_mfma_f32_16x16x32_bf16 a[236:239], a[12:15], v[136:139], a[236:239]
 buffer_load_dwordx4 v[176:179], v38, s[84:87], s78 offen offset:0 sc1
 v_mfma_f32_16x16x32_bf16 a[208:211], a[16:19], v[128:131], a[208:211]
 ds_read_b64_tr_b16 a[76:77], v57 offset:16384
 s_add_u32 s79, s79, 131072
 v_mfma_f32_16x16x32_bf16 a[240:243], a[16:19], v[136:139], a[240:243]
 ds_read_b64_tr_b16 a[78:79], v57 offset:20480
 s_and_b32 s79, s79, 917504
 v_mfma_f32_16x16x32_bf16 a[212:215], a[20:23], v[128:131], a[212:215]
 ds_read_b64_tr_b16 a[80:81], v58 offset:16384
 v_mfma_f32_16x16x32_bf16 a[244:247], a[20:23], v[136:139], a[244:247]
 buffer_load_dwordx4 v41, s[40:43], s77 offen offset:1024 lds
 v_mfma_f32_16x16x32_bf16 a[216:219], a[24:27], v[128:131], a[216:219]
 ds_read_b64_tr_b16 a[82:83], v58 offset:20480
 s_add_u32 s80, s80, 2048
 v_mfma_f32_16x16x32_bf16 a[248:251], a[24:27], v[136:139], a[248:251]
 ds_read_b64_tr_b16 a[84:85], v59 offset:16384
 s_and_b32 s80, s80, 14336
 v_mfma_f32_16x16x32_bf16 a[220:223], a[28:31], v[128:131], a[220:223]
 ds_read_b64_tr_b16 a[86:87], v59 offset:20480
 v_mfma_f32_16x16x32_bf16 a[252:255], a[28:31], v[136:139], a[252:255]
 buffer_load_dwordx4 v[180:183], v38, s[84:87], s78 offen offset:1024 sc1
 v_mfma_f32_16x16x32_bf16 a[192:195], a[32:35], v[132:135], a[192:195]
 ds_read_b64_tr_b16 a[88:89], v60 offset:16384
 v_mfma_f32_16x16x32_bf16 a[224:227], a[32:35], v[140:143], a[224:227]
 ds_read_b64_tr_b16 a[90:91], v60 offset:20480
 s_waitcnt lgkmcnt(15)
 v_mfma_f32_16x16x32_bf16 a[196:199], a[36:39], v[132:135], a[196:199]
 ds_read_b64_tr_b16 a[92:93], v61 offset:16384
 v_mfma_f32_16x16x32_bf16 a[228:231], a[36:39], v[140:143], a[228:231]
 buffer_load_dwordx4 v42, s[40:43], s77 offen offset:2048 lds
 v_mfma_f32_16x16x32_bf16 a[200:203], a[40:43], v[132:135], a[200:203]
 ds_read_b64_tr_b16 a[94:95], v61 offset:20480
 v_mfma_f32_16x16x32_bf16 a[232:235], a[40:43], v[140:143], a[232:235]
 ds_read_b64_tr_b16 a[96:97], v54 offset:24576
 s_waitcnt lgkmcnt(15)
 v_mfma_f32_16x16x32_bf16 a[204:207], a[44:47], v[132:135], a[204:207]
 ds_read_b64_tr_b16 a[98:99], v54 offset:28672
 ds_read_b64_tr_b16 a[112:113], v58 offset:24576
 v_mfma_f32_16x16x32_bf16 a[236:239], a[44:47], v[140:143], a[236:239]
 buffer_load_dwordx4 v[184:187], v39, s[84:87], s78 offen offset:0 sc1
 ds_read_b64_tr_b16 a[114:115], v58 offset:28672
 v_mfma_f32_16x16x32_bf16 a[208:211], a[48:51], v[132:135], a[208:211]
 ds_read_b64_tr_b16 a[100:101], v55 offset:24576
 ds_read_b64_tr_b16 a[116:117], v59 offset:24576
 v_mfma_f32_16x16x32_bf16 a[240:243], a[48:51], v[140:143], a[240:243]
 ds_read_b64_tr_b16 a[102:103], v55 offset:28672
 ds_read_b64_tr_b16 a[118:119], v59 offset:28672
 v_mfma_f32_16x16x32_bf16 a[212:215], a[52:55], v[132:135], a[212:215]
 ds_read_b64_tr_b16 a[104:105], v56 offset:24576
 ds_read_b64_tr_b16 a[120:121], v60 offset:24576
 v_mfma_f32_16x16x32_bf16 a[244:247], a[52:55], v[140:143], a[244:247]
 buffer_load_dwordx4 v43, s[40:43], s77 offen offset:3072 lds
 ds_read_b64_tr_b16 a[122:123], v60 offset:28672
 v_mfma_f32_16x16x32_bf16 a[216:219], a[56:59], v[132:135], a[216:219]
 ds_read_b64_tr_b16 a[106:107], v56 offset:28672
 ds_read_b64_tr_b16 a[124:125], v61 offset:24576
 v_mfma_f32_16x16x32_bf16 a[248:251], a[56:59], v[140:143], a[248:251]
 ds_read_b64_tr_b16 a[108:109], v57 offset:24576
 ds_read_b64_tr_b16 a[126:127], v61 offset:28672
 v_mfma_f32_16x16x32_bf16 a[220:223], a[60:63], v[132:135], a[220:223]
 ds_read_b64_tr_b16 a[110:111], v57 offset:28672
 v_mfma_f32_16x16x32_bf16 a[252:255], a[60:63], v[140:143], a[252:255]
 buffer_load_dwordx4 v[188:191], v39, s[84:87], s78 offen offset:1024 sc1
 s_waitcnt vmcnt(8)
 s_barrier
 v_mfma_f32_16x16x32_bf16 a[192:195], a[64:67], v[144:147], a[192:195]
 ds_read_b64_tr_b16 a[0:1], v54 offset:32768
 v_mfma_f32_16x16x32_bf16 a[224:227], a[64:67], v[152:155], a[224:227]
 ds_read_b64_tr_b16 a[2:3], v54 offset:36864
 s_add_u32 s77, s79, s75
 s_waitcnt lgkmcnt(15)
 v_mfma_f32_16x16x32_bf16 a[196:199], a[68:71], v[144:147], a[196:199]
 ds_read_b64_tr_b16 a[4:5], v55 offset:32768
 s_add_u32 m0, s65, 16384
 v_mfma_f32_16x16x32_bf16 a[228:231], a[68:71], v[152:155], a[228:231]
 buffer_load_dwordx4 v40, s[40:43], s77 offen offset:0 lds
 v_mfma_f32_16x16x32_bf16 a[200:203], a[72:75], v[144:147], a[200:203]
 ds_read_b64_tr_b16 a[6:7], v55 offset:36864
 s_add_u32 s76, s76, 16384
 s_cmp_lt_u32 s4, 24
 s_cselect_b32 s86, 50331648, 0
 v_mfma_f32_16x16x32_bf16 a[232:235], a[72:75], v[152:155], a[232:235]
 ds_read_b64_tr_b16 a[8:9], v56 offset:32768
 s_add_u32 s78, s80, s76
 v_mfma_f32_16x16x32_bf16 a[204:207], a[76:79], v[144:147], a[204:207]
 ds_read_b64_tr_b16 a[10:11], v56 offset:36864
 v_mfma_f32_16x16x32_bf16 a[236:239], a[76:79], v[152:155], a[236:239]
 buffer_load_dwordx4 v[128:131], v38, s[84:87], s78 offen offset:0 sc1
 v_mfma_f32_16x16x32_bf16 a[208:211], a[80:83], v[144:147], a[208:211]
 ds_read_b64_tr_b16 a[12:13], v57 offset:32768
 s_add_u32 s79, s79, 131072
 v_mfma_f32_16x16x32_bf16 a[240:243], a[80:83], v[152:155], a[240:243]
 ds_read_b64_tr_b16 a[14:15], v57 offset:36864
 s_and_b32 s79, s79, 917504
 v_mfma_f32_16x16x32_bf16 a[212:215], a[84:87], v[144:147], a[212:215]
 ds_read_b64_tr_b16 a[16:17], v58 offset:32768
 v_mfma_f32_16x16x32_bf16 a[244:247], a[84:87], v[152:155], a[244:247]
 buffer_load_dwordx4 v41, s[40:43], s77 offen offset:1024 lds
 v_mfma_f32_16x16x32_bf16 a[216:219], a[88:91], v[144:147], a[216:219]
 ds_read_b64_tr_b16 a[18:19], v58 offset:36864
 s_add_u32 s80, s80, 2048
 v_mfma_f32_16x16x32_bf16 a[248:251], a[88:91], v[152:155], a[248:251]
 ds_read_b64_tr_b16 a[20:21], v59 offset:32768
 s_and_b32 s80, s80, 14336
 v_mfma_f32_16x16x32_bf16 a[220:223], a[92:95], v[144:147], a[220:223]
 ds_read_b64_tr_b16 a[22:23], v59 offset:36864
 v_mfma_f32_16x16x32_bf16 a[252:255], a[92:95], v[152:155], a[252:255]
 buffer_load_dwordx4 v[132:135], v38, s[84:87], s78 offen offset:1024 sc1
 v_mfma_f32_16x16x32_bf16 a[192:195], a[96:99], v[148:151], a[192:195]
 ds_read_b64_tr_b16 a[24:25], v60 offset:32768
 v_mfma_f32_16x16x32_bf16 a[224:227], a[96:99], v[156:159], a[224:227]
 ds_read_b64_tr_b16 a[26:27], v60 offset:36864
 s_waitcnt lgkmcnt(15)
 v_mfma_f32_16x16x32_bf16 a[196:199], a[100:103], v[148:151], a[196:199]
 ds_read_b64_tr_b16 a[28:29], v61 offset:32768
 v_mfma_f32_16x16x32_bf16 a[228:231], a[100:103], v[156:159], a[228:231]
 buffer_load_dwordx4 v42, s[40:43], s77 offen offset:2048 lds
 v_mfma_f32_16x16x32_bf16 a[200:203], a[104:107], v[148:151], a[200:203]
 ds_read_b64_tr_b16 a[30:31], v61 offset:36864
 v_mfma_f32_16x16x32_bf16 a[232:235], a[104:107], v[156:159], a[232:235]
 ds_read_b64_tr_b16 a[32:33], v54 offset:40960
 s_waitcnt lgkmcnt(15)
 v_mfma_f32_16x16x32_bf16 a[204:207], a[108:111], v[148:151], a[204:207]
 ds_read_b64_tr_b16 a[34:35], v54 offset:45056
 ds_read_b64_tr_b16 a[48:49], v58 offset:40960
 v_mfma_f32_16x16x32_bf16 a[236:239], a[108:111], v[156:159], a[236:239]
 buffer_load_dwordx4 v[136:139], v39, s[84:87], s78 offen offset:0 sc1
 ds_read_b64_tr_b16 a[50:51], v58 offset:45056
 v_mfma_f32_16x16x32_bf16 a[208:211], a[112:115], v[148:151], a[208:211]
 ds_read_b64_tr_b16 a[36:37], v55 offset:40960
 ds_read_b64_tr_b16 a[52:53], v59 offset:40960
 v_mfma_f32_16x16x32_bf16 a[240:243], a[112:115], v[156:159], a[240:243]
 ds_read_b64_tr_b16 a[38:39], v55 offset:45056
 ds_read_b64_tr_b16 a[54:55], v59 offset:45056
 v_mfma_f32_16x16x32_bf16 a[212:215], a[116:119], v[148:151], a[212:215]
 ds_read_b64_tr_b16 a[40:41], v56 offset:40960
 ds_read_b64_tr_b16 a[56:57], v60 offset:40960
 v_mfma_f32_16x16x32_bf16 a[244:247], a[116:119], v[156:159], a[244:247]
 buffer_load_dwordx4 v43, s[40:43], s77 offen offset:3072 lds
 ds_read_b64_tr_b16 a[58:59], v60 offset:45056
 v_mfma_f32_16x16x32_bf16 a[216:219], a[120:123], v[148:151], a[216:219]
 ds_read_b64_tr_b16 a[42:43], v56 offset:45056
 ds_read_b64_tr_b16 a[60:61], v61 offset:40960
 v_mfma_f32_16x16x32_bf16 a[248:251], a[120:123], v[156:159], a[248:251]
 ds_read_b64_tr_b16 a[44:45], v57 offset:40960
 ds_read_b64_tr_b16 a[62:63], v61 offset:45056
 v_mfma_f32_16x16x32_bf16 a[220:223], a[124:127], v[148:151], a[220:223]
 ds_read_b64_tr_b16 a[46:47], v57 offset:45056
 v_mfma_f32_16x16x32_bf16 a[252:255], a[124:127], v[156:159], a[252:255]
 buffer_load_dwordx4 v[140:143], v39, s[84:87], s78 offen offset:1024 sc1
 s_waitcnt vmcnt(8)
 s_barrier
 v_mfma_f32_16x16x32_bf16 a[192:195], a[0:3], v[160:163], a[192:195]
 ds_read_b64_tr_b16 a[64:65], v54 offset:49152
 v_mfma_f32_16x16x32_bf16 a[224:227], a[0:3], v[168:171], a[224:227]
 ds_read_b64_tr_b16 a[66:67], v54 offset:53248
 s_add_u32 s77, s79, s75
 s_waitcnt lgkmcnt(15)
 v_mfma_f32_16x16x32_bf16 a[196:199], a[4:7], v[160:163], a[196:199]
 ds_read_b64_tr_b16 a[68:69], v55 offset:49152
 s_add_u32 m0, s65, 32768
 v_mfma_f32_16x16x32_bf16 a[228:231], a[4:7], v[168:171], a[228:231]
 buffer_load_dwordx4 v40, s[40:43], s77 offen offset:0 lds
 v_mfma_f32_16x16x32_bf16 a[200:203], a[8:11], v[160:163], a[200:203]
 ds_read_b64_tr_b16 a[70:71], v55 offset:53248
 v_mfma_f32_16x16x32_bf16 a[232:235], a[8:11], v[168:171], a[232:235]
 ds_read_b64_tr_b16 a[72:73], v56 offset:49152
 s_add_u32 s78, s80, s76
 v_mfma_f32_16x16x32_bf16 a[204:207], a[12:15], v[160:163], a[204:207]
 ds_read_b64_tr_b16 a[74:75], v56 offset:53248
 v_mfma_f32_16x16x32_bf16 a[236:239], a[12:15], v[168:171], a[236:239]
 buffer_load_dwordx4 v[144:147], v38, s[84:87], s78 offen offset:0 sc1
 v_mfma_f32_16x16x32_bf16 a[208:211], a[16:19], v[160:163], a[208:211]
 ds_read_b64_tr_b16 a[76:77], v57 offset:49152
 s_add_u32 s79, s79, 131072
 v_mfma_f32_16x16x32_bf16 a[240:243], a[16:19], v[168:171], a[240:243]
 ds_read_b64_tr_b16 a[78:79], v57 offset:53248
 s_and_b32 s79, s79, 917504
 v_mfma_f32_16x16x32_bf16 a[212:215], a[20:23], v[160:163], a[212:215]
 ds_read_b64_tr_b16 a[80:81], v58 offset:49152
 v_mfma_f32_16x16x32_bf16 a[244:247], a[20:23], v[168:171], a[244:247]
 buffer_load_dwordx4 v41, s[40:43], s77 offen offset:1024 lds
 v_mfma_f32_16x16x32_bf16 a[216:219], a[24:27], v[160:163], a[216:219]
 ds_read_b64_tr_b16 a[82:83], v58 offset:53248
 s_add_u32 s80, s80, 2048
 v_mfma_f32_16x16x32_bf16 a[248:251], a[24:27], v[168:171], a[248:251]
 ds_read_b64_tr_b16 a[84:85], v59 offset:49152
 s_and_b32 s80, s80, 14336
 v_mfma_f32_16x16x32_bf16 a[220:223], a[28:31], v[160:163], a[220:223]
 ds_read_b64_tr_b16 a[86:87], v59 offset:53248
 v_mfma_f32_16x16x32_bf16 a[252:255], a[28:31], v[168:171], a[252:255]
 buffer_load_dwordx4 v[148:151], v38, s[84:87], s78 offen offset:1024 sc1
 v_mfma_f32_16x16x32_bf16 a[192:195], a[32:35], v[164:167], a[192:195]
 ds_read_b64_tr_b16 a[88:89], v60 offset:49152
 v_mfma_f32_16x16x32_bf16 a[224:227], a[32:35], v[172:175], a[224:227]
 ds_read_b64_tr_b16 a[90:91], v60 offset:53248
 s_waitcnt lgkmcnt(15)
 v_mfma_f32_16x16x32_bf16 a[196:199], a[36:39], v[164:167], a[196:199]
 ds_read_b64_tr_b16 a[92:93], v61 offset:49152
 v_mfma_f32_16x16x32_bf16 a[228:231], a[36:39], v[172:175], a[228:231]
 buffer_load_dwordx4 v42, s[40:43], s77 offen offset:2048 lds
 v_mfma_f32_16x16x32_bf16 a[200:203], a[40:43], v[164:167], a[200:203]
 ds_read_b64_tr_b16 a[94:95], v61 offset:53248
 v_mfma_f32_16x16x32_bf16 a[232:235], a[40:43], v[172:175], a[232:235]
 ds_read_b64_tr_b16 a[96:97], v54 offset:57344
 s_waitcnt lgkmcnt(15)
 v_mfma_f32_16x16x32_bf16 a[204:207], a[44:47], v[164:167], a[204:207]
 ds_read_b64_tr_b16 a[98:99], v54 offset:61440
 ds_read_b64_tr_b16 a[112:113], v58 offset:57344
 v_mfma_f32_16x16x32_bf16 a[236:239], a[44:47], v[172:175], a[236:239]
 buffer_load_dwordx4 v[152:155], v39, s[84:87], s78 offen offset:0 sc1
 ds_read_b64_tr_b16 a[114:115], v58 offset:61440
 v_mfma_f32_16x16x32_bf16 a[208:211], a[48:51], v[164:167], a[208:211]
 ds_read_b64_tr_b16 a[100:101], v55 offset:57344
 ds_read_b64_tr_b16 a[116:117], v59 offset:57344
 v_mfma_f32_16x16x32_bf16 a[240:243], a[48:51], v[172:175], a[240:243]
 ds_read_b64_tr_b16 a[102:103], v55 offset:61440
 ds_read_b64_tr_b16 a[118:119], v59 offset:61440
 v_mfma_f32_16x16x32_bf16 a[212:215], a[52:55], v[164:167], a[212:215]
 ds_read_b64_tr_b16 a[104:105], v56 offset:57344
 ds_read_b64_tr_b16 a[120:121], v60 offset:57344
 v_mfma_f32_16x16x32_bf16 a[244:247], a[52:55], v[172:175], a[244:247]
 buffer_load_dwordx4 v43, s[40:43], s77 offen offset:3072 lds
 ds_read_b64_tr_b16 a[122:123], v60 offset:61440
 v_mfma_f32_16x16x32_bf16 a[216:219], a[56:59], v[164:167], a[216:219]
 ds_read_b64_tr_b16 a[106:107], v56 offset:61440
 ds_read_b64_tr_b16 a[124:125], v61 offset:57344
 v_mfma_f32_16x16x32_bf16 a[248:251], a[56:59], v[172:175], a[248:251]
 ds_read_b64_tr_b16 a[108:109], v57 offset:57344
 ds_read_b64_tr_b16 a[126:127], v61 offset:61440
 v_mfma_f32_16x16x32_bf16 a[220:223], a[60:63], v[164:167], a[220:223]
 ds_read_b64_tr_b16 a[110:111], v57 offset:61440
 v_mfma_f32_16x16x32_bf16 a[252:255], a[60:63], v[172:175], a[252:255]
 buffer_load_dwordx4 v[156:159], v39, s[84:87], s78 offen offset:1024 sc1
 s_waitcnt vmcnt(8)
 s_barrier
 v_mfma_f32_16x16x32_bf16 a[192:195], a[64:67], v[176:179], a[192:195]
 ds_read_b64_tr_b16 a[0:1], v46 offset:0
 v_mfma_f32_16x16x32_bf16 a[224:227], a[64:67], v[184:187], a[224:227]
 ds_read_b64_tr_b16 a[2:3], v46 offset:4096
 s_add_u32 s77, s79, s75
 s_waitcnt lgkmcnt(15)
 v_mfma_f32_16x16x32_bf16 a[196:199], a[68:71], v[176:179], a[196:199]
 ds_read_b64_tr_b16 a[4:5], v47 offset:0
 s_add_u32 m0, s65, 49152
 v_mfma_f32_16x16x32_bf16 a[228:231], a[68:71], v[184:187], a[228:231]
 buffer_load_dwordx4 v40, s[40:43], s77 offen offset:0 lds
 v_mfma_f32_16x16x32_bf16 a[200:203], a[72:75], v[176:179], a[200:203]
 ds_read_b64_tr_b16 a[6:7], v47 offset:4096
 v_mfma_f32_16x16x32_bf16 a[232:235], a[72:75], v[184:187], a[232:235]
 ds_read_b64_tr_b16 a[8:9], v48 offset:0
 s_add_u32 s78, s80, s76
 v_mfma_f32_16x16x32_bf16 a[204:207], a[76:79], v[176:179], a[204:207]
 ds_read_b64_tr_b16 a[10:11], v48 offset:4096
 v_mfma_f32_16x16x32_bf16 a[236:239], a[76:79], v[184:187], a[236:239]
 buffer_load_dwordx4 v[160:163], v38, s[84:87], s78 offen offset:0 sc1
 v_mfma_f32_16x16x32_bf16 a[208:211], a[80:83], v[176:179], a[208:211]
 ds_read_b64_tr_b16 a[12:13], v49 offset:0
 s_add_u32 s79, s79, 131072
 v_mfma_f32_16x16x32_bf16 a[240:243], a[80:83], v[184:187], a[240:243]
 ds_read_b64_tr_b16 a[14:15], v49 offset:4096
 s_and_b32 s79, s79, 917504
 v_mfma_f32_16x16x32_bf16 a[212:215], a[84:87], v[176:179], a[212:215]
 ds_read_b64_tr_b16 a[16:17], v50 offset:0
 v_mfma_f32_16x16x32_bf16 a[244:247], a[84:87], v[184:187], a[244:247]
 buffer_load_dwordx4 v41, s[40:43], s77 offen offset:1024 lds
 v_mfma_f32_16x16x32_bf16 a[216:219], a[88:91], v[176:179], a[216:219]
 ds_read_b64_tr_b16 a[18:19], v50 offset:4096
 s_add_u32 s80, s80, 2048
 v_mfma_f32_16x16x32_bf16 a[248:251], a[88:91], v[184:187], a[248:251]
 ds_read_b64_tr_b16 a[20:21], v51 offset:0
 s_and_b32 s80, s80, 14336
 v_mfma_f32_16x16x32_bf16 a[220:223], a[92:95], v[176:179], a[220:223]
 ds_read_b64_tr_b16 a[22:23], v51 offset:4096
 v_mfma_f32_16x16x32_bf16 a[252:255], a[92:95], v[184:187], a[252:255]
 buffer_load_dwordx4 v[164:167], v38, s[84:87], s78 offen offset:1024 sc1
 v_mfma_f32_16x16x32_bf16 a[192:195], a[96:99], v[180:183], a[192:195]
 ds_read_b64_tr_b16 a[24:25], v52 offset:0
 v_mfma_f32_16x16x32_bf16 a[224:227], a[96:99], v[188:191], a[224:227]
 ds_read_b64_tr_b16 a[26:27], v52 offset:4096
 s_waitcnt lgkmcnt(15)
 v_mfma_f32_16x16x32_bf16 a[196:199], a[100:103], v[180:183], a[196:199]
 ds_read_b64_tr_b16 a[28:29], v53 offset:0
 v_mfma_f32_16x16x32_bf16 a[228:231], a[100:103], v[188:191], a[228:231]
 buffer_load_dwordx4 v42, s[40:43], s77 offen offset:2048 lds
 v_mfma_f32_16x16x32_bf16 a[200:203], a[104:107], v[180:183], a[200:203]
 ds_read_b64_tr_b16 a[30:31], v53 offset:4096
 v_mfma_f32_16x16x32_bf16 a[232:235], a[104:107], v[188:191], a[232:235]
 ds_read_b64_tr_b16 a[32:33], v46 offset:8192
 s_waitcnt lgkmcnt(15)
 v_mfma_f32_16x16x32_bf16 a[204:207], a[108:111], v[180:183], a[204:207]
 ds_read_b64_tr_b16 a[34:35], v46 offset:12288
 ds_read_b64_tr_b16 a[48:49], v50 offset:8192
 v_mfma_f32_16x16x32_bf16 a[236:239], a[108:111], v[188:191], a[236:239]
 buffer_load_dwordx4 v[168:171], v39, s[84:87], s78 offen offset:0 sc1
 ds_read_b64_tr_b16 a[50:51], v50 offset:12288
 v_mfma_f32_16x16x32_bf16 a[208:211], a[112:115], v[180:183], a[208:211]
 ds_read_b64_tr_b16 a[36:37], v47 offset:8192
 ds_read_b64_tr_b16 a[52:53], v51 offset:8192
 v_mfma_f32_16x16x32_bf16 a[240:243], a[112:115], v[188:191], a[240:243]
 ds_read_b64_tr_b16 a[38:39], v47 offset:12288
 ds_read_b64_tr_b16 a[54:55], v51 offset:12288
 v_mfma_f32_16x16x32_bf16 a[212:215], a[116:119], v[180:183], a[212:215]
 ds_read_b64_tr_b16 a[40:41], v48 offset:8192
 ds_read_b64_tr_b16 a[56:57], v52 offset:8192
 v_mfma_f32_16x16x32_bf16 a[244:247], a[116:119], v[188:191], a[244:247]
 buffer_load_dwordx4 v43, s[40:43], s77 offen offset:3072 lds
 ds_read_b64_tr_b16 a[58:59], v52 offset:12288
 v_mfma_f32_16x16x32_bf16 a[216:219], a[120:123], v[180:183], a[216:219]
 ds_read_b64_tr_b16 a[42:43], v48 offset:12288
 ds_read_b64_tr_b16 a[60:61], v53 offset:8192
 v_mfma_f32_16x16x32_bf16 a[248:251], a[120:123], v[188:191], a[248:251]
 ds_read_b64_tr_b16 a[44:45], v49 offset:8192
 ds_read_b64_tr_b16 a[62:63], v53 offset:12288
 v_mfma_f32_16x16x32_bf16 a[220:223], a[124:127], v[180:183], a[220:223]
 ds_read_b64_tr_b16 a[46:47], v49 offset:12288
 v_mfma_f32_16x16x32_bf16 a[252:255], a[124:127], v[188:191], a[252:255]
 buffer_load_dwordx4 v[172:175], v39, s[84:87], s78 offen offset:1024 sc1
 s_add_u32 s4, s4, 8
 s_cmp_lt_u32 s4, 32
 s_cbranch_scc1 L_O_LOOP
 s_waitcnt lgkmcnt(0)
 s_nop 7
 buffer_store_dwordx4 a[208:211], v38, s[28:31], s82 offen offset:0 sc1
 buffer_store_dwordx4 a[212:215], v38, s[28:31], s82 offen offset:1024 sc1
 buffer_store_dwordx4 a[216:219], v38, s[28:31], s82 offen offset:2048 sc1
 buffer_store_dwordx4 a[220:223], v38, s[28:31], s82 offen offset:3072 sc1
 s_add_u32 s82, s82, 4096
 buffer_store_dwordx4 a[240:243], v38, s[28:31], s82 offen offset:0 sc1
 buffer_store_dwordx4 a[244:247], v38, s[28:31], s82 offen offset:1024 sc1
 buffer_store_dwordx4 a[248:251], v38, s[28:31], s82 offen offset:2048 sc1
 buffer_store_dwordx4 a[252:255], v38, s[28:31], s82 offen offset:3072 sc1
 v_accvgpr_read_b32 v128, a192
 v_accvgpr_read_b32 v129, a193
 v_accvgpr_read_b32 v130, a194
 v_accvgpr_read_b32 v131, a195
 v_accvgpr_read_b32 v132, a196
 v_accvgpr_read_b32 v133, a197
 v_accvgpr_read_b32 v134, a198
 v_accvgpr_read_b32 v135, a199
 v_accvgpr_read_b32 v136, a200
 v_accvgpr_read_b32 v137, a201
 v_accvgpr_read_b32 v138, a202
 v_accvgpr_read_b32 v139, a203
 v_accvgpr_read_b32 v140, a204
 v_accvgpr_read_b32 v141, a205
 v_accvgpr_read_b32 v142, a206
 v_accvgpr_read_b32 v143, a207
 v_accvgpr_read_b32 v144, a224
 v_accvgpr_read_b32 v145, a225
 v_accvgpr_read_b32 v146, a226
 v_accvgpr_read_b32 v147, a227
 v_accvgpr_read_b32 v148, a228
 v_accvgpr_read_b32 v149, a229
 v_accvgpr_read_b32 v150, a230
 v_accvgpr_read_b32 v151, a231
 v_accvgpr_read_b32 v152, a232
 v_accvgpr_read_b32 v153, a233
 v_accvgpr_read_b32 v154, a234
 v_accvgpr_read_b32 v155, a235
 v_accvgpr_read_b32 v156, a236
 v_accvgpr_read_b32 v157, a237
 v_accvgpr_read_b32 v158, a238
 v_accvgpr_read_b32 v159, a239
 v_lshrrev_b32 v3, 4, v0
 v_and_b32 v4, 15, v0
 v_lshlrev_b32 v5, 3, v3
 v_lshl_add_u32 v52, v4, 12, v5
 s_lshl_b32 s6, s44, 2
 s_add_u32 s6, s6, 16
 s_waitcnt vmcnt(0)
 s_lshl_b32 s58, s2, 7
 s_add_u32 s58, s58, 46137344
 s_add_u32 s58, s58, s6
 v_mov_b32 v1, s58
 v_mov_b32 v3, s74
 s_mov_b64 exec, 1
 global_store_dword v1, v3, s[90:91] sc1
 s_mov_b64 exec, -1
 s_xor_b32 s58, s2, 128
 s_lshl_b32 s58, s58, 7
 s_add_u32 s58, s58, 46137344
 s_add_u32 s58, s58, s6
 v_mov_b32 v1, s58
 s_mov_b32 s6, 0
 s_mov_b64 exec, 1
L_X_POLL:
 global_load_dword v3, v1, s[90:91] sc1
 s_add_u32 s6, s6, 1
 s_waitcnt vmcnt(0)
 v_readfirstlane_b32 s58, v3
 s_cmp_gt_u32 s6, 0x40000
 s_cbranch_scc1 L_X_POLLX
 s_cmp_lg_u32 s58, s74
 s_cbranch_scc1 L_X_POLL
L_X_POLLX:
 s_mov_b64 exec, -1
 buffer_load_dwordx4 v[192:195], v38, s[28:31], s83 offen offset:0 sc1
 buffer_load_dwordx4 v[196:199], v38, s[28:31], s83 offen offset:1024 sc1
 buffer_load_dwordx4 v[200:203], v38, s[28:31], s83 offen offset:2048 sc1
 buffer_load_dwordx4 v[204:207], v38, s[28:31], s83 offen offset:3072 sc1
 s_add_u32 s83, s83, 4096
 buffer_load_dwordx4 v[208:211], v38, s[28:31], s83 offen offset:0 sc1
 buffer_load_dwordx4 v[212:215], v38, s[28:31], s83 offen offset:1024 sc1
 buffer_load_dwordx4 v[216:219], v38, s[28:31], s83 offen offset:2048 sc1
 buffer_load_dwordx4 v[220:223], v38, s[28:31], s83 offen offset:3072 sc1
 s_waitcnt vmcnt(0)
 v_add_f32 v128, v128, v192
 v_add_f32 v129, v129, v193
 v_add_f32 v130, v130, v194
 v_add_f32 v131, v131, v195
 v_cvt_pk_bf16_f32 v128, v128, v129
 v_cvt_pk_bf16_f32 v129, v130, v131
 buffer_store_dwordx2 v[128:129], v52, s[36:39], s81 offen offset:0
 v_add_f32 v132, v132, v196
 v_add_f32 v133, v133, v197
 v_add_f32 v134, v134, v198
 v_add_f32 v135, v135, v199
 v_cvt_pk_bf16_f32 v132, v132, v133
 v_cvt_pk_bf16_f32 v133, v134, v135
 buffer_store_dwordx2 v[132:133], v52, s[36:39], s81 offen offset:32
 v_add_f32 v136, v136, v200
 v_add_f32 v137, v137, v201
 v_add_f32 v138, v138, v202
 v_add_f32 v139, v139, v203
 v_cvt_pk_bf16_f32 v136, v136, v137
 v_cvt_pk_bf16_f32 v137, v138, v139
 buffer_store_dwordx2 v[136:137], v52, s[36:39], s81 offen offset:64
 v_add_f32 v140, v140, v204
 v_add_f32 v141, v141, v205
 v_add_f32 v142, v142, v206
 v_add_f32 v143, v143, v207
 v_cvt_pk_bf16_f32 v140, v140, v141
 v_cvt_pk_bf16_f32 v141, v142, v143
 buffer_store_dwordx2 v[140:141], v52, s[36:39], s81 offen offset:96
 s_add_u32 s81, s81, 0x10000
 v_add_f32 v144, v144, v208
 v_add_f32 v145, v145, v209
 v_add_f32 v146, v146, v210
 v_add_f32 v147, v147, v211
 v_cvt_pk_bf16_f32 v144, v144, v145
 v_cvt_pk_bf16_f32 v145, v146, v147
 buffer_store_dwordx2 v[144:145], v52, s[36:39], s81 offen offset:0
 v_add_f32 v148, v148, v212
 v_add_f32 v149, v149, v213
 v_add_f32 v150, v150, v214
 v_add_f32 v151, v151, v215
 v_cvt_pk_bf16_f32 v148, v148, v149
 v_cvt_pk_bf16_f32 v149, v150, v151
 buffer_store_dwordx2 v[148:149], v52, s[36:39], s81 offen offset:32
 v_add_f32 v152, v152, v216
 v_add_f32 v153, v153, v217
 v_add_f32 v154, v154, v218
 v_add_f32 v155, v155, v219
 v_cvt_pk_bf16_f32 v152, v152, v153
 v_cvt_pk_bf16_f32 v153, v154, v155
 buffer_store_dwordx2 v[152:153], v52, s[36:39], s81 offen offset:64
 v_add_f32 v156, v156, v220
 v_add_f32 v157, v157, v221
 v_add_f32 v158, v158, v222
 v_add_f32 v159, v159, v223
 v_cvt_pk_bf16_f32 v156, v156, v157
 v_cvt_pk_bf16_f32 v157, v158, v159
 buffer_store_dwordx2 v[156:157], v52, s[36:39], s81 offen offset:96
L_END:
 s_endpgm
.section .rodata,"a"
.p2align 6
.amdhsa_kernel concat_heads__mha_block_cached__mha_block_cached__near_ridge_kernel
  .amdhsa_next_free_vgpr 512
  .amdhsa_next_free_sgpr 102
  .amdhsa_accum_offset 256
  .amdhsa_group_segment_fixed_size 0
  .amdhsa_kernarg_size 104
  .amdhsa_user_sgpr_count 2
  .amdhsa_user_sgpr_kernarg_segment_ptr 1
  .amdhsa_system_sgpr_workgroup_id_x 1
.end_amdhsa_kernel
```
